```python
import torch

def _softmax(x, axis=-1):
    return torch.softmax(x, dim=axis)
def _gelu(x):
    return torch.nn.functional.gelu(x, approximate="tanh")
def _silu(x):
    return torch.nn.functional.silu(x)
def _sigmoid(x):
    return torch.sigmoid(x)
def _layernorm(x, axis=-1, eps=1e-5):
    m = x.mean(dim=axis, keepdim=True)
    v = x.var(dim=axis, keepdim=True, unbiased=False)
    return (x - m) / torch.sqrt(v + eps)
def _scatter_add(tgt, idx, src, axis=0):
    return tgt.clone().index_add_(axis, idx, src)
def _segment_sum(src, seg, n):
    out = torch.zeros((n,) + src.shape[1:], dtype=src.dtype)
    return out.index_add_(0, seg, src)
def _pad(x, pw):
    flat = tuple(v for pair in reversed(pw) for v in pair)
    return torch.nn.functional.pad(x, flat)

kernel_name = 'interleave_layers__grouped_kv_mqa__dense_activation_mish__prompt'

def setup_inputs():

    _w = (lambda a: (lambda t: t.to(torch.bfloat16) if t.is_floating_point() else t)(torch.as_tensor(a)))
    def _A_setup():
        B, S, D, H = 1, 2048, 640, 32
        Dh = D // H
        return {
            "x": _w((lambda *s: torch.randn(*s, dtype=torch.bfloat16) * 0.05)(B, S, D)),
            "wq": _w((lambda *s: torch.randn(*s, dtype=torch.bfloat16) * 0.05)(D, H * Dh)),
            "wk": _w((lambda *s: torch.randn(*s, dtype=torch.bfloat16) * 0.05)(D, Dh)),
            "wv": _w((lambda *s: torch.randn(*s, dtype=torch.bfloat16) * 0.05)(D, Dh)),
            "wo": _w((lambda *s: torch.randn(*s, dtype=torch.bfloat16) * 0.05)(H * Dh, D)),
        }
    _A_in = _A_setup()

    def _B_setup():
        B, S, D, F = 1, 2048, 640, 1728
        return {
            "x": _w((lambda *s: torch.randn(*s, dtype=torch.bfloat16) * 0.05)(B, S, D)),
            "w1": _w((lambda *s: torch.randn(*s, dtype=torch.bfloat16) * 1.6)(D, F) * (D ** -0.5)),
            "b1": _w((lambda *s: torch.randn(*s, dtype=torch.bfloat16) * 0.2)(F)),
            "w2": _w((lambda *s: torch.randn(*s, dtype=torch.bfloat16) * 0.2)(F, D) * (F ** -0.5)),
        }
    _B_in = _B_setup()

    return {
        "A_x": _A_in["x"],
        "A_wq": _A_in["wq"],
        "A_wk": _A_in["wk"],
        "A_wv": _A_in["wv"],
        "A_wo": _A_in["wo"],
        "B_x": _B_in["x"],
        "B_w1": _B_in["w1"],
        "B_b1": _B_in["b1"],
        "B_w2": _B_in["w2"],
    }

def reference(A_x, A_wq, A_wk, A_wv, A_wo, B_x, B_w1, B_b1, B_w2):
    def _A_ref(x, wq, wk, wv, wo):
        B, S, D = x.shape
        H = 32
        Dh = D // H
        q = (lambda x, *d: x.permute(*d))((x @ wq).reshape(B, S, H, Dh), 0, 2, 1, 3)
        k = x @ wk
        v = x @ wv
        scores = torch.einsum("bhqd,bkd->bhqk", q, k) * (Dh ** -0.5)
        p = _softmax(scores, axis=-1)
        o = torch.einsum("bhqk,bkd->bhqd", p, v)
        return (lambda x, *d: x.permute(*d))(o, 0, 2, 1, 3).reshape(B, S, H * Dh) @ wo

    def _B_ref(x, w1, b1, w2):
        h = torch.einsum("bsd,df->bsf", x, w1) + b1
        sp = torch.log1p(torch.exp(-torch.abs(h))) + torch.where(h > 0, h, torch.zeros_like(h))
        act = h * torch.tanh(sp)
        return torch.einsum("bsf,fd->bsd", act, w2)

    x = A_x
    x = x + _A_ref(_layernorm(x, axis=-1), A_wq, A_wk, A_wv, A_wo)
    x = x + _B_ref(_layernorm(x, axis=-1), B_w1, B_b1, B_w2)
    x = x + _A_ref(_layernorm(x, axis=-1), A_wq, A_wk, A_wv, A_wo)
    x = x + _B_ref(_layernorm(x, axis=-1), B_w1, B_b1, B_w2)
    return x
```

```asm
; @launch grid=(256,1,1) block=(256,1,1) lds=163840
.amdgcn_target "amdgcn-amd-amdhsa--gfx950"
.text
.globl interleave_layers__grouped_kv_mqa__dense_activation_mish__prompt_kernel
.type interleave_layers__grouped_kv_mqa__dense_activation_mish__prompt_kernel,@function
.p2align 8
interleave_layers__grouped_kv_mqa__dense_activation_mish__prompt_kernel:
  s_cmp_ge_u32 s2, 256
  s_cbranch_scc1 Lend
  s_getpc_b64 s[60:61]
Lf_pc:
  s_load_dwordx4 s[40:43], s[0:1], 0
  s_mov_b32 s62, Lcode_end-Lf_pc
  s_mov_b32 s63, 0x20000
  s_lshr_b32 s13, s2, 3
  s_lshl_b32 s13, s13, 12
  v_lshlrev_b32 v10, 4, v0
  buffer_load_dwordx4 a[88:91], v10, s[60:63], s13 offen
  s_load_dwordx2 s[4:5], s[0:1], 88
  s_load_dwordx4 s[44:47], s[0:1], 16
  s_load_dwordx2 s[48:49], s[0:1], 32
  s_load_dwordx4 s[52:55], s[0:1], 48
  s_load_dwordx2 s[50:51], s[0:1], 64
  s_load_dwordx2 s[6:7], s[0:1], 72
  s_mov_b32 s3, 0
  v_lshrrev_b32 v6, 6, v0
  v_and_b32 v0, 63, v0
  v_readfirstlane_b32 s12, v6
  v_lshlrev_b32 v1, 4, v0
  v_add_u32 v2, 4096, v1
  s_and_b32 s13, s2, 7
  s_lshr_b32 s14, s2, 6
  s_lshl_b32 s13, s13, 2
  s_add_u32 s10, s13, s14
  s_lshr_b32 s11, s2, 3
  s_and_b32 s11, s11, 7
  s_lshl_b32 s8, s10, 2
  s_add_u32 s8, s8, s12
  s_lshl_b32 s8, s8, 3
  s_add_u32 s8, s8, s11
  v_add_u32 v6, 0, v0
  v_mul_u32_u24 v7, 3277, v6
  v_lshrrev_b32 v7, 18, v7
  v_mul_u32_u24 v12, 80, v7
  v_sub_u32 v6, v6, v12
  v_xor_b32 v6, v6, v7
  v_add_u32 v6, v6, v12
  v_lshlrev_b32 v12, 4, v6
  v_add_u32 v6, 64, v0
  v_mul_u32_u24 v7, 3277, v6
  v_lshrrev_b32 v7, 18, v7
  v_mul_u32_u24 v13, 80, v7
  v_sub_u32 v6, v6, v13
  v_xor_b32 v6, v6, v7
  v_add_u32 v6, v6, v13
  v_lshlrev_b32 v13, 4, v6
  v_add_u32 v6, 128, v0
  v_mul_u32_u24 v7, 3277, v6
  v_lshrrev_b32 v7, 18, v7
  v_mul_u32_u24 v14, 80, v7
  v_sub_u32 v6, v6, v14
  v_xor_b32 v6, v6, v7
  v_add_u32 v6, v6, v14
  v_lshlrev_b32 v14, 4, v6
  v_add_u32 v6, 192, v0
  v_mul_u32_u24 v7, 3277, v6
  v_lshrrev_b32 v7, 18, v7
  v_mul_u32_u24 v15, 80, v7
  v_sub_u32 v6, v6, v15
  v_xor_b32 v6, v6, v7
  v_add_u32 v6, v6, v15
  v_lshlrev_b32 v15, 4, v6
  v_add_u32 v6, 256, v0
  v_mul_u32_u24 v7, 3277, v6
  v_lshrrev_b32 v7, 18, v7
  v_mul_u32_u24 v16, 80, v7
  v_sub_u32 v6, v6, v16
  v_xor_b32 v6, v6, v7
  v_add_u32 v6, v6, v16
  v_lshlrev_b32 v16, 4, v6
  s_mul_i32 s13, s2, 3200
  s_mul_i32 s81, s11, 160
  s_lshr_b32 s16, s8, 3
  s_mul_i32 s16, s16, 20480
  s_mul_i32 m0, s12, 20480
  s_mov_b32 s80, 0
  v_min_u32 v10, 3184, v10
  s_waitcnt lgkmcnt(0)
  s_mov_b32 s24, s42
  s_mov_b32 s25, s43
  s_mov_b32 s26, 819200
  s_mov_b32 s27, 0x20000
  buffer_load_dwordx4 a[88:91], v10, s[24:27], s13 offen
  s_add_u32 s56, s40, s16
  s_addc_u32 s57, s41, 0
  s_mov_b32 s58, 20480
  s_mov_b32 s59, 0x20000
  s_mul_i32 s13, s11, 2560
  buffer_load_dwordx4 a[88:91], v1, s[56:59], s13 offen offset:0
  buffer_load_dwordx4 a[88:91], v1, s[56:59], s13 offen offset:1024
  buffer_load_dwordx4 a[88:91], v1, s[56:59], s13 offen offset:1536
  s_mul_i32 s13, s10, 7168
  s_add_u32 s13, s13, 37224448
  s_add_u32 s64, s4, s13
  s_addc_u32 s65, s5, 0
  s_mov_b32 s66, 7168
  s_mov_b32 s67, 0x20000
  s_lshl_b32 s13, s11, 2
  s_add_u32 s13, s13, s12
  s_lshl_b32 s13, s13, 10
  buffer_load_dwordx4 a[88:91], v1, s[64:67], s13 offen sc1
  s_mov_b32 s84, s4
  s_mov_b32 s85, s5
  s_mov_b32 s86, 20971520
  s_mov_b32 s87, 0x20000
  s_sub_u32 s16, s11, 2
  s_lshl_b32 s16, s16, 5
  s_add_u32 s16, s16, s10
  s_mov_b32 s68, 0
  s_mov_b32 s64, s52
  s_mov_b32 s65, s53
  s_mov_b32 s66, 0
  s_mov_b32 s67, 0x20000
  s_mov_b32 s88, s54
  s_mov_b32 s89, s55
  s_mov_b32 s90, 0
  s_mov_b32 s91, 0x20000
  s_mov_b32 s69, 1073741824
  s_mov_b32 s72, 5120
  s_mov_b32 s73, 0
  s_mov_b32 s76, 0
  v_mov_b32 v20, 0
  s_cmp_lt_u32 s16, 54
  s_cbranch_scc0 Lf_not1
  s_mov_b32 s68, 1
  s_mov_b32 s66, 2211840
  s_lshr_b32 s17, s16, 1
  s_and_b32 s18, s16, 1
  s_cselect_b32 s90, 0, 3456
  s_lshl_b32 s76, s17, 7
  s_lshl_b32 s19, s18, 2
  s_add_u32 s19, s19, s12
  s_mul_i32 s73, s19, 276480
  s_add_u32 s73, s73, s76
  s_mul_i32 s69, s17, 83968
  s_add_u32 s69, s69, 2097152
  s_lshl_b32 s18, s18, 9
  s_add_u32 s82, s69, s18
  s_add_u32 s82, s82, 40960
  s_mul_i32 s19, s19, 5120
  s_add_u32 s69, s69, s19
  s_mov_b32 s72, 41984
  v_lshrrev_b32 v6, 3, v0
  v_mul_u32_u24 v6, 3456, v6
  v_and_b32 v7, 7, v0
  v_lshl_add_u32 v20, v7, 4, v6
  v_add_u32 v21, 27648, v20
  v_add_u32 v22, 27648, v21
  v_add_u32 v23, 27648, v22
  v_add_u32 v24, 27648, v23
  v_add_u32 v25, 27648, v24
  v_add_u32 v26, 27648, v25
  v_add_u32 v27, 27648, v26
  v_add_u32 v28, 27648, v27
  v_add_u32 v29, 27648, v28
  s_branch Lf_roled
Lf_not1:
  s_cmp_lt_u32 s16, 128
  s_cbranch_scc1 Lf_t2
  v_mov_b32 v21, 0
  v_mov_b32 v22, 0
  v_mov_b32 v23, 0
  v_mov_b32 v24, 0
  v_mov_b32 v25, 0
  v_mov_b32 v26, 0
  v_mov_b32 v27, 0
  v_mov_b32 v28, 0
  v_mov_b32 v29, 0
  s_branch Lf_roled
Lf_t2:
  s_mov_b32 s68, 2
  v_bfe_u32 v48, v0, 3, 2
  v_and_b32 v49, 7, v0
  s_cmp_lt_u32 s16, 108
  s_cbranch_scc0 Lf_wo
  s_sub_u32 s16, s16, 54
  s_mov_b32 s64, s50
  s_mov_b32 s65, s51
  s_mov_b32 s66, 2211840
  s_mov_b32 s67, 0x20000
  s_mov_b32 s72, 276480
  s_mul_i32 s17, s12, 108
  s_add_u32 s17, s17, s16
  s_mul_i32 s69, s17, 5120
  s_add_u32 s69, s69, 5242880
  s_lshl_b32 s16, s16, 5
  v_lshrrev_b32 v50, 1, v48
  v_lshlrev_b32 v50, 4, v50
  v_and_b32 v48, 1, v48
  v_lshl_add_u32 v50, v48, 2, v50
  v_add_u32 v50, s16, v50
  v_mov_b32 v51, 4
  s_branch Lf_t2go
Lf_wo:
  s_sub_u32 s16, s16, 108
  s_mov_b32 s64, s48
  s_mov_b32 s65, s49
  s_mov_b32 s66, 819200
  s_mov_b32 s67, 0x20000
  s_mov_b32 s72, 102400
  s_mul_i32 s17, s12, 40
  s_add_u32 s17, s17, s16
  s_mul_i32 s69, s17, 5120
  s_add_u32 s69, s69, 8388608
  s_mul_i32 s17, s16, 52
  s_lshr_b32 s17, s17, 8
  s_mul_i32 s18, s17, 5
  s_sub_u32 s18, s16, s18
  s_lshl_b32 s18, s18, 2
  s_mul_i32 s17, s17, 160
  v_add_u32 v48, s18, v48
  v_cmp_le_u32 vcc, 10, v48
  v_mov_b32 v50, 10
  v_mov_b32 v52, 80
  v_cndmask_b32 v50, 0, v50, vcc
  v_cndmask_b32 v52, 0, v52, vcc
  v_sub_u32 v48, v48, v50
  v_lshrrev_b32 v50, 1, v48
  v_mul_u32_u24 v50, 20, v50
  v_and_b32 v51, 1, v48
  v_lshl_add_u32 v50, v51, 2, v50
  v_subrev_u32 v53, 8, v48
  v_mul_u32_u24 v53, 40, v53
  v_add_u32 v53, 16, v53
  v_cmp_le_u32 vcc, 8, v48
  v_mov_b32 v51, 4
  v_mov_b32 v54, 16
  v_cndmask_b32 v50, v50, v53, vcc
  v_cndmask_b32 v51, v51, v54, vcc
  v_add_u32 v50, v50, v52
  v_add_u32 v50, s17, v50
Lf_t2go:
  v_cmp_le_u32 vcc, 4, v49
  v_add_u32 v50, v50, v49
  s_nop 0
  v_cndmask_b32 v51, 0, v51, vcc
  v_add_u32 v50, v50, v51
  v_mul_u32_u24 v50, 1280, v50
  s_mul_i32 s73, s12, 320
  v_add_u32 v6, 0, v0
  v_mul_u32_u24 v7, 6554, v6
  v_lshrrev_b32 v7, 16, v7
  v_mul_u32_u24 v48, 10, v7
  v_sub_u32 v52, v6, v48
  v_lshlrev_b32 v7, 2, v7
  ds_bpermute_b32 v20, v7, v50
  v_add_u32 v6, 64, v0
  v_mul_u32_u24 v7, 6554, v6
  v_lshrrev_b32 v7, 16, v7
  v_mul_u32_u24 v48, 10, v7
  v_sub_u32 v53, v6, v48
  v_lshlrev_b32 v7, 2, v7
  ds_bpermute_b32 v21, v7, v50
  v_add_u32 v6, 128, v0
  v_mul_u32_u24 v7, 6554, v6
  v_lshrrev_b32 v7, 16, v7
  v_mul_u32_u24 v48, 10, v7
  v_sub_u32 v54, v6, v48
  v_lshlrev_b32 v7, 2, v7
  ds_bpermute_b32 v22, v7, v50
  v_add_u32 v6, 192, v0
  v_mul_u32_u24 v7, 6554, v6
  v_lshrrev_b32 v7, 16, v7
  v_mul_u32_u24 v48, 10, v7
  v_sub_u32 v55, v6, v48
  v_lshlrev_b32 v7, 2, v7
  ds_bpermute_b32 v23, v7, v50
  v_add_u32 v6, 256, v0
  v_mul_u32_u24 v7, 6554, v6
  v_lshrrev_b32 v7, 16, v7
  v_mul_u32_u24 v48, 10, v7
  v_sub_u32 v56, v6, v48
  v_lshlrev_b32 v7, 2, v7
  ds_bpermute_b32 v24, v7, v50
  s_waitcnt lgkmcnt(4)
  v_lshl_add_u32 v20, v52, 4, v20
  v_add_u32 v25, 160, v20
  s_waitcnt lgkmcnt(3)
  v_lshl_add_u32 v21, v53, 4, v21
  v_add_u32 v26, 160, v21
  s_waitcnt lgkmcnt(2)
  v_lshl_add_u32 v22, v54, 4, v22
  v_add_u32 v27, 160, v22
  s_waitcnt lgkmcnt(1)
  v_lshl_add_u32 v23, v55, 4, v23
  v_add_u32 v28, 160, v23
  s_waitcnt lgkmcnt(0)
  v_lshl_add_u32 v24, v56, 4, v24
  v_add_u32 v29, 160, v24
Lf_roled:
  s_add_u32 s14, s4, 10559488
  s_addc_u32 s15, s5, 0
  s_load_dword s0, s[14:15], 0
  buffer_load_dwordx4 a[0:3], v20, s[64:67], s73 offen
  buffer_load_dwordx4 a[4:7], v21, s[64:67], s73 offen
  buffer_load_dwordx4 a[8:11], v22, s[64:67], s73 offen
  buffer_load_dwordx4 a[12:15], v23, s[64:67], s73 offen
  buffer_load_dwordx4 a[16:19], v24, s[64:67], s73 offen
  buffer_load_dwordx4 a[20:23], v25, s[64:67], s73 offen
  buffer_load_dwordx4 a[24:27], v26, s[64:67], s73 offen
  buffer_load_dwordx4 a[28:31], v27, s[64:67], s73 offen
  buffer_load_dwordx4 a[32:35], v28, s[64:67], s73 offen
  buffer_load_dwordx4 a[36:39], v29, s[64:67], s73 offen
  v_lshlrev_b32 v19, 1, v0
  buffer_load_ushort a124, v19, s[88:91], s76 offen
  v_and_b32 v9, 15, v0
  v_lshrrev_b32 v8, 4, v0
  v_mul_u32_u24 v10, 1280, v9
  v_lshl_add_u32 v10, v8, 3, v10
  v_add_u32 v6, 0, v0
  v_mul_u32_u24 v7, 6554, v6
  v_lshrrev_b32 v7, 16, v7
  v_mul_u32_u24 v232, 10, v7
  v_sub_u32 v6, v6, v232
  v_mul_u32_u24 v232, 1280, v7
  v_lshl_add_u32 v232, v6, 4, v232
  v_add_u32 v6, 64, v0
  v_mul_u32_u24 v7, 6554, v6
  v_lshrrev_b32 v7, 16, v7
  v_mul_u32_u24 v233, 10, v7
  v_sub_u32 v6, v6, v233
  v_mul_u32_u24 v233, 1280, v7
  v_lshl_add_u32 v233, v6, 4, v233
  v_subrev_u32 v233, 1024, v233
  v_add_u32 v6, 128, v0
  v_mul_u32_u24 v7, 6554, v6
  v_lshrrev_b32 v7, 16, v7
  v_mul_u32_u24 v234, 10, v7
  v_sub_u32 v6, v6, v234
  v_mul_u32_u24 v234, 1280, v7
  v_lshl_add_u32 v234, v6, 4, v234
  v_subrev_u32 v234, 2048, v234
  v_add_u32 v6, 192, v0
  v_mul_u32_u24 v7, 6554, v6
  v_lshrrev_b32 v7, 16, v7
  v_mul_u32_u24 v235, 10, v7
  v_sub_u32 v6, v6, v235
  v_mul_u32_u24 v235, 1280, v7
  v_lshl_add_u32 v235, v6, 4, v235
  v_subrev_u32 v235, 3072, v235
  v_add_u32 v6, 256, v0
  v_mul_u32_u24 v7, 6554, v6
  v_lshrrev_b32 v7, 16, v7
  v_mul_u32_u24 v236, 10, v7
  v_sub_u32 v6, v6, v236
  v_mul_u32_u24 v236, 1280, v7
  v_lshl_add_u32 v236, v6, 4, v236
  s_mul_i32 s77, s12, 40960
  s_add_u32 s77, s77, s81
  v_and_b32 v32, 3, v0
  v_bfe_u32 v6, v0, 4, 1
  v_lshl_add_u32 v32, v6, 2, v32
  v_bfe_u32 v33, v0, 2, 2
  v_lshrrev_b32 v34, 5, v0
  s_lshl_b32 s16, s12, 3
  s_sub_u32 s16, s16, 24
  v_lshl_add_u32 v6, v32, 2, s16
  s_cmp_lt_u32 s11, 2
  s_cselect_b32 s17, 20, 0
  v_cmp_gt_u32 vcc, s17, v6
  v_cmp_le_u32 s[18:19], 6, v32
  v_mov_b32 v49, 163832
  v_mov_b32 v35, 40
  v_lshlrev_b32 v6, 1, v6
  v_add_u32 v6, 134656, v6
  s_and_b64 vcc, vcc, s[18:19]
  s_mul_i32 s16, s12, 40
  s_add_u32 s16, s16, 83456
  v_cndmask_b32 v49, v49, v6, vcc
  v_cndmask_b32 v35, 0, v35, vcc
  v_cmp_gt_u32 vcc, 5, v32
  v_lshl_add_u32 v6, v32, 3, s16
  v_mov_b32 v7, 160
  v_mov_b32 v36, 51200
  v_cndmask_b32 v49, v49, v6, vcc
  v_cndmask_b32 v35, v35, v7, vcc
  v_cndmask_b32 v36, 0, v36, vcc
  v_lshlrev_b32 v48, 4, v35
  s_min_u32 s13, s10, 19
  s_mul_i32 s14, s13, 52
  s_lshr_b32 s14, s14, 8
  s_mul_i32 s16, s14, 5
  s_sub_u32 s16, s13, s16
  s_mul_i32 s14, s14, 80
  s_lshr_b32 s17, s16, 1
  s_lshl_b32 s17, s17, 5
  s_and_b32 s18, s16, 1
  s_lshl_b32 s18, s18, 3
  s_add_u32 s14, s14, s17
  s_add_u32 s14, s14, s18
  s_cmp_eq_u32 s16, 4
  s_cselect_b32 s16, 3, 2
  s_cselect_b32 s17, 4, 16
  v_lshlrev_b32 v6, s16, v34
  v_add3_u32 v6, v6, v33, s14
  v_mad_u32_u24 v37, v35, v6, v49
  v_mad_u32_u24 v38, v35, s17, v37
  v_mul_u32_u24 v6, 320, v35
  v_sub_u32 v6, v6, v36
  v_add_u32 v51, v6, v37
  v_add_u32 v52, v6, v38
  v_lshl_add_u32 v6, v34, 3, v33
  v_mad_u32_u24 v49, v35, v6, v49
  v_mad_u32_u24 v50, v35, 4, v49
  s_mul_i32 s16, s12, 5120
  s_add_u32 s16, s16, 134656
  v_lshl_add_u32 v7, v8, 3, v33
  v_mul_u32_u24 v7, 160, v7
  v_and_b32 v6, 3, v0
  v_lshl_add_u32 v7, v6, 3, v7
  v_add_u32 v53, s16, v7
  s_cmp_lt_u32 s11, 2
  s_cselect_b32 s16, 163840, s16
  v_add_u32 v56, s16, v1
  v_bfe_u32 v72, v0, 1, 1
  v_mul_u32_u24 v72, 1280, v72
  v_and_b32 v73, 1, v0
  v_lshl_add_u32 v72, v73, 4, v72
  v_add_u32 v72, s16, v72
  v_bfe_u32 v73, v0, 3, 2
  v_lshl_add_u32 v73, v34, 4, v73
  v_mul_u32_u24 v73, 160, v73
  v_add_u32 v57, v72, v73
  v_lshrrev_b32 v73, 3, v0
  v_mul_u32_u24 v73, 160, v73
  v_add_u32 v58, v72, v73
  v_bfe_u32 v73, v0, 2, 1
  v_lshlrev_b32 v73, 16, v73
  v_xor_b32 v72, 65536, v73
  v_add_u32 v59, v57, v72
  v_add_u32 v60, v58, v72
  v_add_u32 v57, v57, v73
  v_add_u32 v58, v58, v73
  buffer_load_dwordx4 v12, s[56:59], s80 offen lds
  s_add_u32 m0, m0, 1024
  v_xor_b32 v12, 64, v12
  buffer_load_dwordx4 v13, s[56:59], s80 offen lds
  s_add_u32 m0, m0, 1024
  v_xor_b32 v13, 64, v13
  buffer_load_dwordx4 v14, s[56:59], s80 offen lds
  s_add_u32 m0, m0, 1024
  v_xor_b32 v14, 64, v14
  buffer_load_dwordx4 v15, s[56:59], s80 offen lds
  s_add_u32 m0, m0, 1024
  v_xor_b32 v15, 64, v15
  buffer_load_dwordx4 v16, s[56:59], s80 offen lds
  s_add_u32 m0, m0, 1024
  v_xor_b32 v16, 64, v16
  s_add_u32 s80, s80, 5120
  buffer_load_dwordx4 v12, s[56:59], s80 offen lds
  s_add_u32 m0, m0, 1024
  v_xor_b32 v12, 192, v12
  buffer_load_dwordx4 v13, s[56:59], s80 offen lds
  s_add_u32 m0, m0, 1024
  v_xor_b32 v13, 192, v13
  buffer_load_dwordx4 v14, s[56:59], s80 offen lds
  s_add_u32 m0, m0, 1024
  v_xor_b32 v14, 192, v14
  buffer_load_dwordx4 v15, s[56:59], s80 offen lds
  s_add_u32 m0, m0, 1024
  v_xor_b32 v15, 192, v15
  buffer_load_dwordx4 v16, s[56:59], s80 offen lds
  s_add_u32 m0, m0, 1024
  v_xor_b32 v16, 192, v16
  s_add_u32 s80, s80, 5120
  buffer_load_dwordx4 v12, s[56:59], s80 offen lds
  s_add_u32 m0, m0, 1024
  v_xor_b32 v12, 64, v12
  buffer_load_dwordx4 v13, s[56:59], s80 offen lds
  s_add_u32 m0, m0, 1024
  v_xor_b32 v13, 64, v13
  buffer_load_dwordx4 v14, s[56:59], s80 offen lds
  s_add_u32 m0, m0, 1024
  v_xor_b32 v14, 64, v14
  buffer_load_dwordx4 v15, s[56:59], s80 offen lds
  s_add_u32 m0, m0, 1024
  v_xor_b32 v15, 64, v15
  buffer_load_dwordx4 v16, s[56:59], s80 offen lds
  s_add_u32 m0, m0, 1024
  v_xor_b32 v16, 64, v16
  s_add_u32 s80, s80, 5120
  buffer_load_dwordx4 v12, s[56:59], s80 offen lds
  s_add_u32 m0, m0, 1024
  s_nop 0
  buffer_load_dwordx4 v13, s[56:59], s80 offen lds
  s_add_u32 m0, m0, 1024
  s_nop 0
  buffer_load_dwordx4 v14, s[56:59], s80 offen lds
  s_add_u32 m0, m0, 1024
  s_nop 0
  buffer_load_dwordx4 v15, s[56:59], s80 offen lds
  s_add_u32 m0, m0, 1024
  s_nop 0
  buffer_load_dwordx4 v16, s[56:59], s80 offen lds
  s_add_u32 m0, m0, 1024
  s_add_u32 s80, s80, 5120
  s_cmp_lt_u32 s11, 2
  s_cbranch_scc0 Lf_nokv
  s_cmp_eq_u32 s11, 0
  s_cselect_b32 s60, s44, s46
  s_cselect_b32 s61, s45, s47
  s_mov_b32 s62, 25600
  s_lshl_b32 s14, s12, 10
  s_add_u32 m0, s14, 134656
  s_nop 0
  buffer_load_dwordx4 v1, s[60:63], s14 offen lds
  s_add_u32 s14, s14, 4096
  s_add_u32 m0, s14, 134656
  s_nop 0
  buffer_load_dwordx4 v1, s[60:63], s14 offen lds
  s_add_u32 s14, s14, 4096
  s_add_u32 m0, s14, 134656
  s_nop 0
  buffer_load_dwordx4 v1, s[60:63], s14 offen lds
  s_add_u32 s14, s14, 4096
  s_add_u32 m0, s14, 134656
  s_nop 0
  buffer_load_dwordx4 v1, s[60:63], s14 offen lds
  s_add_u32 s14, s14, 4096
  s_add_u32 m0, s14, 134656
  s_nop 0
  buffer_load_dwordx4 v1, s[60:63], s14 offen lds
  s_add_u32 s14, s14, 4096
  s_add_u32 m0, s14, 134656
  s_nop 0
  buffer_load_dwordx4 v1, s[60:63], s14 offen lds
  s_add_u32 s14, s14, 4096
  s_add_u32 m0, s14, 134656
  s_nop 0
  buffer_load_dwordx4 v1, s[60:63], s14 offen lds
  s_add_u32 s14, s14, 4096
Lf_nokv:
  s_lshl_b32 s13, s11, 2
  s_add_u32 s13, s13, s12
  s_lshl_b32 s13, s13, 2
  v_mov_b32 v3, 1073741824
  v_mov_b32 v7, s13
  v_cmp_eq_u32 vcc, 0, v0
  s_nop 1
  v_cndmask_b32 v3, v3, v7, vcc
  s_add_u32 s44, s4, 10485760
  s_addc_u32 s45, s5, 0
  s_mov_b32 s46, 71680
  s_mov_b32 s47, 0x20000
  s_getreg_b32 s9, hwreg(HW_REG_XCC_ID, 0, 4)
  s_add_u32 s9, s9, 1
  s_lshl_b32 s9, s9, 24
  s_waitcnt lgkmcnt(0)
  s_add_u32 s0, s0, 1
  s_add_u32 s9, s9, s0
  v_mov_b32 v7, s9
  s_lshl_b32 s13, s10, 10
  buffer_store_dword v7, v3, s[44:47], s13 offen offset:512 sc1
  s_lshr_b32 s13, s2, 3
  s_lshl_b32 s13, s13, 2
  s_add_u32 s13, s13, s12
  s_mul_i32 s13, s13, 6400
  v_min_u32 v6, 240, v1
  v_add_u32 v6, 6144, v6
  buffer_load_dwordx4 a[88:91], v1, s[24:27], s13 offen offset:0
  buffer_load_dwordx4 a[88:91], v1, s[24:27], s13 offen offset:1024
  buffer_load_dwordx4 a[88:91], v1, s[24:27], s13 offen offset:2048
  buffer_load_dwordx4 a[88:91], v1, s[24:27], s13 offen offset:3072
  buffer_load_dwordx4 a[88:91], v2, s[24:27], s13 offen offset:0
  buffer_load_dwordx4 a[88:91], v2, s[24:27], s13 offen offset:1024
  buffer_load_dwordx4 a[88:91], v6, s[24:27], s13 offen offset:0
  buffer_load_dwordx2 v[240:241], v10, s[56:59], s81 offen offset:0
  buffer_load_dwordx2 v[242:243], v10, s[56:59], s81 offen offset:32
  buffer_load_dwordx2 v[244:245], v10, s[56:59], s81 offen offset:64
  buffer_load_dwordx2 v[246:247], v10, s[56:59], s81 offen offset:96
  buffer_load_dwordx2 v[248:249], v10, s[56:59], s81 offen offset:128
  s_mov_b32 s74, 0x3f803f80
  s_cmp_eq_u32 s68, 1
  s_cselect_b32 s82, s82, 1073741824
  s_cbranch_scc1 Lf_w1
  s_waitcnt vmcnt(43)
  ds_write_b128 v56, a[0:3] offset:0
  s_waitcnt vmcnt(42)
  ds_write_b128 v56, a[4:7] offset:1024
  s_waitcnt vmcnt(41)
  ds_write_b128 v56, a[8:11] offset:2048
  s_waitcnt vmcnt(40)
  ds_write_b128 v56, a[12:15] offset:3072
  s_waitcnt vmcnt(39)
  ds_write_b128 v56, a[16:19] offset:4096
  ds_read_b64_tr_b16 a[40:41], v53 offset:0
  ds_read_b64_tr_b16 a[42:43], v53 offset:640
  ds_read_b64_tr_b16 a[44:45], v53 offset:32
  ds_read_b64_tr_b16 a[46:47], v53 offset:672
  ds_read_b64_tr_b16 a[48:49], v53 offset:64
  ds_read_b64_tr_b16 a[50:51], v53 offset:704
  ds_read_b64_tr_b16 a[52:53], v53 offset:96
  ds_read_b64_tr_b16 a[54:55], v53 offset:736
  ds_read_b64_tr_b16 a[56:57], v53 offset:128
  ds_read_b64_tr_b16 a[58:59], v53 offset:768
  s_waitcnt vmcnt(38)
  ds_write_b128 v56, a[20:23] offset:0
  s_waitcnt vmcnt(37)
  ds_write_b128 v56, a[24:27] offset:1024
  s_waitcnt vmcnt(36)
  ds_write_b128 v56, a[28:31] offset:2048
  s_waitcnt vmcnt(35)
  ds_write_b128 v56, a[32:35] offset:3072
  s_waitcnt vmcnt(34)
  ds_write_b128 v56, a[36:39] offset:4096
  ds_read_b64_tr_b16 a[60:61], v53 offset:0
  ds_read_b64_tr_b16 a[62:63], v53 offset:640
  ds_read_b64_tr_b16 a[64:65], v53 offset:32
  ds_read_b64_tr_b16 a[66:67], v53 offset:672
  ds_read_b64_tr_b16 a[68:69], v53 offset:64
  ds_read_b64_tr_b16 a[70:71], v53 offset:704
  ds_read_b64_tr_b16 a[72:73], v53 offset:96
  ds_read_b64_tr_b16 a[74:75], v53 offset:736
  ds_read_b64_tr_b16 a[76:77], v53 offset:128
  ds_read_b64_tr_b16 a[78:79], v53 offset:768
  s_branch Lf_fin
Lf_w1:
  s_waitcnt vmcnt(43)
  ds_write_b128 v57, a[0:3] offset:0
  s_waitcnt vmcnt(42)
  ds_write_b128 v57, a[4:7] offset:32
  s_waitcnt vmcnt(41)
  ds_write_b128 v57, a[8:11] offset:640
  s_waitcnt vmcnt(40)
  ds_write_b128 v57, a[12:15] offset:672
  s_waitcnt vmcnt(39)
  ds_write_b128 v57, a[16:19] offset:64
  s_waitcnt vmcnt(38)
  ds_write_b128 v57, a[20:23] offset:96
  s_waitcnt vmcnt(37)
  ds_write_b128 v57, a[24:27] offset:704
  s_waitcnt vmcnt(36)
  ds_write_b128 v57, a[28:31] offset:736
  s_waitcnt vmcnt(35)
  ds_write_b128 v58, a[32:35] offset:128
  s_waitcnt vmcnt(34)
  ds_write_b128 v58, a[36:39] offset:2688
  ds_read_b64_tr_b16 a[40:41], v53 offset:0
  ds_read_b64_tr_b16 a[42:43], v53 offset:640
  ds_read_b64_tr_b16 a[44:45], v53 offset:32
  ds_read_b64_tr_b16 a[46:47], v53 offset:672
  ds_read_b64_tr_b16 a[48:49], v53 offset:64
  ds_read_b64_tr_b16 a[50:51], v53 offset:704
  ds_read_b64_tr_b16 a[52:53], v53 offset:96
  ds_read_b64_tr_b16 a[54:55], v53 offset:736
  ds_read_b64_tr_b16 a[56:57], v53 offset:128
  ds_read_b64_tr_b16 a[58:59], v53 offset:768
  ds_write_b128 v59, a[0:3] offset:0
  ds_write_b128 v59, a[4:7] offset:32
  ds_write_b128 v59, a[8:11] offset:640
  ds_write_b128 v59, a[12:15] offset:672
  ds_write_b128 v59, a[16:19] offset:64
  ds_write_b128 v59, a[20:23] offset:96
  ds_write_b128 v59, a[24:27] offset:704
  ds_write_b128 v59, a[28:31] offset:736
  ds_write_b128 v60, a[32:35] offset:128
  ds_write_b128 v60, a[36:39] offset:2688
  ds_read_b64_tr_b16 a[60:61], v53 offset:0
  ds_read_b64_tr_b16 a[62:63], v53 offset:640
  ds_read_b64_tr_b16 a[64:65], v53 offset:32
  ds_read_b64_tr_b16 a[66:67], v53 offset:672
  ds_read_b64_tr_b16 a[68:69], v53 offset:64
  ds_read_b64_tr_b16 a[70:71], v53 offset:704
  ds_read_b64_tr_b16 a[72:73], v53 offset:96
  ds_read_b64_tr_b16 a[74:75], v53 offset:736
  ds_read_b64_tr_b16 a[76:77], v53 offset:128
  ds_read_b64_tr_b16 a[78:79], v53 offset:768
  v_mov_b32 v100, 0
  s_waitcnt lgkmcnt(15)
  v_accvgpr_read_b32 v104, a40
  v_accvgpr_read_b32 v105, a41
  v_accvgpr_read_b32 v106, a42
  v_accvgpr_read_b32 v107, a43
  v_dot2_f32_bf16 v100, v104, s74, v100
  v_dot2_f32_bf16 v100, v105, s74, v100
  v_dot2_f32_bf16 v100, v106, s74, v100
  v_dot2_f32_bf16 v100, v107, s74, v100
  v_accvgpr_read_b32 v104, a44
  v_accvgpr_read_b32 v105, a45
  v_accvgpr_read_b32 v106, a46
  v_accvgpr_read_b32 v107, a47
  v_dot2_f32_bf16 v100, v104, s74, v100
  v_dot2_f32_bf16 v100, v105, s74, v100
  v_dot2_f32_bf16 v100, v106, s74, v100
  v_dot2_f32_bf16 v100, v107, s74, v100
  v_accvgpr_read_b32 v104, a48
  v_accvgpr_read_b32 v105, a49
  v_accvgpr_read_b32 v106, a50
  v_accvgpr_read_b32 v107, a51
  v_dot2_f32_bf16 v100, v104, s74, v100
  v_dot2_f32_bf16 v100, v105, s74, v100
  v_dot2_f32_bf16 v100, v106, s74, v100
  v_dot2_f32_bf16 v100, v107, s74, v100
  v_accvgpr_read_b32 v104, a52
  v_accvgpr_read_b32 v105, a53
  v_accvgpr_read_b32 v106, a54
  v_accvgpr_read_b32 v107, a55
  v_dot2_f32_bf16 v100, v104, s74, v100
  v_dot2_f32_bf16 v100, v105, s74, v100
  v_dot2_f32_bf16 v100, v106, s74, v100
  v_dot2_f32_bf16 v100, v107, s74, v100
  v_accvgpr_read_b32 v104, a56
  v_accvgpr_read_b32 v105, a57
  v_accvgpr_read_b32 v106, a58
  v_accvgpr_read_b32 v107, a59
  v_dot2_f32_bf16 v100, v104, s74, v100
  v_dot2_f32_bf16 v100, v105, s74, v100
  v_dot2_f32_bf16 v100, v106, s74, v100
  v_dot2_f32_bf16 v100, v107, s74, v100
  v_mov_b32 v101, 0
  s_waitcnt lgkmcnt(9)
  v_accvgpr_read_b32 v104, a60
  v_accvgpr_read_b32 v105, a61
  s_waitcnt lgkmcnt(8)
  v_accvgpr_read_b32 v106, a62
  v_accvgpr_read_b32 v107, a63
  v_dot2_f32_bf16 v101, v104, s74, v101
  v_dot2_f32_bf16 v101, v105, s74, v101
  v_dot2_f32_bf16 v101, v106, s74, v101
  v_dot2_f32_bf16 v101, v107, s74, v101
  s_waitcnt lgkmcnt(7)
  v_accvgpr_read_b32 v104, a64
  v_accvgpr_read_b32 v105, a65
  s_waitcnt lgkmcnt(6)
  v_accvgpr_read_b32 v106, a66
  v_accvgpr_read_b32 v107, a67
  v_dot2_f32_bf16 v101, v104, s74, v101
  v_dot2_f32_bf16 v101, v105, s74, v101
  v_dot2_f32_bf16 v101, v106, s74, v101
  v_dot2_f32_bf16 v101, v107, s74, v101
  s_waitcnt lgkmcnt(5)
  v_accvgpr_read_b32 v104, a68
  v_accvgpr_read_b32 v105, a69
  s_waitcnt lgkmcnt(4)
  v_accvgpr_read_b32 v106, a70
  v_accvgpr_read_b32 v107, a71
  v_dot2_f32_bf16 v101, v104, s74, v101
  v_dot2_f32_bf16 v101, v105, s74, v101
  v_dot2_f32_bf16 v101, v106, s74, v101
  v_dot2_f32_bf16 v101, v107, s74, v101
  s_waitcnt lgkmcnt(3)
  v_accvgpr_read_b32 v104, a72
  v_accvgpr_read_b32 v105, a73
  s_waitcnt lgkmcnt(2)
  v_accvgpr_read_b32 v106, a74
  v_accvgpr_read_b32 v107, a75
  v_dot2_f32_bf16 v101, v104, s74, v101
  v_dot2_f32_bf16 v101, v105, s74, v101
  v_dot2_f32_bf16 v101, v106, s74, v101
  v_dot2_f32_bf16 v101, v107, s74, v101
  s_waitcnt lgkmcnt(1)
  v_accvgpr_read_b32 v104, a76
  v_accvgpr_read_b32 v105, a77
  s_waitcnt lgkmcnt(0)
  v_accvgpr_read_b32 v106, a78
  v_accvgpr_read_b32 v107, a79
  v_dot2_f32_bf16 v101, v104, s74, v101
  v_dot2_f32_bf16 v101, v105, s74, v101
  v_dot2_f32_bf16 v101, v106, s74, v101
  v_dot2_f32_bf16 v101, v107, s74, v101
  s_nop 2
  v_permlane32_swap_b32 v100, v101
  v_add_f32 v100, v100, v101
  s_lshl_b32 s13, s12, 8
  s_add_u32 s13, s13, 155136
  v_lshlrev_b32 v102, 2, v0
  v_add_u32 v101, s13, v102
  v_add_u32 v102, 155136, v102
  ds_write_b32 v101, v100
  s_waitcnt lgkmcnt(0)
  s_barrier
  ds_read_b32 v104, v102 offset:0
  ds_read_b32 v105, v102 offset:256
  ds_read_b32 v106, v102 offset:512
  ds_read_b32 v107, v102 offset:768
  s_waitcnt lgkmcnt(2)
  v_add_f32 v104, v104, v105
  s_waitcnt lgkmcnt(0)
  v_add_f32 v106, v106, v107
  v_add_f32 v104, v104, v106
  v_cvt_pk_bf16_f32 v108, v104, v104
  v_and_b32 v105, 0xffff0000, v108
  v_sub_f32 v105, v104, v105
  v_cvt_pk_bf16_f32 v105, v105, 0
  s_waitcnt vmcnt(33)
  v_accvgpr_read_b32 v110, a124
  v_lshl_or_b32 v109, v110, 16, v105
  s_cmp_eq_u32 s12, 0
  s_cselect_b32 s82, s82, 1073741824
  v_accvgpr_write_b32 a120, v108
  v_accvgpr_write_b32 a121, v109
  v_accvgpr_write_b32 a122, v110
  v_accvgpr_write_b32 a123, 0
Lf_fin:
  s_waitcnt lgkmcnt(0)
  v_mul_u32_u24 v56, 41472, v34
  v_add_u32 v56, v56, v1
  s_mov_b32 s74, 0x3f803f80
  v_mov_b32 v30, 0
  v_mov_b32 v31, 0
  s_mul_i32 s13, s12, 20480
  v_xor_b32 v6, v8, v9
  v_lshlrev_b32 v6, 4, v6
  v_mul_u32_u24 v61, 1280, v9
  v_add3_u32 v61, v61, v6, s13
  v_xor_b32 v62, 64, v61
  v_xor_b32 v63, 128, v61
  v_xor_b32 v39, 192, v61
  s_waitcnt vmcnt(13)
  ds_read_b128 v[76:79], v61 offset:0
  ds_read_b128 v[80:83], v62 offset:0
  ds_read_b128 v[84:87], v63 offset:0
  ds_read_b128 v[88:91], v39 offset:0
  s_waitcnt lgkmcnt(3)
  v_dot2_f32_bf16 v30, v76, s74, v30
  v_dot2_f32_bf16 v31, v76, v76, v31
  v_dot2_f32_bf16 v30, v77, s74, v30
  v_dot2_f32_bf16 v31, v77, v77, v31
  v_dot2_f32_bf16 v30, v78, s74, v30
  v_dot2_f32_bf16 v31, v78, v78, v31
  v_dot2_f32_bf16 v30, v79, s74, v30
  v_dot2_f32_bf16 v31, v79, v79, v31
  ds_read_b128 v[76:79], v61 offset:256
  s_waitcnt lgkmcnt(3)
  v_dot2_f32_bf16 v30, v80, s74, v30
  v_dot2_f32_bf16 v31, v80, v80, v31
  v_dot2_f32_bf16 v30, v81, s74, v30
  v_dot2_f32_bf16 v31, v81, v81, v31
  v_dot2_f32_bf16 v30, v82, s74, v30
  v_dot2_f32_bf16 v31, v82, v82, v31
  v_dot2_f32_bf16 v30, v83, s74, v30
  v_dot2_f32_bf16 v31, v83, v83, v31
  ds_read_b128 v[80:83], v62 offset:256
  s_waitcnt lgkmcnt(3)
  v_dot2_f32_bf16 v30, v84, s74, v30
  v_dot2_f32_bf16 v31, v84, v84, v31
  v_dot2_f32_bf16 v30, v85, s74, v30
  v_dot2_f32_bf16 v31, v85, v85, v31
  v_dot2_f32_bf16 v30, v86, s74, v30
  v_dot2_f32_bf16 v31, v86, v86, v31
  v_dot2_f32_bf16 v30, v87, s74, v30
  v_dot2_f32_bf16 v31, v87, v87, v31
  ds_read_b128 v[84:87], v63 offset:256
  s_waitcnt lgkmcnt(3)
  v_dot2_f32_bf16 v30, v88, s74, v30
  v_dot2_f32_bf16 v31, v88, v88, v31
  v_dot2_f32_bf16 v30, v89, s74, v30
  v_dot2_f32_bf16 v31, v89, v89, v31
  v_dot2_f32_bf16 v30, v90, s74, v30
  v_dot2_f32_bf16 v31, v90, v90, v31
  v_dot2_f32_bf16 v30, v91, s74, v30
  v_dot2_f32_bf16 v31, v91, v91, v31
  ds_read_b128 v[88:91], v39 offset:256
  s_waitcnt lgkmcnt(3)
  v_dot2_f32_bf16 v30, v76, s74, v30
  v_dot2_f32_bf16 v31, v76, v76, v31
  v_dot2_f32_bf16 v30, v77, s74, v30
  v_dot2_f32_bf16 v31, v77, v77, v31
  v_dot2_f32_bf16 v30, v78, s74, v30
  v_dot2_f32_bf16 v31, v78, v78, v31
  v_dot2_f32_bf16 v30, v79, s74, v30
  v_dot2_f32_bf16 v31, v79, v79, v31
  ds_read_b128 v[76:79], v61 offset:512
  s_waitcnt lgkmcnt(3)
  v_dot2_f32_bf16 v30, v80, s74, v30
  v_dot2_f32_bf16 v31, v80, v80, v31
  v_dot2_f32_bf16 v30, v81, s74, v30
  v_dot2_f32_bf16 v31, v81, v81, v31
  v_dot2_f32_bf16 v30, v82, s74, v30
  v_dot2_f32_bf16 v31, v82, v82, v31
  v_dot2_f32_bf16 v30, v83, s74, v30
  v_dot2_f32_bf16 v31, v83, v83, v31
  ds_read_b128 v[80:83], v62 offset:512
  s_waitcnt lgkmcnt(3)
  v_dot2_f32_bf16 v30, v84, s74, v30
  v_dot2_f32_bf16 v31, v84, v84, v31
  v_dot2_f32_bf16 v30, v85, s74, v30
  v_dot2_f32_bf16 v31, v85, v85, v31
  v_dot2_f32_bf16 v30, v86, s74, v30
  v_dot2_f32_bf16 v31, v86, v86, v31
  v_dot2_f32_bf16 v30, v87, s74, v30
  v_dot2_f32_bf16 v31, v87, v87, v31
  ds_read_b128 v[84:87], v63 offset:512
  s_waitcnt lgkmcnt(3)
  v_dot2_f32_bf16 v30, v88, s74, v30
  v_dot2_f32_bf16 v31, v88, v88, v31
  v_dot2_f32_bf16 v30, v89, s74, v30
  v_dot2_f32_bf16 v31, v89, v89, v31
  v_dot2_f32_bf16 v30, v90, s74, v30
  v_dot2_f32_bf16 v31, v90, v90, v31
  v_dot2_f32_bf16 v30, v91, s74, v30
  v_dot2_f32_bf16 v31, v91, v91, v31
  ds_read_b128 v[88:91], v39 offset:512
  s_waitcnt lgkmcnt(3)
  v_dot2_f32_bf16 v30, v76, s74, v30
  v_dot2_f32_bf16 v31, v76, v76, v31
  v_dot2_f32_bf16 v30, v77, s74, v30
  v_dot2_f32_bf16 v31, v77, v77, v31
  v_dot2_f32_bf16 v30, v78, s74, v30
  v_dot2_f32_bf16 v31, v78, v78, v31
  v_dot2_f32_bf16 v30, v79, s74, v30
  v_dot2_f32_bf16 v31, v79, v79, v31
  ds_read_b128 v[76:79], v61 offset:768
  s_waitcnt lgkmcnt(3)
  v_dot2_f32_bf16 v30, v80, s74, v30
  v_dot2_f32_bf16 v31, v80, v80, v31
  v_dot2_f32_bf16 v30, v81, s74, v30
  v_dot2_f32_bf16 v31, v81, v81, v31
  v_dot2_f32_bf16 v30, v82, s74, v30
  v_dot2_f32_bf16 v31, v82, v82, v31
  v_dot2_f32_bf16 v30, v83, s74, v30
  v_dot2_f32_bf16 v31, v83, v83, v31
  ds_read_b128 v[80:83], v62 offset:768
  s_waitcnt lgkmcnt(3)
  v_dot2_f32_bf16 v30, v84, s74, v30
  v_dot2_f32_bf16 v31, v84, v84, v31
  v_dot2_f32_bf16 v30, v85, s74, v30
  v_dot2_f32_bf16 v31, v85, v85, v31
  v_dot2_f32_bf16 v30, v86, s74, v30
  v_dot2_f32_bf16 v31, v86, v86, v31
  v_dot2_f32_bf16 v30, v87, s74, v30
  v_dot2_f32_bf16 v31, v87, v87, v31
  ds_read_b128 v[84:87], v63 offset:768
  s_waitcnt lgkmcnt(3)
  v_dot2_f32_bf16 v30, v88, s74, v30
  v_dot2_f32_bf16 v31, v88, v88, v31
  v_dot2_f32_bf16 v30, v89, s74, v30
  v_dot2_f32_bf16 v31, v89, v89, v31
  v_dot2_f32_bf16 v30, v90, s74, v30
  v_dot2_f32_bf16 v31, v90, v90, v31
  v_dot2_f32_bf16 v30, v91, s74, v30
  v_dot2_f32_bf16 v31, v91, v91, v31
  ds_read_b128 v[88:91], v39 offset:768
  s_waitcnt lgkmcnt(3)
  v_dot2_f32_bf16 v30, v76, s74, v30
  v_dot2_f32_bf16 v31, v76, v76, v31
  v_dot2_f32_bf16 v30, v77, s74, v30
  v_dot2_f32_bf16 v31, v77, v77, v31
  v_dot2_f32_bf16 v30, v78, s74, v30
  v_dot2_f32_bf16 v31, v78, v78, v31
  v_dot2_f32_bf16 v30, v79, s74, v30
  v_dot2_f32_bf16 v31, v79, v79, v31
  ds_read_b128 v[76:79], v61 offset:1024
  s_waitcnt lgkmcnt(3)
  v_dot2_f32_bf16 v30, v80, s74, v30
  v_dot2_f32_bf16 v31, v80, v80, v31
  v_dot2_f32_bf16 v30, v81, s74, v30
  v_dot2_f32_bf16 v31, v81, v81, v31
  v_dot2_f32_bf16 v30, v82, s74, v30
  v_dot2_f32_bf16 v31, v82, v82, v31
  v_dot2_f32_bf16 v30, v83, s74, v30
  v_dot2_f32_bf16 v31, v83, v83, v31
  ds_read_b128 v[80:83], v62 offset:1024
  s_waitcnt lgkmcnt(3)
  v_dot2_f32_bf16 v30, v84, s74, v30
  v_dot2_f32_bf16 v31, v84, v84, v31
  v_dot2_f32_bf16 v30, v85, s74, v30
  v_dot2_f32_bf16 v31, v85, v85, v31
  v_dot2_f32_bf16 v30, v86, s74, v30
  v_dot2_f32_bf16 v31, v86, v86, v31
  v_dot2_f32_bf16 v30, v87, s74, v30
  v_dot2_f32_bf16 v31, v87, v87, v31
  ds_read_b128 v[84:87], v63 offset:1024
  s_waitcnt lgkmcnt(3)
  v_dot2_f32_bf16 v30, v88, s74, v30
  v_dot2_f32_bf16 v31, v88, v88, v31
  v_dot2_f32_bf16 v30, v89, s74, v30
  v_dot2_f32_bf16 v31, v89, v89, v31
  v_dot2_f32_bf16 v30, v90, s74, v30
  v_dot2_f32_bf16 v31, v90, v90, v31
  v_dot2_f32_bf16 v30, v91, s74, v30
  v_dot2_f32_bf16 v31, v91, v91, v31
  ds_read_b128 v[88:91], v39 offset:1024
  s_waitcnt lgkmcnt(3)
  v_dot2_f32_bf16 v30, v76, s74, v30
  v_dot2_f32_bf16 v31, v76, v76, v31
  v_dot2_f32_bf16 v30, v77, s74, v30
  v_dot2_f32_bf16 v31, v77, v77, v31
  v_dot2_f32_bf16 v30, v78, s74, v30
  v_dot2_f32_bf16 v31, v78, v78, v31
  v_dot2_f32_bf16 v30, v79, s74, v30
  v_dot2_f32_bf16 v31, v79, v79, v31
  s_waitcnt lgkmcnt(2)
  v_dot2_f32_bf16 v30, v80, s74, v30
  v_dot2_f32_bf16 v31, v80, v80, v31
  v_dot2_f32_bf16 v30, v81, s74, v30
  v_dot2_f32_bf16 v31, v81, v81, v31
  v_dot2_f32_bf16 v30, v82, s74, v30
  v_dot2_f32_bf16 v31, v82, v82, v31
  v_dot2_f32_bf16 v30, v83, s74, v30
  v_dot2_f32_bf16 v31, v83, v83, v31
  s_waitcnt lgkmcnt(1)
  v_dot2_f32_bf16 v30, v84, s74, v30
  v_dot2_f32_bf16 v31, v84, v84, v31
  v_dot2_f32_bf16 v30, v85, s74, v30
  v_dot2_f32_bf16 v31, v85, v85, v31
  v_dot2_f32_bf16 v30, v86, s74, v30
  v_dot2_f32_bf16 v31, v86, v86, v31
  v_dot2_f32_bf16 v30, v87, s74, v30
  v_dot2_f32_bf16 v31, v87, v87, v31
  s_waitcnt lgkmcnt(0)
  v_dot2_f32_bf16 v30, v88, s74, v30
  v_dot2_f32_bf16 v31, v88, v88, v31
  v_dot2_f32_bf16 v30, v89, s74, v30
  v_dot2_f32_bf16 v31, v89, v89, v31
  v_dot2_f32_bf16 v30, v90, s74, v30
  v_dot2_f32_bf16 v31, v90, v90, v31
  v_dot2_f32_bf16 v30, v91, s74, v30
  v_dot2_f32_bf16 v31, v91, v91, v31
  s_nop 1
  v_mov_b32 v84, v30
  s_nop 1
  v_permlane16_swap_b32 v30, v84
  v_add_f32 v30, v30, v84
  v_mov_b32 v84, v30
  s_nop 1
  v_permlane32_swap_b32 v30, v84
  v_add_f32 v30, v30, v84
  v_mov_b32 v84, v31
  s_nop 1
  v_permlane16_swap_b32 v31, v84
  v_add_f32 v31, v31, v84
  v_mov_b32 v84, v31
  s_nop 1
  v_permlane32_swap_b32 v31, v84
  v_add_f32 v31, v31, v84
  v_mul_f32 v30, 0x3acccccd, v30
  v_mul_f32 v31, 0x3acccccd, v31
  v_fma_f32 v31, -v30, v30, v31
  v_max_f32 v31, 0, v31
  v_add_f32 v31, 0x3727c5ac, v31
  v_rsq_f32 v84, v31
  v_sub_f32 v30, 0, v30
  v_mul_f32 v31, v31, v84
  v_cvt_pk_bf16_f32 v89, v30, v31
  v_lshlrev_b32 v85, 16, v89
  v_sub_f32 v30, v30, v85
  v_cvt_pk_bf16_f32 v88, v85, v30
  v_and_b32 v85, 0xffff0000, v89
  v_sub_f32 v31, v31, v85
  v_cvt_pk_bf16_f32 v90, v31, 0
  v_mov_b32 v91, 0
  s_lshl_b32 s13, s12, 4
  v_and_b32 v85, 15, v0
  v_add_u32 v85, s13, v85
  v_lshlrev_b32 v30, 4, v85
  v_lshlrev_b32 v85, 2, v85
  v_add_u32 v30, 81920, v30
  v_add_u32 v85, 82944, v85
  ds_write_b128 v30, v[88:91]
  ds_write_b32 v85, v84
  v_mov_b32 v6, 0
  v_mov_b32 v7, 0
  v_mov_b32 v72, 163832
  s_mul_i32 s79, s12, 5120
  s_add_u32 m0, s79, 83456
  s_add_u32 s79, s77, 0
  buffer_load_dwordx4 v232, s[24:27], s79 offen offset:0 lds
  buffer_load_dwordx4 v233, s[24:27], s79 offen offset:1024 lds
  buffer_load_dwordx4 v234, s[24:27], s79 offen offset:2048 lds
  buffer_load_dwordx4 v235, s[24:27], s79 offen offset:3072 lds
  s_add_u32 m0, m0, 4096
  s_nop 0
  buffer_load_dwordx4 v236, s[24:27], s79 offen offset:0 lds
  s_add_u32 s79, s79, 163840
  s_add_u32 m0, m0, 16384
  s_nop 0
  buffer_load_dwordx4 v232, s[24:27], s79 offen offset:0 lds
  buffer_load_dwordx4 v233, s[24:27], s79 offen offset:1024 lds
  buffer_load_dwordx4 v234, s[24:27], s79 offen offset:2048 lds
  buffer_load_dwordx4 v235, s[24:27], s79 offen offset:3072 lds
  s_add_u32 m0, m0, 4096
  s_nop 0
  buffer_load_dwordx4 v236, s[24:27], s79 offen offset:0 lds
  s_add_u32 s79, s79, 163840
  s_add_u32 m0, m0, 16384
  s_cmp_lt_u32 s12, 2
  s_cselect_b32 s79, s79, 1073741824
  s_cselect_b32 m0, m0, 163840
  s_nop 0
  buffer_load_dwordx4 v232, s[24:27], s79 offen offset:0 lds
  buffer_load_dwordx4 v233, s[24:27], s79 offen offset:1024 lds
  buffer_load_dwordx4 v234, s[24:27], s79 offen offset:2048 lds
  buffer_load_dwordx4 v235, s[24:27], s79 offen offset:3072 lds
  s_add_u32 m0, m0, 4096
  s_nop 0
  buffer_load_dwordx4 v236, s[24:27], s79 offen offset:0 lds
  s_mul_i32 s70, s8, 2560
  s_lshl_b32 s71, s8, 7
  s_add_u32 s71, s71, 2621440
  v_and_b32 v18, 15, v0
  v_lshrrev_b32 v6, 5, v0
  v_lshlrev_b32 v17, 8, v6
  v_lshl_add_u32 v17, v18, 4, v17
  v_bfe_u32 v6, v0, 4, 1
  v_lshl_add_u32 v17, v6, 3, v17
  v_lshrrev_b32 v6, 4, v0
  v_lshlrev_b32 v18, 3, v18
  v_lshl_add_u32 v18, v6, 30, v18
  s_add_u32 s56, s4, 16777216
  s_addc_u32 s57, s5, 0
  s_mov_b32 s58, 3145728
  s_mov_b32 s59, 0x20000
  s_waitcnt vmcnt(18)
  buffer_store_dwordx4 v[240:243], v1, s[56:59], s70 offen
  s_waitcnt vmcnt(17)
  buffer_store_dwordx4 v[244:247], v1, s[56:59], s70 offen offset:1024
  s_waitcnt vmcnt(17)
  buffer_store_dwordx2 v[248:249], v17, s[56:59], s70 offen offset:2048
  v_and_b32 v6, 31, v0
  v_xor_b32 v7, v34, v9
  v_lshlrev_b32 v7, 4, v7
  v_mul_u32_u24 v6, 1280, v6
  v_add_u32 v84, v6, v7
  v_xor_b32 v85, 32, v84
  v_xor_b32 v86, 64, v84
  v_xor_b32 v87, 96, v84
  v_xor_b32 v88, 128, v84
  v_xor_b32 v89, 160, v84
  v_xor_b32 v90, 192, v84
  v_xor_b32 v91, 224, v84
  v_mov_b32 v6, 0
  v_mov_b32 v7, 0
  s_waitcnt vmcnt(3)
  ds_write_b64 v72, v[6:7]
  s_waitcnt lgkmcnt(0)
  s_barrier
  v_mov_b32 v54, 0
  v_mov_b32 v55, 0
  ds_read_b64_tr_b16 a[80:81], v37
  ds_read_b64_tr_b16 a[82:83], v38
  ds_read_b64_tr_b16 v[92:93], v49
  v_add_u32 v72, v48, v49
  ds_read_b64_tr_b16 v[94:95], v50
  v_add_u32 v73, v48, v50
  ds_read_b64_tr_b16 v[96:97], v72
  v_add_u32 v74, v48, v72
  ds_read_b64_tr_b16 v[98:99], v73
  v_add_u32 v75, v48, v73
  ds_read_b64_tr_b16 v[100:101], v74
  v_add_u32 v76, v48, v74
  ds_read_b64_tr_b16 v[102:103], v75
  v_add_u32 v77, v48, v75
  ds_read_b64_tr_b16 v[104:105], v76
  v_add_u32 v78, v48, v76
  ds_read_b64_tr_b16 v[106:107], v77
  v_add_u32 v79, v48, v77
  ds_read_b64_tr_b16 v[108:109], v78
  v_add_u32 v80, v48, v78
  ds_read_b64_tr_b16 v[110:111], v79
  v_add_u32 v81, v48, v79
  ds_read_b64_tr_b16 v[112:113], v80
  v_add_u32 v82, v48, v80
  ds_read_b64_tr_b16 v[114:115], v81
  v_add_u32 v83, v48, v81
  s_waitcnt lgkmcnt(11)
  v_dot2_f32_bf16 v54, v92, s74, v54
  v_dot2_f32_bf16 v55, v93, s74, v55
  s_waitcnt lgkmcnt(10)
  v_dot2_f32_bf16 v54, v94, s74, v54
  v_dot2_f32_bf16 v55, v95, s74, v55
  ds_read_b64_tr_b16 v[116:117], v82
  v_add_u32 v72, v48, v82
  ds_read_b64_tr_b16 v[118:119], v83
  v_add_u32 v73, v48, v83
  s_waitcnt lgkmcnt(11)
  v_dot2_f32_bf16 v54, v96, s74, v54
  v_dot2_f32_bf16 v55, v97, s74, v55
  s_waitcnt lgkmcnt(10)
  v_dot2_f32_bf16 v54, v98, s74, v54
  v_dot2_f32_bf16 v55, v99, s74, v55
  ds_read_b64_tr_b16 v[120:121], v72
  v_add_u32 v74, v48, v72
  ds_read_b64_tr_b16 v[122:123], v73
  v_add_u32 v75, v48, v73
  s_waitcnt lgkmcnt(11)
  v_dot2_f32_bf16 v54, v100, s74, v54
  v_dot2_f32_bf16 v55, v101, s74, v55
  s_waitcnt lgkmcnt(10)
  v_dot2_f32_bf16 v54, v102, s74, v54
  v_dot2_f32_bf16 v55, v103, s74, v55
  ds_read_b64_tr_b16 v[124:125], v74
  v_add_u32 v76, v48, v74
  ds_read_b64_tr_b16 v[126:127], v75
  v_add_u32 v77, v48, v75
  s_waitcnt lgkmcnt(11)
  v_dot2_f32_bf16 v54, v104, s74, v54
  v_dot2_f32_bf16 v55, v105, s74, v55
  s_waitcnt lgkmcnt(10)
  v_dot2_f32_bf16 v54, v106, s74, v54
  v_dot2_f32_bf16 v55, v107, s74, v55
  ds_read_b64_tr_b16 v[128:129], v76
  v_add_u32 v78, v48, v76
  ds_read_b64_tr_b16 v[130:131], v77
  v_add_u32 v79, v48, v77
  s_waitcnt lgkmcnt(11)
  v_dot2_f32_bf16 v54, v108, s74, v54
  v_dot2_f32_bf16 v55, v109, s74, v55
  s_waitcnt lgkmcnt(10)
  v_dot2_f32_bf16 v54, v110, s74, v54
  v_dot2_f32_bf16 v55, v111, s74, v55
  ds_read_b64_tr_b16 v[132:133], v78
  v_add_u32 v80, v48, v78
  ds_read_b64_tr_b16 v[134:135], v79
  v_add_u32 v81, v48, v79
  s_waitcnt lgkmcnt(11)
  v_dot2_f32_bf16 v54, v112, s74, v54
  v_dot2_f32_bf16 v55, v113, s74, v55
  s_waitcnt lgkmcnt(10)
  v_dot2_f32_bf16 v54, v114, s74, v54
  v_dot2_f32_bf16 v55, v115, s74, v55
  ds_read_b64_tr_b16 v[136:137], v80
  v_add_u32 v82, v48, v80
  ds_read_b64_tr_b16 v[138:139], v81
  v_add_u32 v83, v48, v81
  s_waitcnt lgkmcnt(11)
  v_dot2_f32_bf16 v54, v116, s74, v54
  v_dot2_f32_bf16 v55, v117, s74, v55
  s_waitcnt lgkmcnt(10)
  v_dot2_f32_bf16 v54, v118, s74, v54
  v_dot2_f32_bf16 v55, v119, s74, v55
  ds_read_b64_tr_b16 v[140:141], v82
  v_add_u32 v72, v48, v82
  ds_read_b64_tr_b16 v[142:143], v83
  v_add_u32 v73, v48, v83
  s_waitcnt lgkmcnt(11)
  v_dot2_f32_bf16 v54, v120, s74, v54
  v_dot2_f32_bf16 v55, v121, s74, v55
  s_waitcnt lgkmcnt(10)
  v_dot2_f32_bf16 v54, v122, s74, v54
  v_dot2_f32_bf16 v55, v123, s74, v55
  ds_read_b64_tr_b16 v[144:145], v72
  v_add_u32 v74, v48, v72
  ds_read_b64_tr_b16 v[146:147], v73
  v_add_u32 v75, v48, v73
  s_waitcnt lgkmcnt(11)
  v_dot2_f32_bf16 v54, v124, s74, v54
  v_dot2_f32_bf16 v55, v125, s74, v55
  s_waitcnt lgkmcnt(10)
  v_dot2_f32_bf16 v54, v126, s74, v54
  v_dot2_f32_bf16 v55, v127, s74, v55
  ds_read_b64_tr_b16 v[148:149], v74
  v_add_u32 v76, v48, v74
  ds_read_b64_tr_b16 v[150:151], v75
  v_add_u32 v77, v48, v75
  s_waitcnt lgkmcnt(11)
  v_dot2_f32_bf16 v54, v128, s74, v54
  v_dot2_f32_bf16 v55, v129, s74, v55
  s_waitcnt lgkmcnt(10)
  v_dot2_f32_bf16 v54, v130, s74, v54
  v_dot2_f32_bf16 v55, v131, s74, v55
  ds_read_b64_tr_b16 v[152:153], v76
  v_add_u32 v78, v48, v76
  ds_read_b64_tr_b16 v[154:155], v77
  v_add_u32 v79, v48, v77
  s_waitcnt lgkmcnt(11)
  v_dot2_f32_bf16 v54, v132, s74, v54
  v_dot2_f32_bf16 v55, v133, s74, v55
  s_waitcnt lgkmcnt(10)
  v_dot2_f32_bf16 v54, v134, s74, v54
  v_dot2_f32_bf16 v55, v135, s74, v55
  ds_read_b64_tr_b16 v[156:157], v78
  v_add_u32 v80, v48, v78
  ds_read_b64_tr_b16 v[158:159], v79
  v_add_u32 v81, v48, v79
  s_waitcnt lgkmcnt(11)
  v_dot2_f32_bf16 v54, v136, s74, v54
  v_dot2_f32_bf16 v55, v137, s74, v55
  s_waitcnt lgkmcnt(10)
  v_dot2_f32_bf16 v54, v138, s74, v54
  v_dot2_f32_bf16 v55, v139, s74, v55
  ds_read_b64_tr_b16 v[160:161], v80
  v_add_u32 v82, v48, v80
  ds_read_b64_tr_b16 v[162:163], v81
  v_add_u32 v83, v48, v81
  s_waitcnt lgkmcnt(11)
  v_dot2_f32_bf16 v54, v140, s74, v54
  v_dot2_f32_bf16 v55, v141, s74, v55
  s_waitcnt lgkmcnt(10)
  v_dot2_f32_bf16 v54, v142, s74, v54
  v_dot2_f32_bf16 v55, v143, s74, v55
  ds_read_b64_tr_b16 v[164:165], v82
  v_add_u32 v72, v48, v82
  ds_read_b64_tr_b16 v[166:167], v83
  v_add_u32 v73, v48, v83
  s_waitcnt lgkmcnt(11)
  v_dot2_f32_bf16 v54, v144, s74, v54
  v_dot2_f32_bf16 v55, v145, s74, v55
  s_waitcnt lgkmcnt(10)
  v_dot2_f32_bf16 v54, v146, s74, v54
  v_dot2_f32_bf16 v55, v147, s74, v55
  ds_read_b64_tr_b16 v[168:169], v72
  v_sub_u32 v49, v72, v36
  v_add_u32 v49, v48, v49
  ds_read_b64_tr_b16 v[170:171], v73
  v_sub_u32 v50, v73, v36
  v_add_u32 v50, v48, v50
  s_waitcnt lgkmcnt(11)
  v_dot2_f32_bf16 v54, v148, s74, v54
  v_dot2_f32_bf16 v55, v149, s74, v55
  s_waitcnt lgkmcnt(10)
  v_dot2_f32_bf16 v54, v150, s74, v54
  v_dot2_f32_bf16 v55, v151, s74, v55
  s_waitcnt lgkmcnt(9)
  v_dot2_f32_bf16 v54, v152, s74, v54
  v_dot2_f32_bf16 v55, v153, s74, v55
  s_waitcnt lgkmcnt(8)
  v_dot2_f32_bf16 v54, v154, s74, v54
  v_dot2_f32_bf16 v55, v155, s74, v55
  s_waitcnt lgkmcnt(7)
  v_dot2_f32_bf16 v54, v156, s74, v54
  v_dot2_f32_bf16 v55, v157, s74, v55
  s_waitcnt lgkmcnt(6)
  v_dot2_f32_bf16 v54, v158, s74, v54
  v_dot2_f32_bf16 v55, v159, s74, v55
  s_waitcnt lgkmcnt(5)
  v_dot2_f32_bf16 v54, v160, s74, v54
  v_dot2_f32_bf16 v55, v161, s74, v55
  s_waitcnt lgkmcnt(4)
  v_dot2_f32_bf16 v54, v162, s74, v54
  v_dot2_f32_bf16 v55, v163, s74, v55
  s_waitcnt lgkmcnt(3)
  v_dot2_f32_bf16 v54, v164, s74, v54
  v_dot2_f32_bf16 v55, v165, s74, v55
  s_waitcnt lgkmcnt(2)
  v_dot2_f32_bf16 v54, v166, s74, v54
  v_dot2_f32_bf16 v55, v167, s74, v55
  s_waitcnt lgkmcnt(1)
  v_dot2_f32_bf16 v54, v168, s74, v54
  v_dot2_f32_bf16 v55, v169, s74, v55
  s_waitcnt lgkmcnt(0)
  v_dot2_f32_bf16 v54, v170, s74, v54
  v_dot2_f32_bf16 v55, v171, s74, v55
  s_barrier
  ds_read_b128 a[96:99], v84 offset:0
  ds_read_b128 a[100:103], v84 offset:40960
  ds_read_b128 a[104:107], v85 offset:0
  ds_read_b128 a[108:111], v85 offset:40960
  ds_read_b128 a[112:115], v86 offset:0
  v_and_b32 v6, 31, v0
  v_lshlrev_b32 v7, 2, v6
  v_lshlrev_b32 v6, 4, v6
  v_add_u32 v6, 81920, v6
  v_add_u32 v7, 82944, v7
  ds_read_b128 v[64:67], v6 offset:0
  ds_read_b32 v46, v7 offset:0
  ds_read_b128 v[68:71], v6 offset:512
  ds_read_b32 v47, v7 offset:128
  s_waitcnt lgkmcnt(8)
  v_mfma_f32_32x32x16_bf16 v[8:23], v[92:95], a[96:99], 0
  ds_read_b128 a[116:119], v86 offset:40960
  s_mul_i32 s79, s12, 5120
  s_add_u32 m0, s79, 83456
  s_add_u32 s79, s77, 409600
  buffer_load_dwordx4 v232, s[24:27], s79 offen offset:0 lds
  s_waitcnt lgkmcnt(8)
  v_mfma_f32_32x32x16_bf16 v[24:39], v[92:95], a[100:103], 0
  ds_read_b128 a[96:99], v87 offset:0
  buffer_load_dwordx4 v233, s[24:27], s79 offen offset:1024 lds
  buffer_load_dwordx4 v234, s[24:27], s79 offen offset:2048 lds
  s_waitcnt lgkmcnt(8)
  v_mfma_f32_32x32x16_bf16 v[8:23], v[96:99], a[104:107], v[8:23]
  ds_read_b128 a[100:103], v87 offset:40960
  buffer_load_dwordx4 v235, s[24:27], s79 offen offset:3072 lds
  s_add_u32 m0, m0, 4096
  s_nop 0
  buffer_load_dwordx4 v236, s[24:27], s79 offen offset:0 lds
  s_add_u32 s79, s79, 163840
  s_add_u32 m0, m0, 16384
  s_waitcnt lgkmcnt(8)
  v_mfma_f32_32x32x16_bf16 v[24:39], v[96:99], a[108:111], v[24:39]
  ds_read_b128 a[104:107], v88 offset:0
  buffer_load_dwordx4 v232, s[24:27], s79 offen offset:0 lds
  buffer_load_dwordx4 v233, s[24:27], s79 offen offset:1024 lds
  s_waitcnt lgkmcnt(8)
  v_mfma_f32_32x32x16_bf16 v[8:23], v[100:103], a[112:115], v[8:23]
  ds_read_b128 a[108:111], v88 offset:40960
  buffer_load_dwordx4 v234, s[24:27], s79 offen offset:2048 lds
  buffer_load_dwordx4 v235, s[24:27], s79 offen offset:3072 lds
  s_add_u32 m0, m0, 4096
  s_waitcnt lgkmcnt(4)
  v_mfma_f32_32x32x16_bf16 v[24:39], v[100:103], a[116:119], v[24:39]
  ds_read_b128 a[112:115], v89 offset:0
  buffer_load_dwordx4 v236, s[24:27], s79 offen offset:0 lds
  s_add_u32 s79, s79, 163840
  s_add_u32 m0, m0, 16384
  s_cmp_lt_u32 s12, 2
  s_cselect_b32 s79, s79, 1073741824
  s_cselect_b32 m0, m0, 163840
  s_waitcnt lgkmcnt(4)
  v_mfma_f32_32x32x16_bf16 v[8:23], v[104:107], a[96:99], v[8:23]
  ds_read_b128 a[116:119], v89 offset:40960
  buffer_load_dwordx4 v232, s[24:27], s79 offen offset:0 lds
  s_waitcnt lgkmcnt(4)
  v_mfma_f32_32x32x16_bf16 v[24:39], v[104:107], a[100:103], v[24:39]
  ds_read_b128 a[96:99], v90 offset:0
  buffer_load_dwordx4 v233, s[24:27], s79 offen offset:1024 lds
  s_waitcnt lgkmcnt(4)
  v_mfma_f32_32x32x16_bf16 v[8:23], v[108:111], a[104:107], v[8:23]
  ds_read_b128 a[100:103], v90 offset:40960
  s_mul_i32 s17, s12, 3072
  buffer_load_dwordx4 v234, s[24:27], s79 offen offset:2048 lds
  s_waitcnt lgkmcnt(4)
  v_mfma_f32_32x32x16_bf16 v[24:39], v[108:111], a[108:111], v[24:39]
  ds_read_b128 a[104:107], v91 offset:0
  s_add_u32 s17, s17, 94208
  buffer_load_dwordx4 v235, s[24:27], s79 offen offset:3072 lds
  s_add_u32 m0, m0, 4096
  s_waitcnt lgkmcnt(4)
  v_mfma_f32_32x32x16_bf16 v[8:23], v[112:115], a[112:115], v[8:23]
  ds_read_b128 a[108:111], v91 offset:40960
  v_add_u32 v61, s17, v1
  buffer_load_dwordx4 v236, s[24:27], s79 offen offset:0 lds
  s_waitcnt lgkmcnt(4)
  v_mfma_f32_32x32x16_bf16 v[24:39], v[112:115], a[116:119], v[24:39]
  ds_read_b128 a[112:115], v84 offset:256
  s_xor_b32 s17, s12, 1
  s_waitcnt lgkmcnt(4)
  v_mfma_f32_32x32x16_bf16 v[8:23], v[116:119], a[96:99], v[8:23]
  ds_read_b128 a[116:119], v84 offset:41216
  s_mul_i32 s17, s17, 3072
  s_waitcnt lgkmcnt(4)
  v_mfma_f32_32x32x16_bf16 v[24:39], v[116:119], a[100:103], v[24:39]
  ds_read_b128 a[96:99], v85 offset:256
  s_add_u32 s17, s17, 94208
  s_waitcnt lgkmcnt(4)
  v_mfma_f32_32x32x16_bf16 v[8:23], v[120:123], a[104:107], v[8:23]
  ds_read_b128 a[100:103], v85 offset:41216
  v_add_u32 v62, s17, v1
  s_waitcnt lgkmcnt(4)
  v_mfma_f32_32x32x16_bf16 v[24:39], v[120:123], a[108:111], v[24:39]
  ds_read_b128 a[104:107], v86 offset:256
  s_lshl_b32 s75, s10, 5
  s_waitcnt lgkmcnt(4)
  v_mfma_f32_32x32x16_bf16 v[8:23], v[124:127], a[112:115], v[8:23]
  ds_read_b128 a[108:111], v86 offset:41216
  s_add_u32 s75, s75, 65536
  s_waitcnt lgkmcnt(4)
  v_mfma_f32_32x32x16_bf16 v[24:39], v[124:127], a[116:119], v[24:39]
  ds_read_b128 a[112:115], v87 offset:256
  s_lshl_b32 s14, s10, 10
  s_waitcnt lgkmcnt(4)
  v_mfma_f32_32x32x16_bf16 v[8:23], v[128:131], a[96:99], v[8:23]
  ds_read_b128 a[116:119], v87 offset:41216
  s_add_u32 s14, s14, 0
  s_waitcnt lgkmcnt(4)
  v_mfma_f32_32x32x16_bf16 v[24:39], v[128:131], a[100:103], v[24:39]
  ds_read_b128 a[96:99], v88 offset:256
  s_cmp_lt_u32 s11, 2
  s_cselect_b32 s75, s75, 1073741824
  s_cselect_b32 s14, s14, 1073741824
  s_waitcnt lgkmcnt(4)
  v_mfma_f32_32x32x16_bf16 v[8:23], v[132:135], a[104:107], v[8:23]
  ds_read_b128 a[100:103], v88 offset:41216
  s_mul_i32 s17, s10, 7168
  s_waitcnt lgkmcnt(4)
  v_mfma_f32_32x32x16_bf16 v[24:39], v[132:135], a[108:111], v[24:39]
  ds_read_b128 a[104:107], v89 offset:256
  s_add_u32 s17, s17, 36700160
  s_waitcnt lgkmcnt(4)
  v_mfma_f32_32x32x16_bf16 v[8:23], v[136:139], a[112:115], v[8:23]
  ds_read_b128 a[108:111], v89 offset:41216
  s_cmp_eq_u32 s11, 0
  s_cselect_b32 s18, 531456, 0
  s_waitcnt lgkmcnt(4)
  v_mfma_f32_32x32x16_bf16 v[24:39], v[136:139], a[116:119], v[24:39]
  ds_read_b128 a[112:115], v90 offset:256
  s_cmp_lt_u32 s12, 3
  s_cselect_b32 s18, s18, 0
  s_waitcnt lgkmcnt(4)
  v_mfma_f32_32x32x16_bf16 v[8:23], v[140:143], a[96:99], v[8:23]
  ds_read_b128 a[116:119], v90 offset:41216
  s_add_u32 s32, s4, s17
  s_addc_u32 s33, s5, 0
  s_waitcnt lgkmcnt(4)
  v_mfma_f32_32x32x16_bf16 v[24:39], v[140:143], a[100:103], v[24:39]
  ds_read_b128 a[96:99], v91 offset:256
  s_mov_b32 s34, s18
  s_waitcnt lgkmcnt(4)
  v_mfma_f32_32x32x16_bf16 v[8:23], v[144:147], a[104:107], v[8:23]
  ds_read_b128 a[100:103], v91 offset:41216
  s_mov_b32 s35, 0x20000
  s_waitcnt lgkmcnt(4)
  v_mfma_f32_32x32x16_bf16 v[24:39], v[144:147], a[108:111], v[24:39]
  ds_read_b128 a[104:107], v84 offset:512
  s_cmp_eq_u32 s11, 1
  s_cselect_b32 s18, 531456, 0
  s_waitcnt lgkmcnt(4)
  v_mfma_f32_32x32x16_bf16 v[8:23], v[148:151], a[112:115], v[8:23]
  ds_read_b128 a[108:111], v84 offset:41472
  s_add_u32 s36, s4, s17
  s_addc_u32 s37, s5, 0
  s_waitcnt lgkmcnt(4)
  v_mfma_f32_32x32x16_bf16 v[24:39], v[148:151], a[116:119], v[24:39]
  ds_read_b128 a[112:115], v85 offset:512
  s_mov_b32 s38, s18
  s_waitcnt lgkmcnt(4)
  v_mfma_f32_32x32x16_bf16 v[8:23], v[152:155], a[96:99], v[8:23]
  ds_read_b128 a[116:119], v85 offset:41472
  s_mov_b32 s39, 0x20000
  s_waitcnt lgkmcnt(4)
  v_mfma_f32_32x32x16_bf16 v[24:39], v[152:155], a[100:103], v[24:39]
  ds_read_b128 a[96:99], v86 offset:512
  s_mov_b32 s15, 0x3f80
  s_waitcnt lgkmcnt(4)
  v_mfma_f32_32x32x16_bf16 v[8:23], v[156:159], a[104:107], v[8:23]
  ds_read_b128 a[100:103], v86 offset:41472
  s_mov_b32 s16, 0x3f803f80
  s_waitcnt lgkmcnt(4)
  v_mfma_f32_32x32x16_bf16 v[24:39], v[156:159], a[108:111], v[24:39]
  ds_read_b128 a[104:107], v87 offset:512
  s_cmp_eq_u32 s11, 0
  s_cselect_b32 s16, s16, s15
  s_cselect_b32 s15, s15, 0
  s_waitcnt lgkmcnt(4)
  s_waitcnt vmcnt(0)
  s_barrier
  ds_read_b64_tr_b16 a[84:85], v51
  ds_read_b64_tr_b16 a[86:87], v52
  v_mfma_f32_32x32x16_bf16 v[8:23], v[160:163], a[112:115], v[8:23]
  ds_read_b128 a[108:111], v87 offset:41472
  ds_read_b64_tr_b16 v[172:173], v49
  v_add_u32 v76, v48, v49
  ds_read_b64_tr_b16 v[174:175], v50
  v_add_u32 v77, v48, v50
  v_mov_b32 v40, s16
  s_lshl_b32 s77, s11, 2
  s_add_u32 s77, s77, s12
  s_waitcnt lgkmcnt(8)
  v_mfma_f32_32x32x16_bf16 v[24:39], v[160:163], a[116:119], v[24:39]
  ds_read_b128 a[112:115], v88 offset:512
  v_mov_b32 v41, s15
  s_mul_i32 s77, s77, 41984
  s_lshl_b32 s78, s10, 10
  s_waitcnt lgkmcnt(8)
  v_mfma_f32_32x32x16_bf16 v[8:23], v[164:167], a[96:99], v[8:23]
  ds_read_b128 a[116:119], v88 offset:41472
  ds_read_b64_tr_b16 v[176:177], v76
  v_add_u32 v78, v48, v76
  ds_read_b64_tr_b16 v[178:179], v77
  v_add_u32 v79, v48, v77
  s_lshl_b32 s15, s12, 3
  s_add_u32 s78, s78, s77
  s_cmp_lt_u32 s10, 20
  s_cselect_b32 s78, s78, 1073741824
  s_waitcnt lgkmcnt(10)
  v_mfma_f32_32x32x16_bf16 v[24:39], v[164:167], a[100:103], v[24:39]
  ds_read_b128 a[96:99], v89 offset:512
  s_add_u32 s16, s15, 1024
  buffer_store_dwordx4 a[80:83], v1, s[84:87], s78 offen sc1
  s_add_u32 s78, s78, 20480
  s_waitcnt lgkmcnt(10)
  v_mfma_f32_32x32x16_bf16 v[8:23], v[168:171], a[104:107], v[8:23]
  ds_read_b128 a[100:103], v89 offset:41472
  ds_read_b64_tr_b16 v[180:181], v78
  v_add_u32 v80, v48, v78
  ds_read_b64_tr_b16 v[182:183], v79
  v_add_u32 v81, v48, v79
  s_cmp_eq_u32 s12, 2
  s_cselect_b32 s15, 2048, s15
  s_cselect_b32 s16, 2056, s16
  buffer_store_dwordx4 a[40:43], v1, s[84:87], s69 offen offset:0 sc1
  s_waitcnt lgkmcnt(10)
  v_mfma_f32_32x32x16_bf16 v[24:39], v[168:171], a[108:111], v[24:39]
  ds_read_b128 a[104:107], v90 offset:512
  s_lshl_b32 s17, s12, 11
  s_waitcnt lgkmcnt(8)
  v_mfma_f32_32x32x16_bf16 v[8:23], v[172:175], a[112:115], v[8:23]
  ds_read_b128 a[108:111], v90 offset:41472
  ds_read_b64_tr_b16 v[184:185], v80
  v_add_u32 v82, v48, v80
  ds_read_b64_tr_b16 v[186:187], v81
  v_add_u32 v83, v48, v81
  s_add_u32 s17, s17, 86016
  buffer_store_dwordx4 a[44:47], v1, s[84:87], s69 offen offset:1024 sc1
  s_waitcnt lgkmcnt(10)
  v_mfma_f32_32x32x16_bf16 v[24:39], v[172:175], a[116:119], v[24:39]
  ds_read_b128 a[112:115], v91 offset:512
  v_lshrrev_b32 v6, 5, v0
  s_waitcnt lgkmcnt(8)
  v_mfma_f32_32x32x16_bf16 v[8:23], v[176:179], a[96:99], v[8:23]
  ds_read_b128 a[116:119], v91 offset:41472
  ds_read_b64_tr_b16 v[188:189], v82
  v_add_u32 v72, v48, v82
  ds_read_b64_tr_b16 v[190:191], v83
  v_add_u32 v73, v48, v83
  v_mul_u32_u24 v6, 576, v6
  buffer_store_dwordx4 a[48:51], v1, s[84:87], s69 offen offset:2048 sc1
  s_waitcnt lgkmcnt(10)
  v_mfma_f32_32x32x16_bf16 v[24:39], v[176:179], a[100:103], v[24:39]
  ds_read_b128 a[96:99], v84 offset:768
  v_and_b32 v7, 31, v0
  s_waitcnt lgkmcnt(8)
  v_mfma_f32_32x32x16_bf16 v[8:23], v[180:183], a[104:107], v[8:23]
  ds_read_b128 a[100:103], v84 offset:41728
  ds_read_b64_tr_b16 v[192:193], v72
  v_add_u32 v74, v48, v72
  ds_read_b64_tr_b16 v[194:195], v73
  v_add_u32 v75, v48, v73
  v_lshl_add_u32 v42, v7, 1, v6
  buffer_store_dwordx4 a[52:55], v1, s[84:87], s69 offen offset:3072 sc1
  s_waitcnt lgkmcnt(10)
  v_mfma_f32_32x32x16_bf16 v[24:39], v[180:183], a[108:111], v[24:39]
  ds_read_b128 a[104:107], v85 offset:768
  v_add_u32 v42, s17, v42
  s_waitcnt lgkmcnt(8)
  v_mfma_f32_32x32x16_bf16 v[8:23], v[184:187], a[112:115], v[8:23]
  ds_read_b128 a[108:111], v85 offset:41728
  ds_read_b64_tr_b16 v[196:197], v74
  v_add_u32 v76, v48, v74
  ds_read_b64_tr_b16 v[198:199], v75
  v_add_u32 v77, v48, v75
  v_and_b32 v6, 7, v0
  buffer_store_dwordx4 a[56:59], v2, s[84:87], s69 offen offset:0 sc1
  s_add_u32 s69, s69, s72
  s_waitcnt lgkmcnt(10)
  v_mfma_f32_32x32x16_bf16 v[24:39], v[184:187], a[116:119], v[24:39]
  ds_read_b128 a[112:115], v86 offset:768
  v_lshrrev_b32 v7, 3, v0
  s_waitcnt lgkmcnt(8)
  v_mfma_f32_32x32x16_bf16 v[8:23], v[188:191], a[96:99], v[8:23]
  ds_read_b128 a[116:119], v86 offset:41728
  ds_read_b64_tr_b16 v[200:201], v76
  v_add_u32 v78, v48, v76
  ds_read_b64_tr_b16 v[202:203], v77
  v_add_u32 v79, v48, v77
  v_mul_u32_u24 v43, 144, v6
  buffer_store_dwordx4 a[60:63], v1, s[84:87], s69 offen offset:0 sc1
  s_waitcnt lgkmcnt(10)
  v_mfma_f32_32x32x16_bf16 v[24:39], v[188:191], a[100:103], v[24:39]
  ds_read_b128 a[96:99], v87 offset:768
  v_lshl_add_u32 v43, v7, 4, v43
  s_waitcnt lgkmcnt(8)
  v_mfma_f32_32x32x16_bf16 v[8:23], v[192:195], a[104:107], v[8:23]
  ds_read_b128 a[100:103], v87 offset:41728
  ds_read_b64_tr_b16 v[204:205], v78
  v_add_u32 v80, v48, v78
  ds_read_b64_tr_b16 v[206:207], v79
  v_add_u32 v81, v48, v79
  v_add_u32 v43, s17, v43
  buffer_store_dwordx4 a[64:67], v1, s[84:87], s69 offen offset:1024 sc1
  s_waitcnt lgkmcnt(10)
  v_mfma_f32_32x32x16_bf16 v[24:39], v[192:195], a[108:111], v[24:39]
  ds_read_b128 a[104:107], v88 offset:768
  v_lshlrev_b32 v44, 9, v7
  s_waitcnt lgkmcnt(8)
  v_mfma_f32_32x32x16_bf16 v[8:23], v[196:199], a[112:115], v[8:23]
  ds_read_b128 a[108:111], v88 offset:41728
  ds_read_b64_tr_b16 v[208:209], v80
  v_add_u32 v82, v48, v80
  ds_read_b64_tr_b16 v[210:211], v81
  v_add_u32 v83, v48, v81
  v_lshl_add_u32 v44, v6, 4, v44
  buffer_store_dwordx4 a[68:71], v1, s[84:87], s69 offen offset:2048 sc1
  s_waitcnt lgkmcnt(10)
  v_mfma_f32_32x32x16_bf16 v[24:39], v[196:199], a[116:119], v[24:39]
  ds_read_b128 a[112:115], v89 offset:768
  s_lshl_b32 s19, s12, 7
  s_waitcnt lgkmcnt(8)
  v_mfma_f32_32x32x16_bf16 v[8:23], v[200:203], a[96:99], v[8:23]
  ds_read_b128 a[116:119], v89 offset:41728
  ds_read_b64_tr_b16 v[212:213], v82
  v_add_u32 v72, v48, v82
  ds_read_b64_tr_b16 v[214:215], v83
  v_add_u32 v73, v48, v83
  v_add_u32 v63, 524288, v1
  buffer_store_dwordx4 a[72:75], v1, s[84:87], s69 offen offset:3072 sc1
  s_waitcnt lgkmcnt(10)
  v_mfma_f32_32x32x16_bf16 v[24:39], v[200:203], a[100:103], v[24:39]
  ds_read_b128 a[96:99], v90 offset:768
  v_add_u32 v45, 524288, v44
  s_waitcnt lgkmcnt(8)
  v_mfma_f32_32x32x16_bf16 v[8:23], v[204:207], a[104:107], v[8:23]
  ds_read_b128 a[100:103], v90 offset:41728
  ds_read_b64_tr_b16 v[216:217], v72
  v_add_u32 v74, v48, v72
  ds_read_b64_tr_b16 v[218:219], v73
  v_add_u32 v75, v48, v73
  buffer_store_dwordx4 a[76:79], v2, s[84:87], s69 offen offset:0 sc1
  s_waitcnt lgkmcnt(10)
  v_mfma_f32_32x32x16_bf16 v[24:39], v[204:207], a[108:111], v[24:39]
  ds_read_b128 a[104:107], v91 offset:768
  s_waitcnt lgkmcnt(8)
  v_mfma_f32_32x32x16_bf16 v[8:23], v[208:211], a[112:115], v[8:23]
  ds_read_b128 a[108:111], v91 offset:41728
  ds_read_b64_tr_b16 v[220:221], v74
  v_add_u32 v76, v48, v74
  ds_read_b64_tr_b16 v[222:223], v75
  v_add_u32 v77, v48, v75
  buffer_store_dwordx4 a[120:123], v56, s[84:87], s82 offen sc1
  s_waitcnt lgkmcnt(10)
  v_mfma_f32_32x32x16_bf16 v[24:39], v[208:211], a[116:119], v[24:39]
  ds_read_b128 a[112:115], v84 offset:1024
  s_waitcnt lgkmcnt(8)
  v_mfma_f32_32x32x16_bf16 v[8:23], v[212:215], a[96:99], v[8:23]
  ds_read_b128 a[116:119], v84 offset:41984
  ds_read_b64_tr_b16 v[224:225], v76
  v_add_u32 v78, v48, v76
  ds_read_b64_tr_b16 v[226:227], v77
  v_add_u32 v79, v48, v77
  s_waitcnt lgkmcnt(10)
  v_mfma_f32_32x32x16_bf16 v[24:39], v[212:215], a[100:103], v[24:39]
  ds_read_b128 a[96:99], v85 offset:1024
  s_waitcnt lgkmcnt(8)
  v_mfma_f32_32x32x16_bf16 v[8:23], v[216:219], a[104:107], v[8:23]
  ds_read_b128 a[100:103], v85 offset:41984
  ds_read_b64_tr_b16 v[228:229], v78
  v_add_u32 v80, v48, v78
  ds_read_b64_tr_b16 v[230:231], v79
  v_add_u32 v81, v48, v79
  s_waitcnt lgkmcnt(10)
  v_mfma_f32_32x32x16_bf16 v[24:39], v[216:219], a[108:111], v[24:39]
  ds_read_b128 a[104:107], v86 offset:1024
  s_waitcnt lgkmcnt(8)
  v_mfma_f32_32x32x16_bf16 v[8:23], v[220:223], a[112:115], v[8:23]
  ds_read_b128 a[108:111], v86 offset:41984
  ds_read_b64_tr_b16 v[232:233], v80
  v_add_u32 v82, v48, v80
  ds_read_b64_tr_b16 v[234:235], v81
  v_add_u32 v83, v48, v81
  s_waitcnt lgkmcnt(10)
  v_mfma_f32_32x32x16_bf16 v[24:39], v[220:223], a[116:119], v[24:39]
  ds_read_b128 a[112:115], v87 offset:1024
  s_waitcnt lgkmcnt(8)
  v_mfma_f32_32x32x16_bf16 v[8:23], v[224:227], a[96:99], v[8:23]
  ds_read_b128 a[116:119], v87 offset:41984
  ds_read_b64_tr_b16 v[236:237], v82
  v_add_u32 v72, v48, v82
  ds_read_b64_tr_b16 v[238:239], v83
  v_add_u32 v73, v48, v83
  s_waitcnt lgkmcnt(10)
  v_mfma_f32_32x32x16_bf16 v[24:39], v[224:227], a[100:103], v[24:39]
  ds_read_b128 a[96:99], v88 offset:1024
  s_waitcnt lgkmcnt(8)
  v_mfma_f32_32x32x16_bf16 v[8:23], v[228:231], a[104:107], v[8:23]
  ds_read_b128 a[100:103], v88 offset:41984
  ds_read_b64_tr_b16 v[240:241], v72
  v_add_u32 v74, v48, v72
  ds_read_b64_tr_b16 v[242:243], v73
  v_add_u32 v75, v48, v73
  s_waitcnt lgkmcnt(10)
  v_mfma_f32_32x32x16_bf16 v[24:39], v[228:231], a[108:111], v[24:39]
  ds_read_b128 a[104:107], v89 offset:1024
  s_waitcnt lgkmcnt(8)
  v_mfma_f32_32x32x16_bf16 v[8:23], v[232:235], a[112:115], v[8:23]
  ds_read_b128 a[108:111], v89 offset:41984
  ds_read_b64_tr_b16 v[244:245], v74
  v_add_u32 v76, v48, v74
  ds_read_b64_tr_b16 v[246:247], v75
  v_add_u32 v77, v48, v75
  s_waitcnt lgkmcnt(10)
  v_mfma_f32_32x32x16_bf16 v[24:39], v[232:235], a[116:119], v[24:39]
  ds_read_b128 a[112:115], v90 offset:1024
  s_waitcnt lgkmcnt(8)
  v_mfma_f32_32x32x16_bf16 v[8:23], v[236:239], a[96:99], v[8:23]
  ds_read_b128 a[116:119], v90 offset:41984
  ds_read_b64_tr_b16 v[248:249], v76
  ds_read_b64_tr_b16 v[250:251], v77
  s_waitcnt lgkmcnt(10)
  v_mfma_f32_32x32x16_bf16 v[24:39], v[236:239], a[100:103], v[24:39]
  ds_read_b128 a[96:99], v91 offset:1024
  s_waitcnt lgkmcnt(8)
  v_mfma_f32_32x32x16_bf16 v[8:23], v[240:243], a[104:107], v[8:23]
  ds_read_b128 a[100:103], v91 offset:41984
  v_lshrrev_b32 v49, 3, v0
  v_and_b32 v48, 7, v0
  v_lshlrev_b32 v48, 4, v48
  v_lshl_add_u32 v48, v49, 10, v48
  s_and_b32 s13, s10, 28
  s_lshl_b32 s13, s13, 10
  buffer_load_dwordx4 v[48:51], v48, s[44:47], s13 offen offset:512 sc1
  s_waitcnt lgkmcnt(8)
  v_mfma_f32_32x32x16_bf16 v[24:39], v[240:243], a[108:111], v[24:39]
  s_waitcnt lgkmcnt(5)
  v_mfma_f32_32x32x16_bf16 v[8:23], v[244:247], a[112:115], v[8:23]
  s_waitcnt lgkmcnt(4)
  v_mfma_f32_32x32x16_bf16 v[24:39], v[244:247], a[116:119], v[24:39]
  s_waitcnt lgkmcnt(1)
  v_mfma_f32_32x32x16_bf16 v[8:23], v[248:251], a[96:99], v[8:23]
  s_waitcnt lgkmcnt(0)
  v_mfma_f32_32x32x16_bf16 v[24:39], v[248:251], a[100:103], v[24:39]
  s_mov_b32 s83, s78
  v_dot2_f32_bf16 v54, v172, s74, v54
  v_dot2_f32_bf16 v55, v173, s74, v55
  v_dot2_f32_bf16 v54, v174, s74, v54
  v_dot2_f32_bf16 v55, v175, s74, v55
  v_dot2_f32_bf16 v54, v176, s74, v54
  v_dot2_f32_bf16 v55, v177, s74, v55
  v_dot2_f32_bf16 v54, v178, s74, v54
  v_dot2_f32_bf16 v55, v179, s74, v55
  v_dot2_f32_bf16 v54, v180, s74, v54
  v_dot2_f32_bf16 v55, v181, s74, v55
  v_dot2_f32_bf16 v54, v182, s74, v54
  v_dot2_f32_bf16 v55, v183, s74, v55
  v_dot2_f32_bf16 v54, v184, s74, v54
  v_dot2_f32_bf16 v55, v185, s74, v55
  v_dot2_f32_bf16 v54, v186, s74, v54
  v_dot2_f32_bf16 v55, v187, s74, v55
  v_dot2_f32_bf16 v54, v188, s74, v54
  v_dot2_f32_bf16 v55, v189, s74, v55
  v_dot2_f32_bf16 v54, v190, s74, v54
  v_dot2_f32_bf16 v55, v191, s74, v55
  v_dot2_f32_bf16 v54, v192, s74, v54
  v_dot2_f32_bf16 v55, v193, s74, v55
  v_dot2_f32_bf16 v54, v194, s74, v54
  v_dot2_f32_bf16 v55, v195, s74, v55
  v_dot2_f32_bf16 v54, v196, s74, v54
  v_dot2_f32_bf16 v55, v197, s74, v55
  v_dot2_f32_bf16 v54, v198, s74, v54
  v_dot2_f32_bf16 v55, v199, s74, v55
  v_dot2_f32_bf16 v54, v200, s74, v54
  v_dot2_f32_bf16 v55, v201, s74, v55
  v_dot2_f32_bf16 v54, v202, s74, v54
  v_dot2_f32_bf16 v55, v203, s74, v55
  v_dot2_f32_bf16 v54, v204, s74, v54
  v_dot2_f32_bf16 v55, v205, s74, v55
  v_dot2_f32_bf16 v54, v206, s74, v54
  v_dot2_f32_bf16 v55, v207, s74, v55
  v_dot2_f32_bf16 v54, v208, s74, v54
  v_dot2_f32_bf16 v55, v209, s74, v55
  v_dot2_f32_bf16 v54, v210, s74, v54
  v_dot2_f32_bf16 v55, v211, s74, v55
  v_dot2_f32_bf16 v54, v212, s74, v54
  v_dot2_f32_bf16 v55, v213, s74, v55
  v_dot2_f32_bf16 v54, v214, s74, v54
  v_dot2_f32_bf16 v55, v215, s74, v55
  v_dot2_f32_bf16 v54, v216, s74, v54
  v_dot2_f32_bf16 v55, v217, s74, v55
  v_dot2_f32_bf16 v54, v218, s74, v54
  v_dot2_f32_bf16 v55, v219, s74, v55
  v_dot2_f32_bf16 v54, v220, s74, v54
  v_dot2_f32_bf16 v55, v221, s74, v55
  v_dot2_f32_bf16 v54, v222, s74, v54
  v_dot2_f32_bf16 v55, v223, s74, v55
  v_dot2_f32_bf16 v54, v224, s74, v54
  v_dot2_f32_bf16 v55, v225, s74, v55
  v_dot2_f32_bf16 v54, v226, s74, v54
  v_dot2_f32_bf16 v55, v227, s74, v55
  v_dot2_f32_bf16 v54, v228, s74, v54
  v_dot2_f32_bf16 v55, v229, s74, v55
  v_dot2_f32_bf16 v54, v230, s74, v54
  v_dot2_f32_bf16 v55, v231, s74, v55
  v_dot2_f32_bf16 v54, v232, s74, v54
  v_dot2_f32_bf16 v55, v233, s74, v55
  v_dot2_f32_bf16 v54, v234, s74, v54
  v_dot2_f32_bf16 v55, v235, s74, v55
  v_dot2_f32_bf16 v54, v236, s74, v54
  v_dot2_f32_bf16 v55, v237, s74, v55
  v_dot2_f32_bf16 v54, v238, s74, v54
  v_dot2_f32_bf16 v55, v239, s74, v55
  v_dot2_f32_bf16 v54, v240, s74, v54
  v_dot2_f32_bf16 v55, v241, s74, v55
  v_dot2_f32_bf16 v54, v242, s74, v54
  v_dot2_f32_bf16 v55, v243, s74, v55
  v_dot2_f32_bf16 v54, v244, s74, v54
  v_dot2_f32_bf16 v55, v245, s74, v55
  v_dot2_f32_bf16 v54, v246, s74, v54
  v_dot2_f32_bf16 v55, v247, s74, v55
  v_dot2_f32_bf16 v54, v248, s74, v54
  v_dot2_f32_bf16 v55, v249, s74, v55
  v_dot2_f32_bf16 v54, v250, s74, v54
  v_dot2_f32_bf16 v55, v251, s74, v55
  s_nop 2
  v_add_f32 v54, v54, v55
  v_mov_b32 v55, v54
  s_nop 1
  v_permlane32_swap_b32 v54, v55
  v_add_f32 v54, v54, v55
  v_cvt_pk_bf16_f32 v252, v54, v54
  v_and_b32 v55, 0xffff0000, v252
  v_sub_f32 v55, v54, v55
  v_cvt_pk_bf16_f32 v253, v55, 0
  v_cmp_gt_u32 vcc, 32, v0
  v_mov_b32 v254, 0
  v_mov_b32 v255, 0
  v_cndmask_b32 v252, 0, v252, vcc
  v_cndmask_b32 v253, 0, v253, vcc
  s_add_u32 s78, s77, 40960
  s_cmp_eq_u32 s10, 20
  s_cselect_b32 s78, s78, 1073741824
  v_mfma_f32_32x32x16_bf16 v[8:23], v[252:255], v[64:67], v[8:23]
  v_mfma_f32_32x32x16_bf16 v[24:39], v[252:255], v[68:71], v[24:39]
  s_barrier
  s_waitcnt vmcnt(0)
  v_xor_b32 v48, s9, v48
  v_xor_b32 v49, s9, v49
  v_xor_b32 v50, s9, v50
  v_xor_b32 v51, s9, v51
  v_or3_b32 v48, v48, v49, v50
  v_or_b32 v48, v48, v51
  v_cmp_eq_u32 vcc, 0, v48
  s_nop 0
  s_cmp_eq_u32 vcc_lo, -1
  s_cselect_b32 s95, 1, 0
  v_mov_b32 v206, v62
  s_cmp_eq_u32 s12, 2
  s_cselect_b32 vcc_hi, -1, 0
  s_mov_b32 vcc_lo, 0
  v_mul_f32 v116, 0x3ea52b5c, v46
  v_mul_f32 v118, 0x3ea52b5c, v47
  v_mul_f32 v20, v20, v46
  v_mul_f32 v21, v21, v46
  v_mul_f32 v22, v22, v46
  v_mul_f32 v23, v23, v46
  v_cvt_pk_bf16_f32 v102, v20, v21
  v_cvt_pk_bf16_f32 v103, v22, v23
  v_cndmask_b32 v102, v102, v40, vcc
  v_cndmask_b32 v103, v103, v41, vcc
  ds_write_b16 v42, v102 offset:0
  ds_write_b16_d16_hi v42, v102 offset:144
  ds_write_b16 v42, v103 offset:288
  ds_write_b16_d16_hi v42, v103 offset:432
  buffer_store_dwordx2 v[102:103], v63, s[32:35], s15 offen
  v_mul_f32 v36, v36, v47
  v_mul_f32 v37, v37, v47
  v_mul_f32 v38, v38, v47
  v_mul_f32 v39, v39, v47
  v_cvt_pk_bf16_f32 v110, v36, v37
  v_cvt_pk_bf16_f32 v111, v38, v39
  v_cndmask_b32 v110, v110, v40, vcc
  v_cndmask_b32 v111, v111, v41, vcc
  ds_write_b16 v42, v110 offset:64
  ds_write_b16_d16_hi v42, v110 offset:208
  ds_write_b16 v42, v111 offset:352
  ds_write_b16_d16_hi v42, v111 offset:496
  buffer_store_dwordx2 v[110:111], v63, s[32:35], s16 offen
  ds_read_b128 v[112:115], v43
  v_pk_mul_f32 v[8:9], v[8:9], v[116:117] op_sel_hi:[1,0]
  v_pk_mul_f32 v[10:11], v[10:11], v[116:117] op_sel_hi:[1,0]
  v_pk_mul_f32 v[12:13], v[12:13], v[116:117] op_sel_hi:[1,0]
  v_pk_mul_f32 v[14:15], v[14:15], v[116:117] op_sel_hi:[1,0]
  v_pk_mul_f32 v[16:17], v[16:17], v[116:117] op_sel_hi:[1,0]
  v_pk_mul_f32 v[18:19], v[18:19], v[116:117] op_sel_hi:[1,0]
  s_waitcnt lgkmcnt(0)
  buffer_store_dwordx4 v[112:115], v45, s[36:39], s19 offen offset:3072
  buffer_store_dwordx2 v[102:103], v1, s[32:35], s15 offen sc1
  buffer_store_dwordx2 v[110:111], v1, s[32:35], s16 offen sc1
  buffer_store_dwordx4 v[112:115], v44, s[36:39], s19 offen offset:3072 sc1
  buffer_store_dwordx4 a[84:87], v1, s[84:87], s83 offen sc1
  buffer_store_dwordx4 v[252:255], v1, s[84:87], s78 offen sc1
  v_cvt_pk_bf16_f32 v64, v8, v9
  v_cvt_pk_bf16_f32 v65, v10, v11
  v_cvt_pk_bf16_f32 v66, v12, v13
  v_cvt_pk_bf16_f32 v67, v14, v15
  v_cvt_pk_bf16_f32 v76, v16, v17
  v_cvt_pk_bf16_f32 v77, v18, v19
  ds_write_b128 v61, v[64:67] offset:0
  v_pk_mul_f32 v[24:25], v[24:25], v[118:119] op_sel_hi:[1,0]
  v_pk_mul_f32 v[26:27], v[26:27], v[118:119] op_sel_hi:[1,0]
  v_pk_mul_f32 v[28:29], v[28:29], v[118:119] op_sel_hi:[1,0]
  v_pk_mul_f32 v[30:31], v[30:31], v[118:119] op_sel_hi:[1,0]
  v_pk_mul_f32 v[32:33], v[32:33], v[118:119] op_sel_hi:[1,0]
  v_pk_mul_f32 v[34:35], v[34:35], v[118:119] op_sel_hi:[1,0]
  v_cvt_pk_bf16_f32 v68, v24, v25
  v_cvt_pk_bf16_f32 v69, v26, v27
  v_cvt_pk_bf16_f32 v70, v28, v29
  v_cvt_pk_bf16_f32 v71, v30, v31
  v_cvt_pk_bf16_f32 v78, v32, v33
  v_cvt_pk_bf16_f32 v79, v34, v35
  ds_write_b128 v61, v[68:71] offset:1024
  ds_write_b128 v61, v[76:79] offset:2048
  s_waitcnt lgkmcnt(0)
  s_barrier
  ds_read_b128 v[56:59], v206 offset:0
  ds_read_b128 v[60:63], v206 offset:1024
  ds_read_b128 v[72:75], v206 offset:2048
  s_waitcnt vmcnt(5)
  v_mov_b32 v6, s0
  buffer_store_dword v6, v3, s[44:47], s14 offen offset:768
  s_mov_b32 s3, 1
  v_lshrrev_b32 v7, 5, v0
  v_lshlrev_b32 v4, 2, v0
  v_lshl_add_u32 v4, v7, 30, v4
  v_mov_b32 v5, 0xdddddddd
  s_lshl_b32 s13, s12, 3
  s_lshl_b32 s77, 0xff, s13
  s_lshl_b32 s78, 0x11111111, s12
  s_lshl_b32 s60, s10, 10
  s_mov_b32 s61, 8192
  s_mov_b32 s62, 16384
  s_mov_b32 s63, 24576
  s_mov_b32 s64, 32768
  s_mov_b32 s65, 40960
  s_mov_b32 s66, 49152
  s_mov_b32 s67, 57344
  s_mov_b32 s68, 65536
  s_mov_b32 s69, 73728
  s_mov_b32 s92, 0x3f317218
  s_mov_b32 s93, 0x3f317218
  s_add_u32 s79, s60, 0
  s_mov_b32 s1, 65536
  s_add_u32 s20, s4, 36700160
  s_addc_u32 s21, s5, 0
  s_lshl_b32 s13, s10, 3
  s_add_u32 s13, s13, s11
  s_mul_i32 s13, s13, 12288
  s_add_u32 s13, s13, 33554432
  s_add_u32 s24, s4, s13
  s_addc_u32 s25, s5, 0
  s_mov_b32 s26, 12288
  s_mov_b32 s27, 0x20000
  s_mov_b32 s76, 0
  s_mul_i32 s13, s11, 7
  s_lshl_b32 s14, s12, 1
  s_add_u32 s13, s13, s14
  s_cmp_lt_u32 s13, 54
  s_cselect_b32 s82, 41984, 0
  s_add_u32 s15, s13, 1
  s_cmp_lt_u32 s15, 54
  s_cselect_b32 s83, 41984, 0
  s_cmp_lt_u32 s12, 3
  s_cselect_b32 s83, s83, 0
  s_mov_b32 s84, s13
  s_mul_i32 s14, s13, 41984
  s_add_u32 s14, s14, 2097152
  s_add_u32 s32, s4, s14
  s_addc_u32 s33, s5, 0
  s_mov_b32 s34, s82
  s_mov_b32 s35, 0x20000
  s_add_u32 s14, s14, 41984
  s_add_u32 s36, s4, s14
  s_addc_u32 s37, s5, 0
  s_mov_b32 s38, s83
  s_mov_b32 s39, 0x20000
  s_mul_i32 s14, s11, 102400
  s_mul_i32 s15, s12, 25600
  s_add_u32 s14, s14, s15
  s_add_u32 s14, s14, 8388608
  s_add_u32 s40, s4, s14
  s_addc_u32 s41, s5, 0
  s_mov_b32 s42, 4096
  s_mov_b32 s43, 0x20000
  s_cmp_lg_u32 s95, 0
  s_cselect_b32 s94, 524288, 0
  s_and_b32 s74, s10, 28
  s_and_b32 s13, s12, 1
  s_add_u32 s74, s74, s13
  s_mul_i32 s72, s74, 7168
  s_add_u32 s72, s72, s94
  s_add_u32 s28, s20, s72
  s_addc_u32 s29, s21, 0
  s_mov_b32 s30, 7168
  s_mov_b32 s31, 0x20000
  v_mov_b32 v80, 0
  v_mov_b32 v81, 0
  v_mov_b32 v82, 0
  v_mov_b32 v83, 0
  v_mov_b32 v84, 0
  v_mov_b32 v85, 0
  v_mov_b32 v86, 0
  v_mov_b32 v87, 0
  v_mov_b32 v88, 0
  v_mov_b32 v89, 0
  v_mov_b32 v90, 0
  v_mov_b32 v91, 0
  v_mov_b32 v92, 0
  v_mov_b32 v93, 0
  v_mov_b32 v94, 0
  v_mov_b32 v95, 0
  v_mov_b32 v96, 0
  v_mov_b32 v97, 0
  v_mov_b32 v98, 0
  v_mov_b32 v99, 0
  v_mov_b32 v100, 0
  v_mov_b32 v101, 0
  v_mov_b32 v102, 0
  v_mov_b32 v103, 0
  v_mov_b32 v104, 0
  v_mov_b32 v105, 0
  v_mov_b32 v106, 0
  v_mov_b32 v107, 0
  v_mov_b32 v108, 0
  v_mov_b32 v109, 0
  v_mov_b32 v110, 0
  v_mov_b32 v111, 0
  v_mov_b32 v112, 0
  v_mov_b32 v113, 0
  v_mov_b32 v114, 0
  v_mov_b32 v115, 0
  v_mov_b32 v116, 0
  v_mov_b32 v117, 0
  v_mov_b32 v118, 0
  v_mov_b32 v119, 0
  v_mov_b32 v120, 0
  v_mov_b32 v121, 0
  v_mov_b32 v122, 0
  v_mov_b32 v123, 0
  v_mov_b32 v124, 0
  v_mov_b32 v125, 0
  v_mov_b32 v126, 0
  v_mov_b32 v127, 0
  v_mov_b32 v128, 0
  v_mov_b32 v129, 0
  v_mov_b32 v130, 0
  v_mov_b32 v131, 0
  v_mov_b32 v132, 0
  v_mov_b32 v133, 0
  v_mov_b32 v134, 0
  v_mov_b32 v135, 0
  v_mov_b32 v136, 0
  v_mov_b32 v137, 0
  v_mov_b32 v138, 0
  v_mov_b32 v139, 0
  v_mov_b32 v140, 0
  v_mov_b32 v141, 0
  v_mov_b32 v142, 0
  v_mov_b32 v143, 0
  v_lshrrev_b32 v7, 3, v0
  v_and_b32 v8, 7, v0
  v_lshlrev_b32 v8, 2, v8
  v_lshl_add_u32 v8, v7, 11, v8
  v_lshrrev_b32 v7, 4, v0
  v_lshl_add_u32 v8, v7, 28, v8
  s_lshl_b32 s16, s74, 10
  s_add_u32 s16, s16, 0
  s_mov_b32 s17, 0xffff
  s_waitcnt vmcnt(1)
  v_mov_b32 v6, s0
  buffer_store_dword v6, v3, s[44:47], s75 offen sc1
  s_lshl_b32 s13, s10, 7
  s_add_u32 s13, s13, 67584
  buffer_store_dword v6, v3, s[44:47], s13 offen sc1
  s_waitcnt lgkmcnt(0)
  s_cmp_lg_u32 s95, 0
  s_cbranch_scc0 Lkvg1
  s_mov_b32 s80, 0x400000
Lpoll91:
  buffer_load_dword v6, v8, s[44:47], s16 offen offset:768 sc1
  s_sub_u32 s80, s80, 1
  s_cbranch_scc1 Lpolled91
  s_waitcnt vmcnt(0)
  v_cmp_eq_u32 vcc, s0, v6
  s_nop 0
  s_and_b32 s81, vcc_lo, s17
  s_cmp_eq_u32 s81, s17
  s_cbranch_scc0 Lpoll91
Lpolled91:
Lkvgd1:
  buffer_load_dwordx4 v[144:147], v1, s[28:31], 0 offen offset:0 sc1
  buffer_load_dwordx4 v[156:159], v1, s[28:31], 0 offen offset:2048 sc1
  buffer_load_dwordx4 v[168:171], v2, s[28:31], 0 offen sc1
  buffer_load_dwordx4 v[164:167], v1, s[28:31], 0 offen offset:3072 sc1
  buffer_load_dwordx4 v[172:175], v2, s[28:31], 0 offen offset:1024 sc1
  buffer_load_dwordx4 v[176:179], v2, s[28:31], 0 offen offset:2048 sc1
  buffer_load_dwordx4 v[148:151], v1, s[28:31], 0 offen offset:1024 sc1
  s_waitcnt vmcnt(0)
  s_branch Lattn_go
Lattn_main:
  v_mov_b32 v80, 0
  v_mov_b32 v81, 0
  v_mov_b32 v82, 0
  v_mov_b32 v83, 0
  v_mov_b32 v84, 0
  v_mov_b32 v85, 0
  v_mov_b32 v86, 0
  v_mov_b32 v87, 0
  v_mov_b32 v88, 0
  v_mov_b32 v89, 0
  v_mov_b32 v90, 0
  v_mov_b32 v91, 0
  v_mov_b32 v92, 0
  v_mov_b32 v93, 0
  v_mov_b32 v94, 0
  v_mov_b32 v95, 0
  v_mov_b32 v96, 0
  v_mov_b32 v97, 0
  v_mov_b32 v98, 0
  v_mov_b32 v99, 0
  v_mov_b32 v100, 0
  v_mov_b32 v101, 0
  v_mov_b32 v102, 0
  v_mov_b32 v103, 0
  v_mov_b32 v104, 0
  v_mov_b32 v105, 0
  v_mov_b32 v106, 0
  v_mov_b32 v107, 0
  v_mov_b32 v108, 0
  v_mov_b32 v109, 0
  v_mov_b32 v110, 0
  v_mov_b32 v111, 0
  v_mov_b32 v112, 0
  v_mov_b32 v113, 0
  v_mov_b32 v114, 0
  v_mov_b32 v115, 0
  v_mov_b32 v116, 0
  v_mov_b32 v117, 0
  v_mov_b32 v118, 0
  v_mov_b32 v119, 0
  v_mov_b32 v120, 0
  v_mov_b32 v121, 0
  v_mov_b32 v122, 0
  v_mov_b32 v123, 0
  v_mov_b32 v124, 0
  v_mov_b32 v125, 0
  v_mov_b32 v126, 0
  v_mov_b32 v127, 0
  v_mov_b32 v128, 0
  v_mov_b32 v129, 0
  v_mov_b32 v130, 0
  v_mov_b32 v131, 0
  v_mov_b32 v132, 0
  v_mov_b32 v133, 0
  v_mov_b32 v134, 0
  v_mov_b32 v135, 0
  v_mov_b32 v136, 0
  v_mov_b32 v137, 0
  v_mov_b32 v138, 0
  v_mov_b32 v139, 0
  v_mov_b32 v140, 0
  v_mov_b32 v141, 0
  v_mov_b32 v142, 0
  v_mov_b32 v143, 0
Lattn_go:
  s_mul_i32 m0, s12, 25600
  v_mfma_f32_32x32x16_bf16 v[8:23], v[144:147], v[56:59], 0
  v_mfma_f32_32x32x8_bf16 v[8:23], v[156:157], v[72:73], v[8:23]
  v_mfma_f32_32x32x16_bf16 v[24:39], v[144:147], v[60:63], 0
  s_nop 10
  v_exp_f32 v8, v8
  v_exp_f32 v9, v9
  v_exp_f32 v10, v10
  v_exp_f32 v11, v11
  v_mfma_f32_32x32x8_bf16 v[24:39], v[156:157], v[74:75], v[24:39]
  v_exp_f32 v12, v12
  v_exp_f32 v13, v13
  v_exp_f32 v14, v14
  v_exp_f32 v15, v15
  s_add_u32 s74, s74, 2
  s_and_b32 s74, s74, 31
  s_mul_i32 s72, s74, 7168
  s_add_u32 s72, s72, s94
  s_add_u32 s28, s20, s72
  s_addc_u32 s29, s21, 0
  v_exp_f32 v16, v16
  v_exp_f32 v17, v17
  v_exp_f32 v18, v18
  v_exp_f32 v19, v19
  v_smfmac_f32_32x32x32_bf16 v[80:95], v[164:167], v[8:15], v5
  buffer_load_dwordx4 v[180:183], v1, s[28:31], 0 offen offset:3072 sc1
  buffer_load_dwordx4 v[184:187], v2, s[28:31], 0 offen sc1
  buffer_load_dwordx4 v[160:163], v1, s[28:31], 0 offen offset:2048 sc1
  buffer_load_dwordx4 v[152:155], v1, s[28:31], 0 offen offset:0 sc1
  v_exp_f32 v20, v20
  v_exp_f32 v21, v21
  v_exp_f32 v22, v22
  v_exp_f32 v23, v23
  v_mfma_f32_32x32x16_bf16 v[40:55], v[144:147], v[64:67], 0
  v_exp_f32 v24, v24
  v_exp_f32 v25, v25
  v_exp_f32 v26, v26
  v_exp_f32 v27, v27
  v_mfma_f32_32x32x8_bf16 v[40:55], v[156:157], v[76:77], v[40:55]
  v_exp_f32 v28, v28
  v_exp_f32 v29, v29
  v_exp_f32 v30, v30
  v_exp_f32 v31, v31
  v_smfmac_f32_32x32x32_bf16 v[80:95], v[168:171], v[16:23], v5
  buffer_load_dwordx4 v[248:251], v2, s[28:31], 0 offen offset:1024 sc1
  buffer_load_dwordx4 v[252:255], v2, s[28:31], 0 offen offset:2048 sc1
  buffer_load_dwordx4 v[240:243], v1, s[28:31], 0 offen offset:1024 sc1
  v_exp_f32 v32, v32
  v_exp_f32 v33, v33
  v_exp_f32 v34, v34
  v_exp_f32 v35, v35
  v_smfmac_f32_32x32x32_bf16 v[96:111], v[164:167], v[24:31], v5
  v_exp_f32 v36, v36
  v_exp_f32 v37, v37
  v_exp_f32 v38, v38
  v_exp_f32 v39, v39
  v_mfma_f32_32x32x16_bf16 v[8:23], v[144:147], v[68:71], 0
  v_exp_f32 v40, v40
  v_exp_f32 v41, v41
  v_exp_f32 v42, v42
  v_exp_f32 v43, v43
  v_mfma_f32_32x32x8_bf16 v[8:23], v[156:157], v[78:79], v[8:23]
  v_exp_f32 v44, v44
  v_exp_f32 v45, v45
  v_exp_f32 v46, v46
  v_exp_f32 v47, v47
  v_smfmac_f32_32x32x32_bf16 v[96:111], v[168:171], v[32:39], v5
  v_exp_f32 v48, v48
  v_exp_f32 v49, v49
  v_exp_f32 v50, v50
  v_exp_f32 v51, v51
  v_smfmac_f32_32x32x32_bf16 v[112:127], v[164:167], v[40:47], v5
  v_exp_f32 v52, v52
  v_exp_f32 v53, v53
  v_exp_f32 v54, v54
  v_exp_f32 v55, v55
  v_mfma_f32_32x32x16_bf16 v[24:39], v[148:151], v[56:59], 0
  v_exp_f32 v8, v8
  v_exp_f32 v9, v9
  v_exp_f32 v10, v10
  v_exp_f32 v11, v11
  v_mfma_f32_32x32x8_bf16 v[24:39], v[158:159], v[72:73], v[24:39]
  v_exp_f32 v12, v12
  v_exp_f32 v13, v13
  v_exp_f32 v14, v14
  v_exp_f32 v15, v15
  v_smfmac_f32_32x32x32_bf16 v[112:127], v[168:171], v[48:55], v5
  v_exp_f32 v16, v16
  v_exp_f32 v17, v17
  v_exp_f32 v18, v18
  v_exp_f32 v19, v19
  v_smfmac_f32_32x32x32_bf16 v[128:143], v[164:167], v[8:15], v5
  v_exp_f32 v20, v20
  v_exp_f32 v21, v21
  v_exp_f32 v22, v22
  v_exp_f32 v23, v23
  v_mfma_f32_32x32x16_bf16 v[40:55], v[148:151], v[60:63], 0
  s_add_u32 s74, s74, 2
  v_exp_f32 v24, v24
  v_exp_f32 v25, v25
  v_exp_f32 v26, v26
  v_exp_f32 v27, v27
  v_mfma_f32_32x32x8_bf16 v[40:55], v[158:159], v[74:75], v[40:55]
  v_exp_f32 v28, v28
  v_exp_f32 v29, v29
  v_exp_f32 v30, v30
  v_exp_f32 v31, v31
  v_smfmac_f32_32x32x32_bf16 v[128:143], v[168:171], v[16:23], v5
  v_exp_f32 v32, v32
  v_exp_f32 v33, v33
  v_exp_f32 v34, v34
  v_exp_f32 v35, v35
  v_smfmac_f32_32x32x32_bf16 v[80:95], v[172:175], v[24:31], v5
  v_exp_f32 v36, v36
  v_exp_f32 v37, v37
  v_exp_f32 v38, v38
  v_exp_f32 v39, v39
  v_mfma_f32_32x32x16_bf16 v[8:23], v[148:151], v[64:67], 0
  s_and_b32 s74, s74, 31
  v_exp_f32 v40, v40
  v_exp_f32 v41, v41
  v_exp_f32 v42, v42
  v_exp_f32 v43, v43
  v_mfma_f32_32x32x8_bf16 v[8:23], v[158:159], v[76:77], v[8:23]
  v_exp_f32 v44, v44
  v_exp_f32 v45, v45
  v_exp_f32 v46, v46
  v_exp_f32 v47, v47
  v_smfmac_f32_32x32x32_bf16 v[80:95], v[176:179], v[32:39], v5
  buffer_load_dwordx4 v[236:239], v1, s[44:47], s1 offen sc1
  v_exp_f32 v48, v48
  v_exp_f32 v49, v49
  v_exp_f32 v50, v50
  v_exp_f32 v51, v51
  v_smfmac_f32_32x32x32_bf16 v[96:111], v[172:175], v[40:47], v5
  v_exp_f32 v52, v52
  v_exp_f32 v53, v53
  v_exp_f32 v54, v54
  v_exp_f32 v55, v55
  v_mfma_f32_32x32x16_bf16 v[24:39], v[148:151], v[68:71], 0
  s_mul_i32 s72, s74, 7168
  v_exp_f32 v8, v8
  v_exp_f32 v9, v9
  v_exp_f32 v10, v10
  v_exp_f32 v11, v11
  v_mfma_f32_32x32x8_bf16 v[24:39], v[158:159], v[78:79], v[24:39]
  v_exp_f32 v12, v12
  v_exp_f32 v13, v13
  v_exp_f32 v14, v14
  v_exp_f32 v15, v15
  v_smfmac_f32_32x32x32_bf16 v[96:111], v[176:179], v[48:55], v5
  v_exp_f32 v16, v16
  v_exp_f32 v17, v17
  v_exp_f32 v18, v18
  v_exp_f32 v19, v19
  v_smfmac_f32_32x32x32_bf16 v[112:127], v[172:175], v[8:15], v5
  s_waitcnt vmcnt(4)
  v_exp_f32 v20, v20
  v_exp_f32 v21, v21
  v_exp_f32 v22, v22
  v_exp_f32 v23, v23
  v_mfma_f32_32x32x16_bf16 v[40:55], v[152:155], v[56:59], 0
  v_exp_f32 v24, v24
  v_exp_f32 v25, v25
  v_exp_f32 v26, v26
  v_exp_f32 v27, v27
  v_mfma_f32_32x32x8_bf16 v[40:55], v[160:161], v[72:73], v[40:55]
  v_exp_f32 v28, v28
  v_exp_f32 v29, v29
  v_exp_f32 v30, v30
  v_exp_f32 v31, v31
  v_smfmac_f32_32x32x32_bf16 v[112:127], v[176:179], v[16:23], v5
  v_exp_f32 v32, v32
  v_exp_f32 v33, v33
  v_exp_f32 v34, v34
  v_exp_f32 v35, v35
  v_smfmac_f32_32x32x32_bf16 v[128:143], v[172:175], v[24:31], v5
  v_exp_f32 v36, v36
  v_exp_f32 v37, v37
  v_exp_f32 v38, v38
  v_exp_f32 v39, v39
  v_mfma_f32_32x32x16_bf16 v[8:23], v[152:155], v[60:63], 0
  v_exp_f32 v40, v40
  v_exp_f32 v41, v41
  v_exp_f32 v42, v42
  v_exp_f32 v43, v43
  v_mfma_f32_32x32x8_bf16 v[8:23], v[160:161], v[74:75], v[8:23]
  v_exp_f32 v44, v44
  v_exp_f32 v45, v45
  v_exp_f32 v46, v46
  v_exp_f32 v47, v47
  v_smfmac_f32_32x32x32_bf16 v[128:143], v[176:179], v[32:39], v5
  v_exp_f32 v48, v48
  v_exp_f32 v49, v49
  v_exp_f32 v50, v50
  v_exp_f32 v51, v51
  v_smfmac_f32_32x32x32_bf16 v[80:95], v[180:183], v[40:47], v5
  s_lshl_b32 s13, s12, 1
  s_and_b32 s13, s13, 2
  s_lshl_b32 s22, 0x33333333, s13
  s_mov_b32 s23, s22
  s_waitcnt vmcnt(0)
  v_xor_b32 v236, s0, v236
  v_xor_b32 v237, s0, v237
  v_xor_b32 v238, s0, v238
  v_xor_b32 v239, s0, v239
  v_or3_b32 v236, v236, v237, v238
  v_or3_b32 v236, v236, v239, v239
  v_cmp_eq_u32 vcc, 0, v236
  s_nop 1
  s_and_b64 vcc, vcc, s[22:23]
  s_cmp_eq_u64 vcc, s[22:23]
  s_cbranch_scc0 Lkvs
Lkvd:
  s_add_u32 s28, s20, s72
  s_addc_u32 s29, s21, 0
  v_exp_f32 v52, v52
  v_exp_f32 v53, v53
  v_exp_f32 v54, v54
  v_exp_f32 v55, v55
  v_mfma_f32_32x32x16_bf16 v[24:39], v[152:155], v[64:67], 0
  s_add_u32 s74, s74, 2
  v_exp_f32 v8, v8
  v_exp_f32 v9, v9
  v_exp_f32 v10, v10
  v_exp_f32 v11, v11
  v_mfma_f32_32x32x8_bf16 v[24:39], v[160:161], v[76:77], v[24:39]
  v_exp_f32 v12, v12
  v_exp_f32 v13, v13
  v_exp_f32 v14, v14
  v_exp_f32 v15, v15
  v_smfmac_f32_32x32x32_bf16 v[80:95], v[184:187], v[48:55], v5
  buffer_load_dwordx4 v[164:167], v1, s[28:31], 0 offen offset:3072
  buffer_load_dwordx4 v[168:171], v2, s[28:31], 0 offen
  buffer_load_dwordx4 v[244:247], v1, s[28:31], 0 offen offset:2048
  buffer_load_dwordx4 v[144:147], v1, s[28:31], 0 offen offset:0
  v_exp_f32 v16, v16
  v_exp_f32 v17, v17
  v_exp_f32 v18, v18
  v_exp_f32 v19, v19
  v_smfmac_f32_32x32x32_bf16 v[96:111], v[180:183], v[8:15], v5
  v_exp_f32 v20, v20
  v_exp_f32 v21, v21
  v_exp_f32 v22, v22
  v_exp_f32 v23, v23
  v_mfma_f32_32x32x16_bf16 v[40:55], v[152:155], v[68:71], 0
  s_and_b32 s74, s74, 31
  v_exp_f32 v24, v24
  v_exp_f32 v25, v25
  v_exp_f32 v26, v26
  v_exp_f32 v27, v27
  v_mfma_f32_32x32x8_bf16 v[40:55], v[160:161], v[78:79], v[40:55]
  v_exp_f32 v28, v28
  v_exp_f32 v29, v29
  v_exp_f32 v30, v30
  v_exp_f32 v31, v31
  v_smfmac_f32_32x32x32_bf16 v[96:111], v[184:187], v[16:23], v5
  buffer_load_dwordx4 v[172:175], v2, s[28:31], 0 offen offset:1024
  buffer_load_dwordx4 v[176:179], v2, s[28:31], 0 offen offset:2048
  buffer_load_dwordx4 v[148:151], v1, s[28:31], 0 offen offset:1024
  v_exp_f32 v32, v32
  v_exp_f32 v33, v33
  v_exp_f32 v34, v34
  v_exp_f32 v35, v35
  v_smfmac_f32_32x32x32_bf16 v[112:127], v[180:183], v[24:31], v5
  s_mov_b32 s18, 67584
  v_exp_f32 v36, v36
  v_exp_f32 v37, v37
  v_exp_f32 v38, v38
  v_exp_f32 v39, v39
  v_mfma_f32_32x32x16_bf16 v[8:23], v[240:243], v[56:59], 0
  s_mul_i32 s72, s74, 7168
  v_exp_f32 v40, v40
  v_exp_f32 v41, v41
  v_exp_f32 v42, v42
  v_exp_f32 v43, v43
  v_mfma_f32_32x32x8_bf16 v[8:23], v[162:163], v[72:73], v[8:23]
  v_exp_f32 v44, v44
  v_exp_f32 v45, v45
  v_exp_f32 v46, v46
  v_exp_f32 v47, v47
  v_smfmac_f32_32x32x32_bf16 v[112:127], v[184:187], v[32:39], v5
  buffer_load_dwordx4 v[188:191], v1, s[44:47], s18 offen offset:0 sc1
  buffer_load_dwordx4 v[192:195], v1, s[44:47], s18 offen offset:1024 sc1
  buffer_load_dwordx4 v[196:199], v1, s[44:47], s18 offen offset:2048 sc1
  buffer_load_dwordx4 v[200:203], v1, s[44:47], s18 offen offset:3072 sc1
  v_exp_f32 v48, v48
  v_exp_f32 v49, v49
  v_exp_f32 v50, v50
  v_exp_f32 v51, v51
  v_smfmac_f32_32x32x32_bf16 v[128:143], v[180:183], v[40:47], v5
  s_lshl_b32 s19, s11, 2
  v_exp_f32 v52, v52
  v_exp_f32 v53, v53
  v_exp_f32 v54, v54
  v_exp_f32 v55, v55
  v_mfma_f32_32x32x16_bf16 v[24:39], v[240:243], v[60:63], 0
  s_add_u32 s19, s19, s12
  v_exp_f32 v8, v8
  v_exp_f32 v9, v9
  v_exp_f32 v10, v10
  v_exp_f32 v11, v11
  v_mfma_f32_32x32x8_bf16 v[24:39], v[162:163], v[74:75], v[24:39]
  v_exp_f32 v12, v12
  v_exp_f32 v13, v13
  v_exp_f32 v14, v14
  v_exp_f32 v15, v15
  v_smfmac_f32_32x32x32_bf16 v[128:143], v[184:187], v[48:55], v5
  v_exp_f32 v16, v16
  v_exp_f32 v17, v17
  v_exp_f32 v18, v18
  v_exp_f32 v19, v19
  v_smfmac_f32_32x32x32_bf16 v[80:95], v[248:251], v[8:15], v5
  s_add_u32 s28, s20, s72
  s_addc_u32 s29, s21, 0
  v_exp_f32 v20, v20
  v_exp_f32 v21, v21
  v_exp_f32 v22, v22
  v_exp_f32 v23, v23
  v_mfma_f32_32x32x16_bf16 v[40:55], v[240:243], v[64:67], 0
  s_lshl_b32 s19, s19, 10
  v_exp_f32 v24, v24
  v_exp_f32 v25, v25
  v_exp_f32 v26, v26
  v_exp_f32 v27, v27
  v_mfma_f32_32x32x8_bf16 v[40:55], v[162:163], v[76:77], v[40:55]
  v_exp_f32 v28, v28
  v_exp_f32 v29, v29
  v_exp_f32 v30, v30
  v_exp_f32 v31, v31
  v_smfmac_f32_32x32x32_bf16 v[80:95], v[252:255], v[16:23], v5
  buffer_load_dwordx4 v[180:183], v1, s[28:31], 0 offen offset:3072
  buffer_load_dwordx4 v[184:187], v2, s[28:31], 0 offen
  buffer_load_dwordx4 v[156:159], v1, s[28:31], 0 offen offset:2048
  buffer_load_dwordx4 v[152:155], v1, s[28:31], 0 offen offset:0
  v_exp_f32 v32, v32
  v_exp_f32 v33, v33
  v_exp_f32 v34, v34
  v_exp_f32 v35, v35
  v_smfmac_f32_32x32x32_bf16 v[96:111], v[248:251], v[24:31], v5
  s_mul_i32 s14, s10, 7168
  v_exp_f32 v36, v36
  v_exp_f32 v37, v37
  v_exp_f32 v38, v38
  v_exp_f32 v39, v39
  v_mfma_f32_32x32x16_bf16 v[8:23], v[240:243], v[68:71], 0
  s_add_u32 s14, s14, 41418752
  v_exp_f32 v40, v40
  v_exp_f32 v41, v41
  v_exp_f32 v42, v42
  v_exp_f32 v43, v43
  v_mfma_f32_32x32x8_bf16 v[8:23], v[162:163], v[78:79], v[8:23]
  v_exp_f32 v44, v44
  v_exp_f32 v45, v45
  v_exp_f32 v46, v46
  v_exp_f32 v47, v47
  v_smfmac_f32_32x32x32_bf16 v[96:111], v[252:255], v[32:39], v5
  v_exp_f32 v48, v48
  v_exp_f32 v49, v49
  v_exp_f32 v50, v50
  v_exp_f32 v51, v51
  v_smfmac_f32_32x32x32_bf16 v[112:127], v[248:251], v[40:47], v5
  s_waitcnt vmcnt(11)
  v_exp_f32 v52, v52
  v_exp_f32 v53, v53
  v_exp_f32 v54, v54
  v_exp_f32 v55, v55
  v_mfma_f32_32x32x16_bf16 v[24:39], v[144:147], v[56:59], 0
  v_exp_f32 v8, v8
  v_exp_f32 v9, v9
  v_exp_f32 v10, v10
  v_exp_f32 v11, v11
  v_mfma_f32_32x32x8_bf16 v[24:39], v[244:245], v[72:73], v[24:39]
  v_exp_f32 v12, v12
  v_exp_f32 v13, v13
  v_exp_f32 v14, v14
  v_exp_f32 v15, v15
  v_smfmac_f32_32x32x32_bf16 v[112:127], v[252:255], v[48:55], v5
  s_add_u32 s48, s4, s14
  s_addc_u32 s49, s5, 0
  v_exp_f32 v16, v16
  v_exp_f32 v17, v17
  v_exp_f32 v18, v18
  v_exp_f32 v19, v19
  v_smfmac_f32_32x32x32_bf16 v[128:143], v[248:251], v[8:15], v5
  s_cmp_eq_u32 s3, 1
  s_cselect_b64 s[22:23], -1, 0
  s_waitcnt vmcnt(7)
  v_xor_b32 v188, s0, v188
  v_xor_b32 v189, s0, v189
  v_xor_b32 v190, s0, v190
  v_xor_b32 v191, s0, v191
  s_waitcnt vmcnt(6)
  v_xor_b32 v192, s0, v192
  v_xor_b32 v193, s0, v193
  v_xor_b32 v194, s0, v194
  v_xor_b32 v195, s0, v195
  s_waitcnt vmcnt(5)
  v_xor_b32 v196, s0, v196
  v_xor_b32 v197, s0, v197
  v_xor_b32 v198, s0, v198
  v_xor_b32 v199, s0, v199
  s_waitcnt vmcnt(4)
  v_xor_b32 v200, s0, v200
  v_xor_b32 v201, s0, v201
  v_xor_b32 v202, s0, v202
  v_xor_b32 v203, s0, v203
  v_or3_b32 v188, v188, v189, v190
  v_or3_b32 v188, v188, v191, v192
  v_or3_b32 v188, v188, v193, v194
  v_or3_b32 v188, v188, v195, v196
  v_or3_b32 v188, v188, v197, v198
  v_or3_b32 v188, v188, v199, v200
  v_or3_b32 v188, v188, v201, v202
  v_or3_b32 v188, v188, v203, v203
  v_cmp_eq_u32 vcc, 0, v188
  s_nop 1
  s_and_b64 vcc, vcc, s[22:23]
  s_cmp_eq_u64 vcc, s[22:23]
  s_cbranch_scc0 Lrls
Lrld:
  v_exp_f32 v20, v20
  v_exp_f32 v21, v21
  v_exp_f32 v22, v22
  v_exp_f32 v23, v23
  v_mfma_f32_32x32x16_bf16 v[40:55], v[144:147], v[60:63], 0
  s_mov_b32 s50, 7168
  v_exp_f32 v24, v24
  v_exp_f32 v25, v25
  v_exp_f32 v26, v26
  v_exp_f32 v27, v27
  v_mfma_f32_32x32x8_bf16 v[40:55], v[244:245], v[74:75], v[40:55]
  v_exp_f32 v28, v28
  v_exp_f32 v29, v29
  v_exp_f32 v30, v30
  v_exp_f32 v31, v31
  v_smfmac_f32_32x32x32_bf16 v[128:143], v[252:255], v[16:23], v5
  v_exp_f32 v32, v32
  v_exp_f32 v33, v33
  v_exp_f32 v34, v34
  v_exp_f32 v35, v35
  v_smfmac_f32_32x32x32_bf16 v[80:95], v[164:167], v[24:31], v5
  s_mul_i32 s87, s12, 15360
  v_exp_f32 v36, v36
  v_exp_f32 v37, v37
  v_exp_f32 v38, v38
  v_exp_f32 v39, v39
  v_mfma_f32_32x32x16_bf16 v[8:23], v[144:147], v[64:67], 0
  s_add_u32 s74, s74, 2
  v_exp_f32 v40, v40
  v_exp_f32 v41, v41
  v_exp_f32 v42, v42
  v_exp_f32 v43, v43
  v_mfma_f32_32x32x8_bf16 v[8:23], v[244:245], v[76:77], v[8:23]
  v_exp_f32 v44, v44
  v_exp_f32 v45, v45
  v_exp_f32 v46, v46
  v_exp_f32 v47, v47
  v_smfmac_f32_32x32x32_bf16 v[80:95], v[168:171], v[32:39], v5
  buffer_load_dwordx4 v[248:251], v2, s[28:31], 0 offen offset:1024
  buffer_load_dwordx4 v[252:255], v2, s[28:31], 0 offen offset:2048
  buffer_load_dwordx4 v[240:243], v1, s[28:31], 0 offen offset:1024
  v_exp_f32 v48, v48
  v_exp_f32 v49, v49
  v_exp_f32 v50, v50
  v_exp_f32 v51, v51
  v_smfmac_f32_32x32x32_bf16 v[96:111], v[164:167], v[40:47], v5
  s_add_u32 s87, s87, 111616
  v_exp_f32 v52, v52
  v_exp_f32 v53, v53
  v_exp_f32 v54, v54
  v_exp_f32 v55, v55
  v_mfma_f32_32x32x16_bf16 v[24:39], v[144:147], v[68:71], 0
  s_and_b32 s74, s74, 31
  v_exp_f32 v8, v8
  v_exp_f32 v9, v9
  v_exp_f32 v10, v10
  v_exp_f32 v11, v11
  v_mfma_f32_32x32x8_bf16 v[24:39], v[244:245], v[78:79], v[24:39]
  v_exp_f32 v12, v12
  v_exp_f32 v13, v13
  v_exp_f32 v14, v14
  v_exp_f32 v15, v15
  v_smfmac_f32_32x32x32_bf16 v[96:111], v[168:171], v[48:55], v5
  buffer_load_dwordx4 v[188:191], v1, s[32:35], 0 offen offset:0
  buffer_load_dwordx4 v[192:195], v1, s[32:35], 0 offen offset:1024
  v_exp_f32 v16, v16
  v_exp_f32 v17, v17
  v_exp_f32 v18, v18
  v_exp_f32 v19, v19
  v_smfmac_f32_32x32x32_bf16 v[112:127], v[164:167], v[8:15], v5
  v_exp_f32 v20, v20
  v_exp_f32 v21, v21
  v_exp_f32 v22, v22
  v_exp_f32 v23, v23
  v_mfma_f32_32x32x16_bf16 v[40:55], v[148:151], v[56:59], 0
  s_mul_i32 s72, s74, 7168
  v_exp_f32 v24, v24
  v_exp_f32 v25, v25
  v_exp_f32 v26, v26
  v_exp_f32 v27, v27
  v_mfma_f32_32x32x8_bf16 v[40:55], v[246:247], v[72:73], v[40:55]
  v_exp_f32 v28, v28
  v_exp_f32 v29, v29
  v_exp_f32 v30, v30
  v_exp_f32 v31, v31
  v_smfmac_f32_32x32x32_bf16 v[112:127], v[168:171], v[16:23], v5
  buffer_load_dwordx4 v[196:199], v1, s[32:35], 0 offen offset:2048
  buffer_load_dwordx4 v[200:203], v1, s[32:35], 0 offen offset:3072
  v_exp_f32 v32, v32
  v_exp_f32 v33, v33
  v_exp_f32 v34, v34
  v_exp_f32 v35, v35
  v_smfmac_f32_32x32x32_bf16 v[128:143], v[164:167], v[24:31], v5
  s_xor_b32 s91, s12, 1
  v_exp_f32 v36, v36
  v_exp_f32 v37, v37
  v_exp_f32 v38, v38
  v_exp_f32 v39, v39
  v_mfma_f32_32x32x16_bf16 v[8:23], v[148:151], v[60:63], 0
  s_mul_i32 s91, s91, 15360
  v_exp_f32 v40, v40
  v_exp_f32 v41, v41
  v_exp_f32 v42, v42
  v_exp_f32 v43, v43
  v_mfma_f32_32x32x8_bf16 v[8:23], v[246:247], v[74:75], v[8:23]
  v_exp_f32 v44, v44
  v_exp_f32 v45, v45
  v_exp_f32 v46, v46
  v_exp_f32 v47, v47
  v_smfmac_f32_32x32x32_bf16 v[128:143], v[168:171], v[32:39], v5
  buffer_load_dwordx4 v[204:207], v2, s[32:35], 0 offen offset:0
  buffer_load_dwordx4 v[208:211], v2, s[32:35], 0 offen offset:1024
  v_exp_f32 v48, v48
  v_exp_f32 v49, v49
  v_exp_f32 v50, v50
  v_exp_f32 v51, v51
  v_smfmac_f32_32x32x32_bf16 v[80:95], v[172:175], v[40:47], v5
  s_add_u32 s28, s20, s72
  s_addc_u32 s29, s21, 0
  v_exp_f32 v52, v52
  v_exp_f32 v53, v53
  v_exp_f32 v54, v54
  v_exp_f32 v55, v55
  v_mfma_f32_32x32x16_bf16 v[24:39], v[148:151], v[64:67], 0
  s_add_u32 s91, s91, 111616
  v_exp_f32 v8, v8
  v_exp_f32 v9, v9
  v_exp_f32 v10, v10
  v_exp_f32 v11, v11
  v_mfma_f32_32x32x8_bf16 v[24:39], v[246:247], v[76:77], v[24:39]
  v_exp_f32 v12, v12
  v_exp_f32 v13, v13
  v_exp_f32 v14, v14
  v_exp_f32 v15, v15
  v_smfmac_f32_32x32x32_bf16 v[80:95], v[176:179], v[48:55], v5
  buffer_load_dwordx4 v[164:167], v1, s[28:31], 0 offen offset:3072
  buffer_load_dwordx4 v[168:171], v2, s[28:31], 0 offen
  buffer_load_dwordx4 v[160:163], v1, s[28:31], 0 offen offset:2048
  buffer_load_dwordx4 v[144:147], v1, s[28:31], 0 offen offset:0
  v_exp_f32 v16, v16
  v_exp_f32 v17, v17
  v_exp_f32 v18, v18
  v_exp_f32 v19, v19
  v_smfmac_f32_32x32x32_bf16 v[96:111], v[172:175], v[8:15], v5
  s_mul_i32 s13, s11, 276480
  v_exp_f32 v20, v20
  v_exp_f32 v21, v21
  v_exp_f32 v22, v22
  v_exp_f32 v23, v23
  v_mfma_f32_32x32x16_bf16 v[40:55], v[148:151], v[68:71], 0
  s_mul_i32 s14, s12, 71680
  v_exp_f32 v24, v24
  v_exp_f32 v25, v25
  v_exp_f32 v26, v26
  v_exp_f32 v27, v27
  v_mfma_f32_32x32x8_bf16 v[40:55], v[246:247], v[78:79], v[40:55]
  v_exp_f32 v28, v28
  v_exp_f32 v29, v29
  v_exp_f32 v30, v30
  v_exp_f32 v31, v31
  v_smfmac_f32_32x32x32_bf16 v[96:111], v[176:179], v[16:23], v5
  buffer_load_dwordx4 v[212:215], v2, s[32:35], 0 offen offset:2048
  buffer_load_dwordx4 v[216:219], v2, s[32:35], 0 offen offset:3072
  v_exp_f32 v32, v32
  v_exp_f32 v33, v33
  v_exp_f32 v34, v34
  v_exp_f32 v35, v35
  v_smfmac_f32_32x32x32_bf16 v[112:127], v[172:175], v[24:31], v5
  s_add_u32 s32, s32, 8192
  s_addc_u32 s33, s33, 0
  s_waitcnt vmcnt(15)
  v_exp_f32 v36, v36
  v_exp_f32 v37, v37
  v_exp_f32 v38, v38
  v_exp_f32 v39, v39
  v_mfma_f32_32x32x16_bf16 v[8:23], v[152:155], v[56:59], 0
  s_add_u32 s13, s13, s14
  v_exp_f32 v40, v40
  v_exp_f32 v41, v41
  v_exp_f32 v42, v42
  v_exp_f32 v43, v43
  v_mfma_f32_32x32x8_bf16 v[8:23], v[156:157], v[72:73], v[8:23]
  v_exp_f32 v44, v44
  v_exp_f32 v45, v45
  v_exp_f32 v46, v46
  v_exp_f32 v47, v47
  v_smfmac_f32_32x32x32_bf16 v[112:127], v[176:179], v[32:39], v5
  buffer_load_dwordx4 v[220:223], v1, s[32:35], 0 offen offset:0
  buffer_load_dwordx4 v[224:227], v1, s[32:35], 0 offen offset:1024
  v_exp_f32 v48, v48
  v_exp_f32 v49, v49
  v_exp_f32 v50, v50
  v_exp_f32 v51, v51
  v_smfmac_f32_32x32x32_bf16 v[128:143], v[172:175], v[40:47], v5
  s_add_u32 s13, s13, 5242880
  v_exp_f32 v52, v52
  v_exp_f32 v53, v53
  v_exp_f32 v54, v54
  v_exp_f32 v55, v55
  v_mfma_f32_32x32x16_bf16 v[24:39], v[152:155], v[60:63], 0
  s_sub_u32 s90, 276480, s14
  v_exp_f32 v8, v8
  v_exp_f32 v9, v9
  v_exp_f32 v10, v10
  v_exp_f32 v11, v11
  v_mfma_f32_32x32x8_bf16 v[24:39], v[156:157], v[74:75], v[24:39]
  v_exp_f32 v12, v12
  v_exp_f32 v13, v13
  v_exp_f32 v14, v14
  v_exp_f32 v15, v15
  v_smfmac_f32_32x32x32_bf16 v[128:143], v[176:179], v[48:55], v5
  buffer_load_dwordx4 v[228:231], v1, s[32:35], 0 offen offset:2048
  buffer_load_dwordx4 v[232:235], v1, s[32:35], 0 offen offset:3072
  v_exp_f32 v16, v16
  v_exp_f32 v17, v17
  v_exp_f32 v18, v18
  v_exp_f32 v19, v19
  v_smfmac_f32_32x32x32_bf16 v[80:95], v[180:183], v[8:15], v5
  s_add_u32 s88, s4, s13
  s_addc_u32 s89, s5, 0
  v_exp_f32 v20, v20
  v_exp_f32 v21, v21
  v_exp_f32 v22, v22
  v_exp_f32 v23, v23
  v_mfma_f32_32x32x16_bf16 v[40:55], v[152:155], v[64:67], 0
  s_add_u32 s74, s74, 2
  v_exp_f32 v24, v24
  v_exp_f32 v25, v25
  v_exp_f32 v26, v26
  v_exp_f32 v27, v27
  v_mfma_f32_32x32x8_bf16 v[40:55], v[156:157], v[76:77], v[40:55]
  v_exp_f32 v28, v28
  v_exp_f32 v29, v29
  v_exp_f32 v30, v30
  v_exp_f32 v31, v31
  v_smfmac_f32_32x32x32_bf16 v[80:95], v[184:187], v[16:23], v5
  buffer_load_dwordx4 v[172:175], v2, s[28:31], 0 offen offset:1024
  buffer_load_dwordx4 v[176:179], v2, s[28:31], 0 offen offset:2048
  buffer_load_dwordx4 v[148:151], v1, s[28:31], 0 offen offset:1024
  v_exp_f32 v32, v32
  v_exp_f32 v33, v33
  v_exp_f32 v34, v34
  v_exp_f32 v35, v35
  v_smfmac_f32_32x32x32_bf16 v[96:111], v[180:183], v[24:31], v5
  s_mov_b32 s51, 0x20000
  v_exp_f32 v36, v36
  v_exp_f32 v37, v37
  v_exp_f32 v38, v38
  v_exp_f32 v39, v39
  v_mfma_f32_32x32x16_bf16 v[8:23], v[152:155], v[68:71], 0
  s_and_b32 s74, s74, 31
  v_exp_f32 v40, v40
  v_exp_f32 v41, v41
  v_exp_f32 v42, v42
  v_exp_f32 v43, v43
  v_mfma_f32_32x32x8_bf16 v[8:23], v[156:157], v[78:79], v[8:23]
  v_exp_f32 v44, v44
  v_exp_f32 v45, v45
  v_exp_f32 v46, v46
  v_exp_f32 v47, v47
  v_smfmac_f32_32x32x32_bf16 v[96:111], v[184:187], v[32:39], v5
  v_exp_f32 v48, v48
  v_exp_f32 v49, v49
  v_exp_f32 v50, v50
  v_exp_f32 v51, v51
  v_smfmac_f32_32x32x32_bf16 v[112:127], v[180:183], v[40:47], v5
  s_waitcnt vmcnt(19)
  v_exp_f32 v52, v52
  v_exp_f32 v53, v53
  v_exp_f32 v54, v54
  v_exp_f32 v55, v55
  v_mfma_f32_32x32x16_bf16 v[24:39], v[240:243], v[56:59], 0
  s_mul_i32 s72, s74, 7168
  v_exp_f32 v8, v8
  v_exp_f32 v9, v9
  v_exp_f32 v10, v10
  v_exp_f32 v11, v11
  v_mfma_f32_32x32x8_bf16 v[24:39], v[158:159], v[72:73], v[24:39]
  v_exp_f32 v12, v12
  v_exp_f32 v13, v13
  v_exp_f32 v14, v14
  v_exp_f32 v15, v15
  v_smfmac_f32_32x32x32_bf16 v[112:127], v[184:187], v[48:55], v5
  buffer_load_dwordx4 v[236:239], v2, s[32:35], 0 offen offset:0
  buffer_load_dwordx4 a[0:3], v2, s[32:35], 0 offen offset:1024
  v_exp_f32 v16, v16
  v_exp_f32 v17, v17
  v_exp_f32 v18, v18
  v_exp_f32 v19, v19
  v_smfmac_f32_32x32x32_bf16 v[128:143], v[180:183], v[8:15], v5
  s_lshl_b32 s85, s12, 11
  v_exp_f32 v20, v20
  v_exp_f32 v21, v21
  v_exp_f32 v22, v22
  v_exp_f32 v23, v23
  v_mfma_f32_32x32x16_bf16 v[40:55], v[240:243], v[60:63], 0
  s_lshr_b32 s15, s12, 1
  v_exp_f32 v24, v24
  v_exp_f32 v25, v25
  v_exp_f32 v26, v26
  v_exp_f32 v27, v27
  v_mfma_f32_32x32x8_bf16 v[40:55], v[158:159], v[74:75], v[40:55]
  v_exp_f32 v28, v28
  v_exp_f32 v29, v29
  v_exp_f32 v30, v30
  v_exp_f32 v31, v31
  v_smfmac_f32_32x32x32_bf16 v[128:143], v[184:187], v[16:23], v5
  buffer_load_dwordx4 a[4:7], v2, s[32:35], 0 offen offset:2048
  buffer_load_dwordx4 a[8:11], v2, s[32:35], 0 offen offset:3072
  v_exp_f32 v32, v32
  v_exp_f32 v33, v33
  v_exp_f32 v34, v34
  v_exp_f32 v35, v35
  v_smfmac_f32_32x32x32_bf16 v[80:95], v[248:251], v[24:31], v5
  s_add_u32 s28, s20, s72
  s_addc_u32 s29, s21, 0
  v_exp_f32 v36, v36
  v_exp_f32 v37, v37
  v_exp_f32 v38, v38
  v_exp_f32 v39, v39
  v_mfma_f32_32x32x16_bf16 v[8:23], v[240:243], v[64:67], 0
  s_lshl_b32 s15, s15, 10
  v_exp_f32 v40, v40
  v_exp_f32 v41, v41
  v_exp_f32 v42, v42
  v_exp_f32 v43, v43
  v_mfma_f32_32x32x8_bf16 v[8:23], v[158:159], v[76:77], v[8:23]
  v_exp_f32 v44, v44
  v_exp_f32 v45, v45
  v_exp_f32 v46, v46
  v_exp_f32 v47, v47
  v_smfmac_f32_32x32x32_bf16 v[80:95], v[252:255], v[32:39], v5
  buffer_load_dwordx4 v[180:183], v1, s[28:31], 0 offen offset:3072
  buffer_load_dwordx4 v[184:187], v2, s[28:31], 0 offen
  buffer_load_dwordx4 v[244:247], v1, s[28:31], 0 offen offset:2048
  buffer_load_dwordx4 v[152:155], v1, s[28:31], 0 offen offset:0
  v_exp_f32 v48, v48
  v_exp_f32 v49, v49
  v_exp_f32 v50, v50
  v_exp_f32 v51, v51
  v_smfmac_f32_32x32x32_bf16 v[96:111], v[248:251], v[40:47], v5
  s_add_u32 s32, s32, 8192
  s_addc_u32 s33, s33, 0
  v_exp_f32 v52, v52
  v_exp_f32 v53, v53
  v_exp_f32 v54, v54
  v_exp_f32 v55, v55
  v_mfma_f32_32x32x16_bf16 v[24:39], v[240:243], v[68:71], 0
  s_and_b32 s17, s12, 1
  v_exp_f32 v8, v8
  v_exp_f32 v9, v9
  v_exp_f32 v10, v10
  v_exp_f32 v11, v11
  v_mfma_f32_32x32x8_bf16 v[24:39], v[158:159], v[78:79], v[24:39]
  v_exp_f32 v12, v12
  v_exp_f32 v13, v13
  v_exp_f32 v14, v14
  v_exp_f32 v15, v15
  v_smfmac_f32_32x32x32_bf16 v[96:111], v[252:255], v[48:55], v5
  buffer_load_dwordx4 a[12:15], v1, s[32:35], 0 offen offset:0
  buffer_load_dwordx4 a[16:19], v1, s[32:35], 0 offen offset:1024
  v_exp_f32 v16, v16
  v_exp_f32 v17, v17
  v_exp_f32 v18, v18
  v_exp_f32 v19, v19
  v_smfmac_f32_32x32x32_bf16 v[112:127], v[248:251], v[8:15], v5
  s_waitcnt vmcnt(19)
  v_exp_f32 v20, v20
  v_exp_f32 v21, v21
  v_exp_f32 v22, v22
  v_exp_f32 v23, v23
  v_mfma_f32_32x32x16_bf16 v[40:55], v[144:147], v[56:59], 0
  s_lshl_b32 s17, s17, 3
  v_exp_f32 v24, v24
  v_exp_f32 v25, v25
  v_exp_f32 v26, v26
  v_exp_f32 v27, v27
  v_mfma_f32_32x32x8_bf16 v[40:55], v[160:161], v[72:73], v[40:55]
  v_exp_f32 v28, v28
  v_exp_f32 v29, v29
  v_exp_f32 v30, v30
  v_exp_f32 v31, v31
  v_smfmac_f32_32x32x32_bf16 v[112:127], v[252:255], v[16:23], v5
  buffer_load_dwordx4 a[20:23], v1, s[32:35], 0 offen offset:2048
  buffer_load_dwordx4 a[24:27], v1, s[32:35], 0 offen offset:3072
  v_exp_f32 v32, v32
  v_exp_f32 v33, v33
  v_exp_f32 v34, v34
  v_exp_f32 v35, v35
  v_smfmac_f32_32x32x32_bf16 v[128:143], v[248:251], v[24:31], v5
  s_add_u32 s15, s15, s17
  v_exp_f32 v36, v36
  v_exp_f32 v37, v37
  v_exp_f32 v38, v38
  v_exp_f32 v39, v39
  v_mfma_f32_32x32x16_bf16 v[8:23], v[144:147], v[60:63], 0
  s_add_u32 s86, s15, 8192
  v_exp_f32 v40, v40
  v_exp_f32 v41, v41
  v_exp_f32 v42, v42
  v_exp_f32 v43, v43
  v_mfma_f32_32x32x8_bf16 v[8:23], v[160:161], v[74:75], v[8:23]
  v_exp_f32 v44, v44
  v_exp_f32 v45, v45
  v_exp_f32 v46, v46
  v_exp_f32 v47, v47
  v_smfmac_f32_32x32x32_bf16 v[128:143], v[252:255], v[32:39], v5
  buffer_load_dwordx4 a[28:31], v2, s[32:35], 0 offen offset:0
  buffer_load_dwordx4 a[32:35], v2, s[32:35], 0 offen offset:1024
  v_exp_f32 v48, v48
  v_exp_f32 v49, v49
  v_exp_f32 v50, v50
  v_exp_f32 v51, v51
  v_smfmac_f32_32x32x32_bf16 v[80:95], v[164:167], v[40:47], v5
  s_mul_i32 s81, s12, 2560
  v_exp_f32 v52, v52
  v_exp_f32 v53, v53
  v_exp_f32 v54, v54
  v_exp_f32 v55, v55
  v_mfma_f32_32x32x16_bf16 v[24:39], v[144:147], v[64:67], 0
  s_add_u32 s74, s74, 2
  v_exp_f32 v8, v8
  v_exp_f32 v9, v9
  v_exp_f32 v10, v10
  v_exp_f32 v11, v11
  v_mfma_f32_32x32x8_bf16 v[24:39], v[160:161], v[76:77], v[24:39]
  v_exp_f32 v12, v12
  v_exp_f32 v13, v13
  v_exp_f32 v14, v14
  v_exp_f32 v15, v15
  v_smfmac_f32_32x32x32_bf16 v[80:95], v[168:171], v[48:55], v5
  buffer_load_dwordx4 v[248:251], v2, s[28:31], 0 offen offset:1024
  buffer_load_dwordx4 v[252:255], v2, s[28:31], 0 offen offset:2048
  buffer_load_dwordx4 v[240:243], v1, s[28:31], 0 offen offset:1024
  v_exp_f32 v16, v16
  v_exp_f32 v17, v17
  v_exp_f32 v18, v18
  v_exp_f32 v19, v19
  v_smfmac_f32_32x32x32_bf16 v[96:111], v[164:167], v[8:15], v5
  s_add_u32 s56, s4, 16777216
  s_addc_u32 s57, s5, 0
  v_exp_f32 v20, v20
  v_exp_f32 v21, v21
  v_exp_f32 v22, v22
  v_exp_f32 v23, v23
  v_mfma_f32_32x32x16_bf16 v[40:55], v[144:147], v[68:71], 0
  s_and_b32 s74, s74, 31
  v_exp_f32 v24, v24
  v_exp_f32 v25, v25
  v_exp_f32 v26, v26
  v_exp_f32 v27, v27
  v_mfma_f32_32x32x8_bf16 v[40:55], v[160:161], v[78:79], v[40:55]
  v_exp_f32 v28, v28
  v_exp_f32 v29, v29
  v_exp_f32 v30, v30
  v_exp_f32 v31, v31
  v_smfmac_f32_32x32x32_bf16 v[96:111], v[168:171], v[16:23], v5
  v_exp_f32 v32, v32
  v_exp_f32 v33, v33
  v_exp_f32 v34, v34
  v_exp_f32 v35, v35
  v_smfmac_f32_32x32x32_bf16 v[112:127], v[164:167], v[24:31], v5
  s_waitcnt vmcnt(17)
  v_exp_f32 v36, v36
  v_exp_f32 v37, v37
  v_exp_f32 v38, v38
  v_exp_f32 v39, v39
  v_mfma_f32_32x32x16_bf16 v[8:23], v[148:151], v[56:59], 0
  s_mul_i32 s72, s74, 7168
  v_exp_f32 v40, v40
  v_exp_f32 v41, v41
  v_exp_f32 v42, v42
  v_exp_f32 v43, v43
  v_mfma_f32_32x32x8_bf16 v[8:23], v[162:163], v[72:73], v[8:23]
  v_exp_f32 v44, v44
  v_exp_f32 v45, v45
  v_exp_f32 v46, v46
  v_exp_f32 v47, v47
  v_smfmac_f32_32x32x32_bf16 v[112:127], v[168:171], v[32:39], v5
  buffer_load_dwordx4 a[36:39], v2, s[32:35], 0 offen offset:2048
  buffer_load_dwordx4 a[40:43], v2, s[32:35], 0 offen offset:3072
  v_exp_f32 v48, v48
  v_exp_f32 v49, v49
  v_exp_f32 v50, v50
  v_exp_f32 v51, v51
  v_smfmac_f32_32x32x32_bf16 v[128:143], v[164:167], v[40:47], v5
  s_add_u32 s32, s32, 8192
  s_addc_u32 s33, s33, 0
  v_exp_f32 v52, v52
  v_exp_f32 v53, v53
  v_exp_f32 v54, v54
  v_exp_f32 v55, v55
  v_mfma_f32_32x32x16_bf16 v[24:39], v[148:151], v[60:63], 0
  s_mov_b32 s58, 0x300000
  v_exp_f32 v8, v8
  v_exp_f32 v9, v9
  v_exp_f32 v10, v10
  v_exp_f32 v11, v11
  v_mfma_f32_32x32x8_bf16 v[24:39], v[162:163], v[74:75], v[24:39]
  v_exp_f32 v12, v12
  v_exp_f32 v13, v13
  v_exp_f32 v14, v14
  v_exp_f32 v15, v15
  v_smfmac_f32_32x32x32_bf16 v[128:143], v[168:171], v[48:55], v5
  buffer_load_dwordx4 a[44:47], v1, s[32:35], 0 offen offset:0
  buffer_load_dwordx4 a[48:51], v1, s[32:35], 0 offen offset:1024
  v_exp_f32 v16, v16
  v_exp_f32 v17, v17
  v_exp_f32 v18, v18
  v_exp_f32 v19, v19
  v_smfmac_f32_32x32x32_bf16 v[80:95], v[172:175], v[8:15], v5
  s_add_u32 s28, s20, s72
  s_addc_u32 s29, s21, 0
  v_exp_f32 v20, v20
  v_exp_f32 v21, v21
  v_exp_f32 v22, v22
  v_exp_f32 v23, v23
  v_mfma_f32_32x32x16_bf16 v[40:55], v[148:151], v[64:67], 0
  s_mov_b32 s59, 0x20000
  v_exp_f32 v24, v24
  v_exp_f32 v25, v25
  v_exp_f32 v26, v26
  v_exp_f32 v27, v27
  v_mfma_f32_32x32x8_bf16 v[40:55], v[162:163], v[76:77], v[40:55]
  v_exp_f32 v28, v28
  v_exp_f32 v29, v29
  v_exp_f32 v30, v30
  v_exp_f32 v31, v31
  v_smfmac_f32_32x32x32_bf16 v[80:95], v[176:179], v[16:23], v5
  buffer_load_dwordx4 v[164:167], v1, s[28:31], 0 offen offset:3072
  buffer_load_dwordx4 v[168:171], v2, s[28:31], 0 offen
  buffer_load_dwordx4 v[156:159], v1, s[28:31], 0 offen offset:2048
  buffer_load_dwordx4 v[144:147], v1, s[28:31], 0 offen offset:0
  v_exp_f32 v32, v32
  v_exp_f32 v33, v33
  v_exp_f32 v34, v34
  v_exp_f32 v35, v35
  v_smfmac_f32_32x32x32_bf16 v[96:111], v[172:175], v[24:31], v5
  s_mul_i32 s75, s10, 98304
  v_exp_f32 v36, v36
  v_exp_f32 v37, v37
  v_exp_f32 v38, v38
  v_exp_f32 v39, v39
  v_mfma_f32_32x32x16_bf16 v[8:23], v[148:151], v[68:71], 0
  s_lshl_b32 s13, s12, 8
  v_exp_f32 v40, v40
  v_exp_f32 v41, v41
  v_exp_f32 v42, v42
  v_exp_f32 v43, v43
  v_mfma_f32_32x32x8_bf16 v[8:23], v[162:163], v[78:79], v[8:23]
  v_exp_f32 v44, v44
  v_exp_f32 v45, v45
  v_exp_f32 v46, v46
  v_exp_f32 v47, v47
  v_smfmac_f32_32x32x32_bf16 v[96:111], v[176:179], v[32:39], v5
  buffer_load_dwordx4 a[52:55], v1, s[32:35], 0 offen offset:2048
  buffer_load_dwordx4 a[56:59], v1, s[32:35], 0 offen offset:3072
  v_exp_f32 v48, v48
  v_exp_f32 v49, v49
  v_exp_f32 v50, v50
  v_exp_f32 v51, v51
  v_smfmac_f32_32x32x32_bf16 v[112:127], v[172:175], v[40:47], v5
  s_waitcnt vmcnt(19)
  v_exp_f32 v52, v52
  v_exp_f32 v53, v53
  v_exp_f32 v54, v54
  v_exp_f32 v55, v55
  v_mfma_f32_32x32x16_bf16 v[24:39], v[152:155], v[56:59], 0
  s_add_u32 s75, s75, s13
  v_exp_f32 v8, v8
  v_exp_f32 v9, v9
  v_exp_f32 v10, v10
  v_exp_f32 v11, v11
  v_mfma_f32_32x32x8_bf16 v[24:39], v[244:245], v[72:73], v[24:39]
  v_exp_f32 v12, v12
  v_exp_f32 v13, v13
  v_exp_f32 v14, v14
  v_exp_f32 v15, v15
  v_smfmac_f32_32x32x32_bf16 v[112:127], v[176:179], v[48:55], v5
  buffer_load_dwordx4 a[60:63], v2, s[32:35], 0 offen offset:0
  buffer_load_dwordx4 a[64:67], v2, s[32:35], 0 offen offset:1024
  v_exp_f32 v16, v16
  v_exp_f32 v17, v17
  v_exp_f32 v18, v18
  v_exp_f32 v19, v19
  v_smfmac_f32_32x32x32_bf16 v[128:143], v[172:175], v[8:15], v5
  s_add_u32 s75, s75, 33554432
  v_exp_f32 v20, v20
  v_exp_f32 v21, v21
  v_exp_f32 v22, v22
  v_exp_f32 v23, v23
  v_mfma_f32_32x32x16_bf16 v[40:55], v[152:155], v[60:63], 0
  s_mul_i32 s13, s10, 221184
  v_exp_f32 v24, v24
  v_exp_f32 v25, v25
  v_exp_f32 v26, v26
  v_exp_f32 v27, v27
  v_mfma_f32_32x32x8_bf16 v[40:55], v[244:245], v[74:75], v[40:55]
  v_exp_f32 v28, v28
  v_exp_f32 v29, v29
  v_exp_f32 v30, v30
  v_exp_f32 v31, v31
  v_smfmac_f32_32x32x32_bf16 v[128:143], v[176:179], v[16:23], v5
  buffer_load_dwordx4 a[68:71], v2, s[32:35], 0 offen offset:2048
  buffer_load_dwordx4 a[72:75], v2, s[32:35], 0 offen offset:3072
  v_exp_f32 v32, v32
  v_exp_f32 v33, v33
  v_exp_f32 v34, v34
  v_exp_f32 v35, v35
  v_smfmac_f32_32x32x32_bf16 v[80:95], v[180:183], v[24:31], v5
  s_lshl_b32 s14, s11, 2
  v_exp_f32 v36, v36
  v_exp_f32 v37, v37
  v_exp_f32 v38, v38
  v_exp_f32 v39, v39
  v_mfma_f32_32x32x16_bf16 v[8:23], v[152:155], v[64:67], 0
  s_add_u32 s74, s74, 2
  v_exp_f32 v40, v40
  v_exp_f32 v41, v41
  v_exp_f32 v42, v42
  v_exp_f32 v43, v43
  v_mfma_f32_32x32x8_bf16 v[8:23], v[244:245], v[76:77], v[8:23]
  v_exp_f32 v44, v44
  v_exp_f32 v45, v45
  v_exp_f32 v46, v46
  v_exp_f32 v47, v47
  v_smfmac_f32_32x32x32_bf16 v[80:95], v[184:187], v[32:39], v5
  buffer_load_dwordx4 v[172:175], v2, s[28:31], 0 offen offset:1024
  buffer_load_dwordx4 v[176:179], v2, s[28:31], 0 offen offset:2048
  buffer_load_dwordx4 v[148:151], v1, s[28:31], 0 offen offset:1024
  v_exp_f32 v48, v48
  v_exp_f32 v49, v49
  v_exp_f32 v50, v50
  v_exp_f32 v51, v51
  v_smfmac_f32_32x32x32_bf16 v[96:111], v[180:183], v[40:47], v5
  s_add_u32 s14, s14, s12
  v_exp_f32 v52, v52
  v_exp_f32 v53, v53
  v_exp_f32 v54, v54
  v_exp_f32 v55, v55
  v_mfma_f32_32x32x16_bf16 v[24:39], v[152:155], v[68:71], 0
  s_and_b32 s74, s74, 31
  v_exp_f32 v8, v8
  v_exp_f32 v9, v9
  v_exp_f32 v10, v10
  v_exp_f32 v11, v11
  v_mfma_f32_32x32x8_bf16 v[24:39], v[244:245], v[78:79], v[24:39]
  v_exp_f32 v12, v12
  v_exp_f32 v13, v13
  v_exp_f32 v14, v14
  v_exp_f32 v15, v15
  v_smfmac_f32_32x32x32_bf16 v[96:111], v[184:187], v[48:55], v5
  v_exp_f32 v16, v16
  v_exp_f32 v17, v17
  v_exp_f32 v18, v18
  v_exp_f32 v19, v19
  v_smfmac_f32_32x32x32_bf16 v[112:127], v[180:183], v[8:15], v5
  s_add_u32 s32, s32, 8192
  s_addc_u32 s33, s33, 0
  s_waitcnt vmcnt(17)
  v_exp_f32 v20, v20
  v_exp_f32 v21, v21
  v_exp_f32 v22, v22
  v_exp_f32 v23, v23
  v_mfma_f32_32x32x16_bf16 v[40:55], v[240:243], v[56:59], 0
  s_mul_i32 s72, s74, 7168
  v_exp_f32 v24, v24
  v_exp_f32 v25, v25
  v_exp_f32 v26, v26
  v_exp_f32 v27, v27
  v_mfma_f32_32x32x8_bf16 v[40:55], v[246:247], v[72:73], v[40:55]
  v_exp_f32 v28, v28
  v_exp_f32 v29, v29
  v_exp_f32 v30, v30
  v_exp_f32 v31, v31
  v_smfmac_f32_32x32x32_bf16 v[112:127], v[184:187], v[16:23], v5
  buffer_load_dwordx4 a[76:79], v1, s[32:35], 0 offen offset:0
  buffer_load_dwordx4 a[80:83], v1, s[32:35], 0 offen offset:1024
  v_exp_f32 v32, v32
  v_exp_f32 v33, v33
  v_exp_f32 v34, v34
  v_exp_f32 v35, v35
  v_smfmac_f32_32x32x32_bf16 v[128:143], v[180:183], v[24:31], v5
  s_mul_i32 s14, s14, 6912
  v_exp_f32 v36, v36
  v_exp_f32 v37, v37
  v_exp_f32 v38, v38
  v_exp_f32 v39, v39
  v_mfma_f32_32x32x16_bf16 v[8:23], v[240:243], v[60:63], 0
  s_add_u32 s13, s13, s14
  v_exp_f32 v40, v40
  v_exp_f32 v41, v41
  v_exp_f32 v42, v42
  v_exp_f32 v43, v43
  v_mfma_f32_32x32x8_bf16 v[8:23], v[246:247], v[74:75], v[8:23]
  v_exp_f32 v44, v44
  v_exp_f32 v45, v45
  v_exp_f32 v46, v46
  v_exp_f32 v47, v47
  v_smfmac_f32_32x32x32_bf16 v[128:143], v[184:187], v[32:39], v5
  buffer_load_dwordx4 a[84:87], v1, s[32:35], 0 offen offset:2048
  buffer_load_dwordx4 a[88:91], v1, s[32:35], 0 offen offset:3072
  v_exp_f32 v48, v48
  v_exp_f32 v49, v49
  v_exp_f32 v50, v50
  v_exp_f32 v51, v51
  v_smfmac_f32_32x32x32_bf16 v[80:95], v[248:251], v[40:47], v5
  s_add_u32 s28, s20, s72
  s_addc_u32 s29, s21, 0
  v_exp_f32 v52, v52
  v_exp_f32 v53, v53
  v_exp_f32 v54, v54
  v_exp_f32 v55, v55
  v_mfma_f32_32x32x16_bf16 v[24:39], v[240:243], v[64:67], 0
  s_add_u32 s13, s13, 20971520
  v_exp_f32 v8, v8
  v_exp_f32 v9, v9
  v_exp_f32 v10, v10
  v_exp_f32 v11, v11
  v_mfma_f32_32x32x8_bf16 v[24:39], v[246:247], v[76:77], v[24:39]
  v_exp_f32 v12, v12
  v_exp_f32 v13, v13
  v_exp_f32 v14, v14
  v_exp_f32 v15, v15
  v_smfmac_f32_32x32x32_bf16 v[80:95], v[252:255], v[48:55], v5
  buffer_load_dwordx4 v[180:183], v1, s[28:31], 0 offen offset:3072
  buffer_load_dwordx4 v[184:187], v2, s[28:31], 0 offen
  buffer_load_dwordx4 v[160:163], v1, s[28:31], 0 offen offset:2048
  buffer_load_dwordx4 v[152:155], v1, s[28:31], 0 offen offset:0
  v_exp_f32 v16, v16
  v_exp_f32 v17, v17
  v_exp_f32 v18, v18
  v_exp_f32 v19, v19
  v_smfmac_f32_32x32x32_bf16 v[96:111], v[248:251], v[8:15], v5
  s_add_u32 s52, s4, s13
  s_addc_u32 s53, s5, 0
  v_exp_f32 v20, v20
  v_exp_f32 v21, v21
  v_exp_f32 v22, v22
  v_exp_f32 v23, v23
  v_mfma_f32_32x32x16_bf16 v[40:55], v[240:243], v[68:71], 0
  s_mov_b32 s54, 6912
  v_exp_f32 v24, v24
  v_exp_f32 v25, v25
  v_exp_f32 v26, v26
  v_exp_f32 v27, v27
  v_mfma_f32_32x32x8_bf16 v[40:55], v[246:247], v[78:79], v[40:55]
  v_exp_f32 v28, v28
  v_exp_f32 v29, v29
  v_exp_f32 v30, v30
  v_exp_f32 v31, v31
  v_smfmac_f32_32x32x32_bf16 v[96:111], v[252:255], v[16:23], v5
  buffer_load_dwordx4 a[92:95], v2, s[32:35], 0 offen offset:0
  buffer_load_dwordx4 v1, s[40:43], 0 offen offset:0 lds
  v_exp_f32 v32, v32
  v_exp_f32 v33, v33
  v_exp_f32 v34, v34
  v_exp_f32 v35, v35
  v_smfmac_f32_32x32x32_bf16 v[112:127], v[248:251], v[24:31], v5
  s_waitcnt vmcnt(19)
  v_exp_f32 v36, v36
  v_exp_f32 v37, v37
  v_exp_f32 v38, v38
  v_exp_f32 v39, v39
  v_mfma_f32_32x32x16_bf16 v[8:23], v[144:147], v[56:59], 0
  s_mov_b32 s55, 0x20000
  v_exp_f32 v40, v40
  v_exp_f32 v41, v41
  v_exp_f32 v42, v42
  v_exp_f32 v43, v43
  v_mfma_f32_32x32x8_bf16 v[8:23], v[156:157], v[72:73], v[8:23]
  v_exp_f32 v44, v44
  v_exp_f32 v45, v45
  v_exp_f32 v46, v46
  v_exp_f32 v47, v47
  v_smfmac_f32_32x32x32_bf16 v[112:127], v[252:255], v[32:39], v5
  buffer_load_dwordx4 v1, s[40:43], 0 offen offset:1024 lds
  buffer_load_dwordx4 v1, s[40:43], 0 offen offset:2048 lds
  v_exp_f32 v48, v48
  v_exp_f32 v49, v49
  v_exp_f32 v50, v50
  v_exp_f32 v51, v51
  v_smfmac_f32_32x32x32_bf16 v[128:143], v[248:251], v[40:47], v5
  s_mul_i32 s70, s8, 2560
  v_exp_f32 v52, v52
  v_exp_f32 v53, v53
  v_exp_f32 v54, v54
  v_exp_f32 v55, v55
  v_mfma_f32_32x32x16_bf16 v[24:39], v[144:147], v[60:63], 0
  s_lshl_b32 s71, s8, 7
  v_exp_f32 v8, v8
  v_exp_f32 v9, v9
  v_exp_f32 v10, v10
  v_exp_f32 v11, v11
  v_mfma_f32_32x32x8_bf16 v[24:39], v[156:157], v[74:75], v[24:39]
  v_exp_f32 v12, v12
  v_exp_f32 v13, v13
  v_exp_f32 v14, v14
  v_exp_f32 v15, v15
  v_smfmac_f32_32x32x32_bf16 v[128:143], v[252:255], v[48:55], v5
  buffer_load_dwordx4 v1, s[40:43], 0 offen offset:3072 lds
  v_exp_f32 v16, v16
  v_exp_f32 v17, v17
  v_exp_f32 v18, v18
  v_exp_f32 v19, v19
  v_smfmac_f32_32x32x32_bf16 v[80:95], v[164:167], v[8:15], v5
  s_add_u32 s71, s71, 2621440
  v_exp_f32 v20, v20
  v_exp_f32 v21, v21
  v_exp_f32 v22, v22
  v_exp_f32 v23, v23
  v_mfma_f32_32x32x16_bf16 v[40:55], v[144:147], v[64:67], 0
  s_add_u32 s74, s74, 2
  v_exp_f32 v24, v24
  v_exp_f32 v25, v25
  v_exp_f32 v26, v26
  v_exp_f32 v27, v27
  v_mfma_f32_32x32x8_bf16 v[40:55], v[156:157], v[76:77], v[40:55]
  v_exp_f32 v28, v28
  v_exp_f32 v29, v29
  v_exp_f32 v30, v30
  v_exp_f32 v31, v31
  v_smfmac_f32_32x32x32_bf16 v[80:95], v[168:171], v[16:23], v5
  buffer_load_dwordx4 v[248:251], v2, s[28:31], 0 offen offset:1024
  buffer_load_dwordx4 v[252:255], v2, s[28:31], 0 offen offset:2048
  buffer_load_dwordx4 v[240:243], v1, s[28:31], 0 offen offset:1024
  v_exp_f32 v32, v32
  v_exp_f32 v33, v33
  v_exp_f32 v34, v34
  v_exp_f32 v35, v35
  v_smfmac_f32_32x32x32_bf16 v[96:111], v[164:167], v[24:31], v5
  v_exp_f32 v36, v36
  v_exp_f32 v37, v37
  v_exp_f32 v38, v38
  v_exp_f32 v39, v39
  v_mfma_f32_32x32x16_bf16 v[8:23], v[144:147], v[68:71], 0
  s_and_b32 s74, s74, 31
  v_exp_f32 v40, v40
  v_exp_f32 v41, v41
  v_exp_f32 v42, v42
  v_exp_f32 v43, v43
  v_mfma_f32_32x32x8_bf16 v[8:23], v[156:157], v[78:79], v[8:23]
  v_exp_f32 v44, v44
  v_exp_f32 v45, v45
  v_exp_f32 v46, v46
  v_exp_f32 v47, v47
  v_smfmac_f32_32x32x32_bf16 v[96:111], v[168:171], v[32:39], v5
  v_exp_f32 v48, v48
  v_exp_f32 v49, v49
  v_exp_f32 v50, v50
  v_exp_f32 v51, v51
  v_smfmac_f32_32x32x32_bf16 v[112:127], v[164:167], v[40:47], v5
  s_add_u32 s40, s40, 4096
  s_addc_u32 s41, s41, 0
  s_add_u32 m0, m0, 4096
  s_waitcnt vmcnt(16)
  v_exp_f32 v52, v52
  v_exp_f32 v53, v53
  v_exp_f32 v54, v54
  v_exp_f32 v55, v55
  v_mfma_f32_32x32x16_bf16 v[24:39], v[148:151], v[56:59], 0
  s_mul_i32 s72, s74, 7168
  v_exp_f32 v8, v8
  v_exp_f32 v9, v9
  v_exp_f32 v10, v10
  v_exp_f32 v11, v11
  v_mfma_f32_32x32x8_bf16 v[24:39], v[158:159], v[72:73], v[24:39]
  v_exp_f32 v12, v12
  v_exp_f32 v13, v13
  v_exp_f32 v14, v14
  v_exp_f32 v15, v15
  v_smfmac_f32_32x32x32_bf16 v[112:127], v[168:171], v[48:55], v5
  buffer_load_dwordx4 v1, s[40:43], 0 offen offset:0 lds
  buffer_load_dwordx4 v1, s[40:43], 0 offen offset:1024 lds
  v_exp_f32 v16, v16
  v_exp_f32 v17, v17
  v_exp_f32 v18, v18
  v_exp_f32 v19, v19
  v_smfmac_f32_32x32x32_bf16 v[128:143], v[164:167], v[8:15], v5
  v_exp_f32 v20, v20
  v_exp_f32 v21, v21
  v_exp_f32 v22, v22
  v_exp_f32 v23, v23
  v_mfma_f32_32x32x16_bf16 v[40:55], v[148:151], v[60:63], 0
  v_exp_f32 v24, v24
  v_exp_f32 v25, v25
  v_exp_f32 v26, v26
  v_exp_f32 v27, v27
  v_mfma_f32_32x32x8_bf16 v[40:55], v[158:159], v[74:75], v[40:55]
  v_exp_f32 v28, v28
  v_exp_f32 v29, v29
  v_exp_f32 v30, v30
  v_exp_f32 v31, v31
  v_smfmac_f32_32x32x32_bf16 v[128:143], v[168:171], v[16:23], v5
  buffer_load_dwordx4 v1, s[40:43], 0 offen offset:2048 lds
  buffer_load_dwordx4 v1, s[40:43], 0 offen offset:3072 lds
  v_exp_f32 v32, v32
  v_exp_f32 v33, v33
  v_exp_f32 v34, v34
  v_exp_f32 v35, v35
  v_smfmac_f32_32x32x32_bf16 v[80:95], v[172:175], v[24:31], v5
  s_add_u32 s28, s20, s72
  s_addc_u32 s29, s21, 0
  v_exp_f32 v36, v36
  v_exp_f32 v37, v37
  v_exp_f32 v38, v38
  v_exp_f32 v39, v39
  v_mfma_f32_32x32x16_bf16 v[8:23], v[148:151], v[64:67], 0
  v_exp_f32 v40, v40
  v_exp_f32 v41, v41
  v_exp_f32 v42, v42
  v_exp_f32 v43, v43
  v_mfma_f32_32x32x8_bf16 v[8:23], v[158:159], v[76:77], v[8:23]
  v_exp_f32 v44, v44
  v_exp_f32 v45, v45
  v_exp_f32 v46, v46
  v_exp_f32 v47, v47
  v_smfmac_f32_32x32x32_bf16 v[80:95], v[176:179], v[32:39], v5
  buffer_load_dwordx4 v[164:167], v1, s[28:31], 0 offen offset:3072
  buffer_load_dwordx4 v[168:171], v2, s[28:31], 0 offen
  buffer_load_dwordx4 v[244:247], v1, s[28:31], 0 offen offset:2048
  buffer_load_dwordx4 v[144:147], v1, s[28:31], 0 offen offset:0
  v_exp_f32 v48, v48
  v_exp_f32 v49, v49
  v_exp_f32 v50, v50
  v_exp_f32 v51, v51
  v_smfmac_f32_32x32x32_bf16 v[96:111], v[172:175], v[40:47], v5
  s_add_u32 s40, s40, 4096
  s_addc_u32 s41, s41, 0
  s_add_u32 m0, m0, 4096
  v_exp_f32 v52, v52
  v_exp_f32 v53, v53
  v_exp_f32 v54, v54
  v_exp_f32 v55, v55
  v_mfma_f32_32x32x16_bf16 v[24:39], v[148:151], v[68:71], 0
  v_exp_f32 v8, v8
  v_exp_f32 v9, v9
  v_exp_f32 v10, v10
  v_exp_f32 v11, v11
  v_mfma_f32_32x32x8_bf16 v[24:39], v[158:159], v[78:79], v[24:39]
  v_exp_f32 v12, v12
  v_exp_f32 v13, v13
  v_exp_f32 v14, v14
  v_exp_f32 v15, v15
  v_smfmac_f32_32x32x32_bf16 v[96:111], v[176:179], v[48:55], v5
  buffer_load_dwordx4 v1, s[40:43], 0 offen offset:0 lds
  buffer_load_dwordx4 v1, s[40:43], 0 offen offset:1024 lds
  v_exp_f32 v16, v16
  v_exp_f32 v17, v17
  v_exp_f32 v18, v18
  v_exp_f32 v19, v19
  v_smfmac_f32_32x32x32_bf16 v[112:127], v[172:175], v[8:15], v5
  s_waitcnt vmcnt(18)
  v_exp_f32 v20, v20
  v_exp_f32 v21, v21
  v_exp_f32 v22, v22
  v_exp_f32 v23, v23
  v_mfma_f32_32x32x16_bf16 v[40:55], v[152:155], v[56:59], 0
  v_exp_f32 v24, v24
  v_exp_f32 v25, v25
  v_exp_f32 v26, v26
  v_exp_f32 v27, v27
  v_mfma_f32_32x32x8_bf16 v[40:55], v[160:161], v[72:73], v[40:55]
  v_exp_f32 v28, v28
  v_exp_f32 v29, v29
  v_exp_f32 v30, v30
  v_exp_f32 v31, v31
  v_smfmac_f32_32x32x32_bf16 v[112:127], v[176:179], v[16:23], v5
  buffer_load_dwordx4 v1, s[40:43], 0 offen offset:2048 lds
  buffer_load_dwordx4 v1, s[40:43], 0 offen offset:3072 lds
  v_exp_f32 v32, v32
  v_exp_f32 v33, v33
  v_exp_f32 v34, v34
  v_exp_f32 v35, v35
  v_smfmac_f32_32x32x32_bf16 v[128:143], v[172:175], v[24:31], v5
  s_add_u32 s40, s40, 4096
  s_addc_u32 s41, s41, 0
  s_add_u32 m0, m0, 4096
  v_exp_f32 v36, v36
  v_exp_f32 v37, v37
  v_exp_f32 v38, v38
  v_exp_f32 v39, v39
  v_mfma_f32_32x32x16_bf16 v[8:23], v[152:155], v[60:63], 0
  v_exp_f32 v40, v40
  v_exp_f32 v41, v41
  v_exp_f32 v42, v42
  v_exp_f32 v43, v43
  v_mfma_f32_32x32x8_bf16 v[8:23], v[160:161], v[74:75], v[8:23]
  v_exp_f32 v44, v44
  v_exp_f32 v45, v45
  v_exp_f32 v46, v46
  v_exp_f32 v47, v47
  v_smfmac_f32_32x32x32_bf16 v[128:143], v[176:179], v[32:39], v5
  buffer_load_dwordx4 v1, s[40:43], 0 offen offset:0 lds
  buffer_load_dwordx4 v1, s[40:43], 0 offen offset:1024 lds
  v_exp_f32 v48, v48
  v_exp_f32 v49, v49
  v_exp_f32 v50, v50
  v_exp_f32 v51, v51
  v_smfmac_f32_32x32x32_bf16 v[80:95], v[180:183], v[40:47], v5
  v_exp_f32 v52, v52
  v_exp_f32 v53, v53
  v_exp_f32 v54, v54
  v_exp_f32 v55, v55
  v_mfma_f32_32x32x16_bf16 v[24:39], v[152:155], v[64:67], 0
  s_add_u32 s74, s74, 2
  v_exp_f32 v8, v8
  v_exp_f32 v9, v9
  v_exp_f32 v10, v10
  v_exp_f32 v11, v11
  v_mfma_f32_32x32x8_bf16 v[24:39], v[160:161], v[76:77], v[24:39]
  v_exp_f32 v12, v12
  v_exp_f32 v13, v13
  v_exp_f32 v14, v14
  v_exp_f32 v15, v15
  v_smfmac_f32_32x32x32_bf16 v[80:95], v[184:187], v[48:55], v5
  buffer_load_dwordx4 v[172:175], v2, s[28:31], 0 offen offset:1024
  buffer_load_dwordx4 v[176:179], v2, s[28:31], 0 offen offset:2048
  buffer_load_dwordx4 v[148:151], v1, s[28:31], 0 offen offset:1024
  v_exp_f32 v16, v16
  v_exp_f32 v17, v17
  v_exp_f32 v18, v18
  v_exp_f32 v19, v19
  v_smfmac_f32_32x32x32_bf16 v[96:111], v[180:183], v[8:15], v5
  v_exp_f32 v20, v20
  v_exp_f32 v21, v21
  v_exp_f32 v22, v22
  v_exp_f32 v23, v23
  v_mfma_f32_32x32x16_bf16 v[40:55], v[152:155], v[68:71], 0
  s_and_b32 s74, s74, 31
  v_exp_f32 v24, v24
  v_exp_f32 v25, v25
  v_exp_f32 v26, v26
  v_exp_f32 v27, v27
  v_mfma_f32_32x32x8_bf16 v[40:55], v[160:161], v[78:79], v[40:55]
  v_exp_f32 v28, v28
  v_exp_f32 v29, v29
  v_exp_f32 v30, v30
  v_exp_f32 v31, v31
  v_smfmac_f32_32x32x32_bf16 v[96:111], v[184:187], v[16:23], v5
  v_exp_f32 v32, v32
  v_exp_f32 v33, v33
  v_exp_f32 v34, v34
  v_exp_f32 v35, v35
  v_smfmac_f32_32x32x32_bf16 v[112:127], v[180:183], v[24:31], v5
  s_waitcnt vmcnt(17)
  v_exp_f32 v36, v36
  v_exp_f32 v37, v37
  v_exp_f32 v38, v38
  v_exp_f32 v39, v39
  v_mfma_f32_32x32x16_bf16 v[8:23], v[240:243], v[56:59], 0
  s_mul_i32 s72, s74, 7168
  v_exp_f32 v40, v40
  v_exp_f32 v41, v41
  v_exp_f32 v42, v42
  v_exp_f32 v43, v43
  v_mfma_f32_32x32x8_bf16 v[8:23], v[162:163], v[72:73], v[8:23]
  v_exp_f32 v44, v44
  v_exp_f32 v45, v45
  v_exp_f32 v46, v46
  v_exp_f32 v47, v47
  v_smfmac_f32_32x32x32_bf16 v[112:127], v[184:187], v[32:39], v5
  buffer_load_dwordx4 v1, s[40:43], 0 offen offset:2048 lds
  buffer_load_dwordx4 v1, s[40:43], 0 offen offset:3072 lds
  v_exp_f32 v48, v48
  v_exp_f32 v49, v49
  v_exp_f32 v50, v50
  v_exp_f32 v51, v51
  v_smfmac_f32_32x32x32_bf16 v[128:143], v[180:183], v[40:47], v5
  s_add_u32 s40, s40, 4096
  s_addc_u32 s41, s41, 0
  s_add_u32 m0, m0, 4096
  v_exp_f32 v52, v52
  v_exp_f32 v53, v53
  v_exp_f32 v54, v54
  v_exp_f32 v55, v55
  v_mfma_f32_32x32x16_bf16 v[24:39], v[240:243], v[60:63], 0
  v_exp_f32 v8, v8
  v_exp_f32 v9, v9
  v_exp_f32 v10, v10
  v_exp_f32 v11, v11
  v_mfma_f32_32x32x8_bf16 v[24:39], v[162:163], v[74:75], v[24:39]
  v_exp_f32 v12, v12
  v_exp_f32 v13, v13
  v_exp_f32 v14, v14
  v_exp_f32 v15, v15
  v_smfmac_f32_32x32x32_bf16 v[128:143], v[184:187], v[48:55], v5
  buffer_load_dwordx4 v1, s[40:43], 0 offen offset:0 lds
  buffer_load_dwordx4 v1, s[40:43], 0 offen offset:1024 lds
  v_exp_f32 v16, v16
  v_exp_f32 v17, v17
  v_exp_f32 v18, v18
  v_exp_f32 v19, v19
  v_smfmac_f32_32x32x32_bf16 v[80:95], v[248:251], v[8:15], v5
  s_add_u32 s28, s20, s72
  s_addc_u32 s29, s21, 0
  v_exp_f32 v20, v20
  v_exp_f32 v21, v21
  v_exp_f32 v22, v22
  v_exp_f32 v23, v23
  v_mfma_f32_32x32x16_bf16 v[40:55], v[240:243], v[64:67], 0
  v_exp_f32 v24, v24
  v_exp_f32 v25, v25
  v_exp_f32 v26, v26
  v_exp_f32 v27, v27
  v_mfma_f32_32x32x8_bf16 v[40:55], v[162:163], v[76:77], v[40:55]
  v_exp_f32 v28, v28
  v_exp_f32 v29, v29
  v_exp_f32 v30, v30
  v_exp_f32 v31, v31
  v_smfmac_f32_32x32x32_bf16 v[80:95], v[252:255], v[16:23], v5
  buffer_load_dwordx4 v[180:183], v1, s[28:31], 0 offen offset:3072
  buffer_load_dwordx4 v[184:187], v2, s[28:31], 0 offen
  buffer_load_dwordx4 v[156:159], v1, s[28:31], 0 offen offset:2048
  buffer_load_dwordx4 v[152:155], v1, s[28:31], 0 offen offset:0
  v_exp_f32 v32, v32
  v_exp_f32 v33, v33
  v_exp_f32 v34, v34
  v_exp_f32 v35, v35
  v_smfmac_f32_32x32x32_bf16 v[96:111], v[248:251], v[24:31], v5
  v_exp_f32 v36, v36
  v_exp_f32 v37, v37
  v_exp_f32 v38, v38
  v_exp_f32 v39, v39
  v_mfma_f32_32x32x16_bf16 v[8:23], v[240:243], v[68:71], 0
  v_exp_f32 v40, v40
  v_exp_f32 v41, v41
  v_exp_f32 v42, v42
  v_exp_f32 v43, v43
  v_mfma_f32_32x32x8_bf16 v[8:23], v[162:163], v[78:79], v[8:23]
  v_exp_f32 v44, v44
  v_exp_f32 v45, v45
  v_exp_f32 v46, v46
  v_exp_f32 v47, v47
  v_smfmac_f32_32x32x32_bf16 v[96:111], v[252:255], v[32:39], v5
  buffer_load_dwordx4 v1, s[40:43], 0 offen offset:2048 lds
  buffer_load_dwordx4 v1, s[40:43], 0 offen offset:3072 lds
  v_exp_f32 v48, v48
  v_exp_f32 v49, v49
  v_exp_f32 v50, v50
  v_exp_f32 v51, v51
  v_smfmac_f32_32x32x32_bf16 v[112:127], v[248:251], v[40:47], v5
  s_add_u32 s40, s40, 4096
  s_addc_u32 s41, s41, 0
  s_add_u32 m0, m0, 4096
  s_waitcnt vmcnt(19)
  v_exp_f32 v52, v52
  v_exp_f32 v53, v53
  v_exp_f32 v54, v54
  v_exp_f32 v55, v55
  v_mfma_f32_32x32x16_bf16 v[24:39], v[144:147], v[56:59], 0
  v_exp_f32 v8, v8
  v_exp_f32 v9, v9
  v_exp_f32 v10, v10
  v_exp_f32 v11, v11
  v_mfma_f32_32x32x8_bf16 v[24:39], v[244:245], v[72:73], v[24:39]
  v_exp_f32 v12, v12
  v_exp_f32 v13, v13
  v_exp_f32 v14, v14
  v_exp_f32 v15, v15
  v_smfmac_f32_32x32x32_bf16 v[112:127], v[252:255], v[48:55], v5
  buffer_load_dwordx4 v1, s[40:43], 0 offen offset:0 lds
  buffer_load_dwordx4 v1, s[40:43], 0 offen offset:1024 lds
  v_exp_f32 v16, v16
  v_exp_f32 v17, v17
  v_exp_f32 v18, v18
  v_exp_f32 v19, v19
  v_smfmac_f32_32x32x32_bf16 v[128:143], v[248:251], v[8:15], v5
  v_exp_f32 v20, v20
  v_exp_f32 v21, v21
  v_exp_f32 v22, v22
  v_exp_f32 v23, v23
  v_mfma_f32_32x32x16_bf16 v[40:55], v[144:147], v[60:63], 0
  v_exp_f32 v24, v24
  v_exp_f32 v25, v25
  v_exp_f32 v26, v26
  v_exp_f32 v27, v27
  v_mfma_f32_32x32x8_bf16 v[40:55], v[244:245], v[74:75], v[40:55]
  v_exp_f32 v28, v28
  v_exp_f32 v29, v29
  v_exp_f32 v30, v30
  v_exp_f32 v31, v31
  v_smfmac_f32_32x32x32_bf16 v[128:143], v[252:255], v[16:23], v5
  buffer_load_dwordx4 v1, s[40:43], 0 offen offset:2048 lds
  buffer_load_dwordx4 v1, s[40:43], 0 offen offset:3072 lds
  v_exp_f32 v32, v32
  v_exp_f32 v33, v33
  v_exp_f32 v34, v34
  v_exp_f32 v35, v35
  v_smfmac_f32_32x32x32_bf16 v[80:95], v[164:167], v[24:31], v5
  v_exp_f32 v36, v36
  v_exp_f32 v37, v37
  v_exp_f32 v38, v38
  v_exp_f32 v39, v39
  v_mfma_f32_32x32x16_bf16 v[8:23], v[144:147], v[64:67], 0
  s_add_u32 s74, s74, 2
  v_exp_f32 v40, v40
  v_exp_f32 v41, v41
  v_exp_f32 v42, v42
  v_exp_f32 v43, v43
  v_mfma_f32_32x32x8_bf16 v[8:23], v[244:245], v[76:77], v[8:23]
  v_exp_f32 v44, v44
  v_exp_f32 v45, v45
  v_exp_f32 v46, v46
  v_exp_f32 v47, v47
  v_smfmac_f32_32x32x32_bf16 v[80:95], v[168:171], v[32:39], v5
  buffer_load_dwordx4 v[248:251], v2, s[28:31], 0 offen offset:1024
  buffer_load_dwordx4 v[252:255], v2, s[28:31], 0 offen offset:2048
  buffer_load_dwordx4 v[240:243], v1, s[28:31], 0 offen offset:1024
  v_exp_f32 v48, v48
  v_exp_f32 v49, v49
  v_exp_f32 v50, v50
  v_exp_f32 v51, v51
  v_smfmac_f32_32x32x32_bf16 v[96:111], v[164:167], v[40:47], v5
  v_exp_f32 v52, v52
  v_exp_f32 v53, v53
  v_exp_f32 v54, v54
  v_exp_f32 v55, v55
  v_mfma_f32_32x32x16_bf16 v[24:39], v[144:147], v[68:71], 0
  s_and_b32 s74, s74, 31
  v_exp_f32 v8, v8
  v_exp_f32 v9, v9
  v_exp_f32 v10, v10
  v_exp_f32 v11, v11
  v_mfma_f32_32x32x8_bf16 v[24:39], v[244:245], v[78:79], v[24:39]
  v_exp_f32 v12, v12
  v_exp_f32 v13, v13
  v_exp_f32 v14, v14
  v_exp_f32 v15, v15
  v_smfmac_f32_32x32x32_bf16 v[96:111], v[168:171], v[48:55], v5
  v_exp_f32 v16, v16
  v_exp_f32 v17, v17
  v_exp_f32 v18, v18
  v_exp_f32 v19, v19
  v_smfmac_f32_32x32x32_bf16 v[112:127], v[164:167], v[8:15], v5
  s_add_u32 s40, s40, 4096
  s_addc_u32 s41, s41, 0
  s_add_u32 m0, m0, 4096
  s_waitcnt vmcnt(17)
  v_exp_f32 v20, v20
  v_exp_f32 v21, v21
  v_exp_f32 v22, v22
  v_exp_f32 v23, v23
  v_mfma_f32_32x32x16_bf16 v[40:55], v[148:151], v[56:59], 0
  s_mul_i32 s72, s74, 7168
  v_exp_f32 v24, v24
  v_exp_f32 v25, v25
  v_exp_f32 v26, v26
  v_exp_f32 v27, v27
  v_mfma_f32_32x32x8_bf16 v[40:55], v[246:247], v[72:73], v[40:55]
  v_exp_f32 v28, v28
  v_exp_f32 v29, v29
  v_exp_f32 v30, v30
  v_exp_f32 v31, v31
  v_smfmac_f32_32x32x32_bf16 v[112:127], v[168:171], v[16:23], v5
  buffer_load_dwordx4 v1, s[40:43], 0 offen offset:0 lds
  buffer_load_dwordx4 a[96:99], v1, s[36:39], 0 offen offset:0
  v_exp_f32 v32, v32
  v_exp_f32 v33, v33
  v_exp_f32 v34, v34
  v_exp_f32 v35, v35
  v_smfmac_f32_32x32x32_bf16 v[128:143], v[164:167], v[24:31], v5
  v_exp_f32 v36, v36
  v_exp_f32 v37, v37
  v_exp_f32 v38, v38
  v_exp_f32 v39, v39
  v_mfma_f32_32x32x16_bf16 v[8:23], v[148:151], v[60:63], 0
  v_exp_f32 v40, v40
  v_exp_f32 v41, v41
  v_exp_f32 v42, v42
  v_exp_f32 v43, v43
  v_mfma_f32_32x32x8_bf16 v[8:23], v[246:247], v[74:75], v[8:23]
  v_exp_f32 v44, v44
  v_exp_f32 v45, v45
  v_exp_f32 v46, v46
  v_exp_f32 v47, v47
  v_smfmac_f32_32x32x32_bf16 v[128:143], v[168:171], v[32:39], v5
  buffer_load_dwordx4 a[100:103], v1, s[36:39], 0 offen offset:1024
  buffer_load_dwordx4 a[104:107], v1, s[36:39], 0 offen offset:2048
  v_exp_f32 v48, v48
  v_exp_f32 v49, v49
  v_exp_f32 v50, v50
  v_exp_f32 v51, v51
  v_smfmac_f32_32x32x32_bf16 v[80:95], v[172:175], v[40:47], v5
  s_add_u32 s28, s20, s72
  s_addc_u32 s29, s21, 0
  v_exp_f32 v52, v52
  v_exp_f32 v53, v53
  v_exp_f32 v54, v54
  v_exp_f32 v55, v55
  v_mfma_f32_32x32x16_bf16 v[24:39], v[148:151], v[64:67], 0
  v_exp_f32 v8, v8
  v_exp_f32 v9, v9
  v_exp_f32 v10, v10
  v_exp_f32 v11, v11
  v_mfma_f32_32x32x8_bf16 v[24:39], v[246:247], v[76:77], v[24:39]
  v_exp_f32 v12, v12
  v_exp_f32 v13, v13
  v_exp_f32 v14, v14
  v_exp_f32 v15, v15
  v_smfmac_f32_32x32x32_bf16 v[80:95], v[176:179], v[48:55], v5
  buffer_load_dwordx4 v[164:167], v1, s[28:31], 0 offen offset:3072
  buffer_load_dwordx4 v[168:171], v2, s[28:31], 0 offen
  buffer_load_dwordx4 v[160:163], v1, s[28:31], 0 offen offset:2048
  buffer_load_dwordx4 v[144:147], v1, s[28:31], 0 offen offset:0
  v_exp_f32 v16, v16
  v_exp_f32 v17, v17
  v_exp_f32 v18, v18
  v_exp_f32 v19, v19
  v_smfmac_f32_32x32x32_bf16 v[96:111], v[172:175], v[8:15], v5
  v_exp_f32 v20, v20
  v_exp_f32 v21, v21
  v_exp_f32 v22, v22
  v_exp_f32 v23, v23
  v_mfma_f32_32x32x16_bf16 v[40:55], v[148:151], v[68:71], 0
  v_exp_f32 v24, v24
  v_exp_f32 v25, v25
  v_exp_f32 v26, v26
  v_exp_f32 v27, v27
  v_mfma_f32_32x32x8_bf16 v[40:55], v[246:247], v[78:79], v[40:55]
  v_exp_f32 v28, v28
  v_exp_f32 v29, v29
  v_exp_f32 v30, v30
  v_exp_f32 v31, v31
  v_smfmac_f32_32x32x32_bf16 v[96:111], v[176:179], v[16:23], v5
  buffer_load_dwordx4 a[108:111], v1, s[36:39], 0 offen offset:3072
  buffer_load_dwordx4 a[252:255], v1, s[48:51], s19 offen sc1
  v_exp_f32 v32, v32
  v_exp_f32 v33, v33
  v_exp_f32 v34, v34
  v_exp_f32 v35, v35
  v_smfmac_f32_32x32x32_bf16 v[112:127], v[172:175], v[24:31], v5
  s_waitcnt vmcnt(19)
  v_exp_f32 v36, v36
  v_exp_f32 v37, v37
  v_exp_f32 v38, v38
  v_exp_f32 v39, v39
  v_mfma_f32_32x32x16_bf16 v[8:23], v[152:155], v[56:59], 0
  v_exp_f32 v40, v40
  v_exp_f32 v41, v41
  v_exp_f32 v42, v42
  v_exp_f32 v43, v43
  v_mfma_f32_32x32x8_bf16 v[8:23], v[156:157], v[72:73], v[8:23]
  v_exp_f32 v44, v44
  v_exp_f32 v45, v45
  v_exp_f32 v46, v46
  v_exp_f32 v47, v47
  v_smfmac_f32_32x32x32_bf16 v[112:127], v[176:179], v[32:39], v5
  buffer_load_dwordx4 a[112:115], v2, s[36:39], 0 offen offset:0
  v_exp_f32 v48, v48
  v_exp_f32 v49, v49
  v_exp_f32 v50, v50
  v_exp_f32 v51, v51
  v_smfmac_f32_32x32x32_bf16 v[128:143], v[172:175], v[40:47], v5
  v_exp_f32 v52, v52
  v_exp_f32 v53, v53
  v_exp_f32 v54, v54
  v_exp_f32 v55, v55
  v_mfma_f32_32x32x16_bf16 v[24:39], v[152:155], v[60:63], 0
  v_exp_f32 v8, v8
  v_exp_f32 v9, v9
  v_exp_f32 v10, v10
  v_exp_f32 v11, v11
  v_mfma_f32_32x32x8_bf16 v[24:39], v[156:157], v[74:75], v[24:39]
  v_exp_f32 v12, v12
  v_exp_f32 v13, v13
  v_exp_f32 v14, v14
  v_exp_f32 v15, v15
  v_smfmac_f32_32x32x32_bf16 v[128:143], v[176:179], v[48:55], v5
  buffer_load_dwordx4 a[116:119], v2, s[36:39], 0 offen offset:1024
  buffer_load_dwordx4 a[120:123], v2, s[36:39], 0 offen offset:2048
  v_exp_f32 v16, v16
  v_exp_f32 v17, v17
  v_exp_f32 v18, v18
  v_exp_f32 v19, v19
  v_smfmac_f32_32x32x32_bf16 v[80:95], v[180:183], v[8:15], v5
  v_exp_f32 v20, v20
  v_exp_f32 v21, v21
  v_exp_f32 v22, v22
  v_exp_f32 v23, v23
  v_mfma_f32_32x32x16_bf16 v[40:55], v[152:155], v[64:67], 0
  s_add_u32 s74, s74, 2
  v_exp_f32 v24, v24
  v_exp_f32 v25, v25
  v_exp_f32 v26, v26
  v_exp_f32 v27, v27
  v_mfma_f32_32x32x8_bf16 v[40:55], v[156:157], v[76:77], v[40:55]
  v_exp_f32 v28, v28
  v_exp_f32 v29, v29
  v_exp_f32 v30, v30
  v_exp_f32 v31, v31
  v_smfmac_f32_32x32x32_bf16 v[80:95], v[184:187], v[16:23], v5
  buffer_load_dwordx4 v[172:175], v2, s[28:31], 0 offen offset:1024
  buffer_load_dwordx4 v[176:179], v2, s[28:31], 0 offen offset:2048
  buffer_load_dwordx4 v[148:151], v1, s[28:31], 0 offen offset:1024
  v_exp_f32 v32, v32
  v_exp_f32 v33, v33
  v_exp_f32 v34, v34
  v_exp_f32 v35, v35
  v_smfmac_f32_32x32x32_bf16 v[96:111], v[180:183], v[24:31], v5
  v_exp_f32 v36, v36
  v_exp_f32 v37, v37
  v_exp_f32 v38, v38
  v_exp_f32 v39, v39
  v_mfma_f32_32x32x16_bf16 v[8:23], v[152:155], v[68:71], 0
  s_and_b32 s74, s74, 31
  v_exp_f32 v40, v40
  v_exp_f32 v41, v41
  v_exp_f32 v42, v42
  v_exp_f32 v43, v43
  v_mfma_f32_32x32x8_bf16 v[8:23], v[156:157], v[78:79], v[8:23]
  v_exp_f32 v44, v44
  v_exp_f32 v45, v45
  v_exp_f32 v46, v46
  v_exp_f32 v47, v47
  v_smfmac_f32_32x32x32_bf16 v[96:111], v[184:187], v[32:39], v5
  buffer_load_dwordx4 a[124:127], v2, s[36:39], 0 offen offset:3072
  v_exp_f32 v48, v48
  v_exp_f32 v49, v49
  v_exp_f32 v50, v50
  v_exp_f32 v51, v51
  v_smfmac_f32_32x32x32_bf16 v[112:127], v[180:183], v[40:47], v5
  s_waitcnt vmcnt(17)
  v_exp_f32 v52, v52
  v_exp_f32 v53, v53
  v_exp_f32 v54, v54
  v_exp_f32 v55, v55
  v_mfma_f32_32x32x16_bf16 v[24:39], v[240:243], v[56:59], 0
  s_mul_i32 s72, s74, 7168
  v_exp_f32 v8, v8
  v_exp_f32 v9, v9
  v_exp_f32 v10, v10
  v_exp_f32 v11, v11
  v_mfma_f32_32x32x8_bf16 v[24:39], v[158:159], v[72:73], v[24:39]
  v_exp_f32 v12, v12
  v_exp_f32 v13, v13
  v_exp_f32 v14, v14
  v_exp_f32 v15, v15
  v_smfmac_f32_32x32x32_bf16 v[112:127], v[184:187], v[48:55], v5
  v_exp_f32 v16, v16
  v_exp_f32 v17, v17
  v_exp_f32 v18, v18
  v_exp_f32 v19, v19
  v_smfmac_f32_32x32x32_bf16 v[128:143], v[180:183], v[8:15], v5
  s_add_u32 s36, s36, 8192
  s_addc_u32 s37, s37, 0
  v_exp_f32 v20, v20
  v_exp_f32 v21, v21
  v_exp_f32 v22, v22
  v_exp_f32 v23, v23
  v_mfma_f32_32x32x16_bf16 v[40:55], v[240:243], v[60:63], 0
  v_exp_f32 v24, v24
  v_exp_f32 v25, v25
  v_exp_f32 v26, v26
  v_exp_f32 v27, v27
  v_mfma_f32_32x32x8_bf16 v[40:55], v[158:159], v[74:75], v[40:55]
  v_exp_f32 v28, v28
  v_exp_f32 v29, v29
  v_exp_f32 v30, v30
  v_exp_f32 v31, v31
  v_smfmac_f32_32x32x32_bf16 v[128:143], v[184:187], v[16:23], v5
  buffer_load_dwordx4 a[128:131], v1, s[36:39], 0 offen offset:0
  buffer_load_dwordx4 a[132:135], v1, s[36:39], 0 offen offset:1024
  v_exp_f32 v32, v32
  v_exp_f32 v33, v33
  v_exp_f32 v34, v34
  v_exp_f32 v35, v35
  v_smfmac_f32_32x32x32_bf16 v[80:95], v[248:251], v[24:31], v5
  s_add_u32 s28, s20, s72
  s_addc_u32 s29, s21, 0
  v_exp_f32 v36, v36
  v_exp_f32 v37, v37
  v_exp_f32 v38, v38
  v_exp_f32 v39, v39
  v_mfma_f32_32x32x16_bf16 v[8:23], v[240:243], v[64:67], 0
  v_exp_f32 v40, v40
  v_exp_f32 v41, v41
  v_exp_f32 v42, v42
  v_exp_f32 v43, v43
  v_mfma_f32_32x32x8_bf16 v[8:23], v[158:159], v[76:77], v[8:23]
  v_exp_f32 v44, v44
  v_exp_f32 v45, v45
  v_exp_f32 v46, v46
  v_exp_f32 v47, v47
  v_smfmac_f32_32x32x32_bf16 v[80:95], v[252:255], v[32:39], v5
  buffer_load_dwordx4 v[180:183], v1, s[28:31], 0 offen offset:3072
  buffer_load_dwordx4 v[184:187], v2, s[28:31], 0 offen
  buffer_load_dwordx4 v[244:247], v1, s[28:31], 0 offen offset:2048
  buffer_load_dwordx4 v[152:155], v1, s[28:31], 0 offen offset:0
  v_exp_f32 v48, v48
  v_exp_f32 v49, v49
  v_exp_f32 v50, v50
  v_exp_f32 v51, v51
  v_smfmac_f32_32x32x32_bf16 v[96:111], v[248:251], v[40:47], v5
  v_exp_f32 v52, v52
  v_exp_f32 v53, v53
  v_exp_f32 v54, v54
  v_exp_f32 v55, v55
  v_mfma_f32_32x32x16_bf16 v[24:39], v[240:243], v[68:71], 0
  v_exp_f32 v8, v8
  v_exp_f32 v9, v9
  v_exp_f32 v10, v10
  v_exp_f32 v11, v11
  v_mfma_f32_32x32x8_bf16 v[24:39], v[158:159], v[78:79], v[24:39]
  v_exp_f32 v12, v12
  v_exp_f32 v13, v13
  v_exp_f32 v14, v14
  v_exp_f32 v15, v15
  v_smfmac_f32_32x32x32_bf16 v[96:111], v[252:255], v[48:55], v5
  buffer_load_dwordx4 a[136:139], v1, s[36:39], 0 offen offset:2048
  buffer_load_dwordx4 a[140:143], v1, s[36:39], 0 offen offset:3072
  v_exp_f32 v16, v16
  v_exp_f32 v17, v17
  v_exp_f32 v18, v18
  v_exp_f32 v19, v19
  v_smfmac_f32_32x32x32_bf16 v[112:127], v[248:251], v[8:15], v5
  s_waitcnt vmcnt(17)
  v_exp_f32 v20, v20
  v_exp_f32 v21, v21
  v_exp_f32 v22, v22
  v_exp_f32 v23, v23
  v_mfma_f32_32x32x16_bf16 v[40:55], v[144:147], v[56:59], 0
  v_exp_f32 v24, v24
  v_exp_f32 v25, v25
  v_exp_f32 v26, v26
  v_exp_f32 v27, v27
  v_mfma_f32_32x32x8_bf16 v[40:55], v[160:161], v[72:73], v[40:55]
  v_exp_f32 v28, v28
  v_exp_f32 v29, v29
  v_exp_f32 v30, v30
  v_exp_f32 v31, v31
  v_smfmac_f32_32x32x32_bf16 v[112:127], v[252:255], v[16:23], v5
  buffer_load_dwordx4 a[252:255], v1, s[52:55], 0 offen offset:0
  v_exp_f32 v32, v32
  v_exp_f32 v33, v33
  v_exp_f32 v34, v34
  v_exp_f32 v35, v35
  v_smfmac_f32_32x32x32_bf16 v[128:143], v[248:251], v[24:31], v5
  v_exp_f32 v36, v36
  v_exp_f32 v37, v37
  v_exp_f32 v38, v38
  v_exp_f32 v39, v39
  v_mfma_f32_32x32x16_bf16 v[8:23], v[144:147], v[60:63], 0
  v_exp_f32 v40, v40
  v_exp_f32 v41, v41
  v_exp_f32 v42, v42
  v_exp_f32 v43, v43
  v_mfma_f32_32x32x8_bf16 v[8:23], v[160:161], v[74:75], v[8:23]
  v_exp_f32 v44, v44
  v_exp_f32 v45, v45
  v_exp_f32 v46, v46
  v_exp_f32 v47, v47
  v_smfmac_f32_32x32x32_bf16 v[128:143], v[252:255], v[32:39], v5
  buffer_load_dwordx4 a[144:147], v2, s[36:39], 0 offen offset:0
  buffer_load_dwordx4 a[148:151], v2, s[36:39], 0 offen offset:1024
  v_exp_f32 v48, v48
  v_exp_f32 v49, v49
  v_exp_f32 v50, v50
  v_exp_f32 v51, v51
  v_smfmac_f32_32x32x32_bf16 v[80:95], v[164:167], v[40:47], v5
  v_exp_f32 v52, v52
  v_exp_f32 v53, v53
  v_exp_f32 v54, v54
  v_exp_f32 v55, v55
  v_mfma_f32_32x32x16_bf16 v[24:39], v[144:147], v[64:67], 0
  s_add_u32 s74, s74, 2
  v_exp_f32 v8, v8
  v_exp_f32 v9, v9
  v_exp_f32 v10, v10
  v_exp_f32 v11, v11
  v_mfma_f32_32x32x8_bf16 v[24:39], v[160:161], v[76:77], v[24:39]
  v_exp_f32 v12, v12
  v_exp_f32 v13, v13
  v_exp_f32 v14, v14
  v_exp_f32 v15, v15
  v_smfmac_f32_32x32x32_bf16 v[80:95], v[168:171], v[48:55], v5
  buffer_load_dwordx4 v[248:251], v2, s[28:31], 0 offen offset:1024
  buffer_load_dwordx4 v[252:255], v2, s[28:31], 0 offen offset:2048
  buffer_load_dwordx4 v[240:243], v1, s[28:31], 0 offen offset:1024
  v_exp_f32 v16, v16
  v_exp_f32 v17, v17
  v_exp_f32 v18, v18
  v_exp_f32 v19, v19
  v_smfmac_f32_32x32x32_bf16 v[96:111], v[164:167], v[8:15], v5
  v_exp_f32 v20, v20
  v_exp_f32 v21, v21
  v_exp_f32 v22, v22
  v_exp_f32 v23, v23
  v_mfma_f32_32x32x16_bf16 v[40:55], v[144:147], v[68:71], 0
  s_and_b32 s74, s74, 31
  v_exp_f32 v24, v24
  v_exp_f32 v25, v25
  v_exp_f32 v26, v26
  v_exp_f32 v27, v27
  v_mfma_f32_32x32x8_bf16 v[40:55], v[160:161], v[78:79], v[40:55]
  v_exp_f32 v28, v28
  v_exp_f32 v29, v29
  v_exp_f32 v30, v30
  v_exp_f32 v31, v31
  v_smfmac_f32_32x32x32_bf16 v[96:111], v[168:171], v[16:23], v5
  buffer_load_dwordx4 a[152:155], v2, s[36:39], 0 offen offset:2048
  buffer_load_dwordx4 a[156:159], v2, s[36:39], 0 offen offset:3072
  v_exp_f32 v32, v32
  v_exp_f32 v33, v33
  v_exp_f32 v34, v34
  v_exp_f32 v35, v35
  v_smfmac_f32_32x32x32_bf16 v[112:127], v[164:167], v[24:31], v5
  s_waitcnt vmcnt(17)
  v_exp_f32 v36, v36
  v_exp_f32 v37, v37
  v_exp_f32 v38, v38
  v_exp_f32 v39, v39
  v_mfma_f32_32x32x16_bf16 v[8:23], v[148:151], v[56:59], 0
  s_mul_i32 s72, s74, 7168
  v_exp_f32 v40, v40
  v_exp_f32 v41, v41
  v_exp_f32 v42, v42
  v_exp_f32 v43, v43
  v_mfma_f32_32x32x8_bf16 v[8:23], v[162:163], v[72:73], v[8:23]
  v_exp_f32 v44, v44
  v_exp_f32 v45, v45
  v_exp_f32 v46, v46
  v_exp_f32 v47, v47
  v_smfmac_f32_32x32x32_bf16 v[112:127], v[168:171], v[32:39], v5
  v_exp_f32 v48, v48
  v_exp_f32 v49, v49
  v_exp_f32 v50, v50
  v_exp_f32 v51, v51
  v_smfmac_f32_32x32x32_bf16 v[128:143], v[164:167], v[40:47], v5
  v_exp_f32 v52, v52
  v_exp_f32 v53, v53
  v_exp_f32 v54, v54
  v_exp_f32 v55, v55
  v_mfma_f32_32x32x16_bf16 v[24:39], v[148:151], v[60:63], 0
  v_exp_f32 v8, v8
  v_exp_f32 v9, v9
  v_exp_f32 v10, v10
  v_exp_f32 v11, v11
  v_mfma_f32_32x32x8_bf16 v[24:39], v[162:163], v[74:75], v[24:39]
  v_exp_f32 v12, v12
  v_exp_f32 v13, v13
  v_exp_f32 v14, v14
  v_exp_f32 v15, v15
  v_smfmac_f32_32x32x32_bf16 v[128:143], v[168:171], v[48:55], v5
  buffer_load_dwordx4 a[252:255], v1, s[52:55], 0 offen offset:1024
  v_exp_f32 v16, v16
  v_exp_f32 v17, v17
  v_exp_f32 v18, v18
  v_exp_f32 v19, v19
  v_smfmac_f32_32x32x32_bf16 v[80:95], v[172:175], v[8:15], v5
  s_add_u32 s28, s20, s72
  s_addc_u32 s29, s21, 0
  v_exp_f32 v20, v20
  v_exp_f32 v21, v21
  v_exp_f32 v22, v22
  v_exp_f32 v23, v23
  v_mfma_f32_32x32x16_bf16 v[40:55], v[148:151], v[64:67], 0
  v_exp_f32 v24, v24
  v_exp_f32 v25, v25
  v_exp_f32 v26, v26
  v_exp_f32 v27, v27
  v_mfma_f32_32x32x8_bf16 v[40:55], v[162:163], v[76:77], v[40:55]
  v_exp_f32 v28, v28
  v_exp_f32 v29, v29
  v_exp_f32 v30, v30
  v_exp_f32 v31, v31
  v_smfmac_f32_32x32x32_bf16 v[80:95], v[176:179], v[16:23], v5
  buffer_load_dwordx4 v[164:167], v1, s[28:31], 0 offen offset:3072
  buffer_load_dwordx4 v[168:171], v2, s[28:31], 0 offen
  buffer_load_dwordx4 v[156:159], v1, s[28:31], 0 offen offset:2048
  buffer_load_dwordx4 v[144:147], v1, s[28:31], 0 offen offset:0
  v_exp_f32 v32, v32
  v_exp_f32 v33, v33
  v_exp_f32 v34, v34
  v_exp_f32 v35, v35
  v_smfmac_f32_32x32x32_bf16 v[96:111], v[172:175], v[24:31], v5
  s_add_u32 s36, s36, 8192
  s_addc_u32 s37, s37, 0
  v_exp_f32 v36, v36
  v_exp_f32 v37, v37
  v_exp_f32 v38, v38
  v_exp_f32 v39, v39
  v_mfma_f32_32x32x16_bf16 v[8:23], v[148:151], v[68:71], 0
  v_exp_f32 v40, v40
  v_exp_f32 v41, v41
  v_exp_f32 v42, v42
  v_exp_f32 v43, v43
  v_mfma_f32_32x32x8_bf16 v[8:23], v[162:163], v[78:79], v[8:23]
  v_exp_f32 v44, v44
  v_exp_f32 v45, v45
  v_exp_f32 v46, v46
  v_exp_f32 v47, v47
  v_smfmac_f32_32x32x32_bf16 v[96:111], v[176:179], v[32:39], v5
  buffer_load_dwordx4 a[160:163], v1, s[36:39], 0 offen offset:0
  buffer_load_dwordx4 a[164:167], v1, s[36:39], 0 offen offset:1024
  v_exp_f32 v48, v48
  v_exp_f32 v49, v49
  v_exp_f32 v50, v50
  v_exp_f32 v51, v51
  v_smfmac_f32_32x32x32_bf16 v[112:127], v[172:175], v[40:47], v5
  s_waitcnt vmcnt(17)
  v_exp_f32 v52, v52
  v_exp_f32 v53, v53
  v_exp_f32 v54, v54
  v_exp_f32 v55, v55
  v_mfma_f32_32x32x16_bf16 v[24:39], v[152:155], v[56:59], 0
  v_exp_f32 v8, v8
  v_exp_f32 v9, v9
  v_exp_f32 v10, v10
  v_exp_f32 v11, v11
  v_mfma_f32_32x32x8_bf16 v[24:39], v[244:245], v[72:73], v[24:39]
  v_exp_f32 v12, v12
  v_exp_f32 v13, v13
  v_exp_f32 v14, v14
  v_exp_f32 v15, v15
  v_smfmac_f32_32x32x32_bf16 v[112:127], v[176:179], v[48:55], v5
  buffer_load_dwordx4 a[168:171], v1, s[36:39], 0 offen offset:2048
  buffer_load_dwordx4 a[172:175], v1, s[36:39], 0 offen offset:3072
  v_exp_f32 v16, v16
  v_exp_f32 v17, v17
  v_exp_f32 v18, v18
  v_exp_f32 v19, v19
  v_smfmac_f32_32x32x32_bf16 v[128:143], v[172:175], v[8:15], v5
  v_exp_f32 v20, v20
  v_exp_f32 v21, v21
  v_exp_f32 v22, v22
  v_exp_f32 v23, v23
  v_mfma_f32_32x32x16_bf16 v[40:55], v[152:155], v[60:63], 0
  v_exp_f32 v24, v24
  v_exp_f32 v25, v25
  v_exp_f32 v26, v26
  v_exp_f32 v27, v27
  v_mfma_f32_32x32x8_bf16 v[40:55], v[244:245], v[74:75], v[40:55]
  v_exp_f32 v28, v28
  v_exp_f32 v29, v29
  v_exp_f32 v30, v30
  v_exp_f32 v31, v31
  v_smfmac_f32_32x32x32_bf16 v[128:143], v[176:179], v[16:23], v5
  buffer_load_dwordx4 a[252:255], v1, s[52:55], 0 offen offset:2048
  v_exp_f32 v32, v32
  v_exp_f32 v33, v33
  v_exp_f32 v34, v34
  v_exp_f32 v35, v35
  v_smfmac_f32_32x32x32_bf16 v[80:95], v[180:183], v[24:31], v5
  v_exp_f32 v36, v36
  v_exp_f32 v37, v37
  v_exp_f32 v38, v38
  v_exp_f32 v39, v39
  v_mfma_f32_32x32x16_bf16 v[8:23], v[152:155], v[64:67], 0
  s_add_u32 s74, s74, 2
  v_exp_f32 v40, v40
  v_exp_f32 v41, v41
  v_exp_f32 v42, v42
  v_exp_f32 v43, v43
  v_mfma_f32_32x32x8_bf16 v[8:23], v[244:245], v[76:77], v[8:23]
  v_exp_f32 v44, v44
  v_exp_f32 v45, v45
  v_exp_f32 v46, v46
  v_exp_f32 v47, v47
  v_smfmac_f32_32x32x32_bf16 v[80:95], v[184:187], v[32:39], v5
  buffer_load_dwordx4 v[172:175], v2, s[28:31], 0 offen offset:1024
  buffer_load_dwordx4 v[176:179], v2, s[28:31], 0 offen offset:2048
  buffer_load_dwordx4 v[148:151], v1, s[28:31], 0 offen offset:1024
  v_exp_f32 v48, v48
  v_exp_f32 v49, v49
  v_exp_f32 v50, v50
  v_exp_f32 v51, v51
  v_smfmac_f32_32x32x32_bf16 v[96:111], v[180:183], v[40:47], v5
  v_exp_f32 v52, v52
  v_exp_f32 v53, v53
  v_exp_f32 v54, v54
  v_exp_f32 v55, v55
  v_mfma_f32_32x32x16_bf16 v[24:39], v[152:155], v[68:71], 0
  s_and_b32 s74, s74, 31
  v_exp_f32 v8, v8
  v_exp_f32 v9, v9
  v_exp_f32 v10, v10
  v_exp_f32 v11, v11
  v_mfma_f32_32x32x8_bf16 v[24:39], v[244:245], v[78:79], v[24:39]
  v_exp_f32 v12, v12
  v_exp_f32 v13, v13
  v_exp_f32 v14, v14
  v_exp_f32 v15, v15
  v_smfmac_f32_32x32x32_bf16 v[96:111], v[184:187], v[48:55], v5
  buffer_load_dwordx4 a[176:179], v2, s[36:39], 0 offen offset:0
  buffer_load_dwordx4 a[180:183], v2, s[36:39], 0 offen offset:1024
  v_exp_f32 v16, v16
  v_exp_f32 v17, v17
  v_exp_f32 v18, v18
  v_exp_f32 v19, v19
  v_smfmac_f32_32x32x32_bf16 v[112:127], v[180:183], v[8:15], v5
  s_waitcnt vmcnt(17)
  v_exp_f32 v20, v20
  v_exp_f32 v21, v21
  v_exp_f32 v22, v22
  v_exp_f32 v23, v23
  v_mfma_f32_32x32x16_bf16 v[40:55], v[240:243], v[56:59], 0
  s_mul_i32 s72, s74, 7168
  v_exp_f32 v24, v24
  v_exp_f32 v25, v25
  v_exp_f32 v26, v26
  v_exp_f32 v27, v27
  v_mfma_f32_32x32x8_bf16 v[40:55], v[246:247], v[72:73], v[40:55]
  v_exp_f32 v28, v28
  v_exp_f32 v29, v29
  v_exp_f32 v30, v30
  v_exp_f32 v31, v31
  v_smfmac_f32_32x32x32_bf16 v[112:127], v[184:187], v[16:23], v5
  v_exp_f32 v32, v32
  v_exp_f32 v33, v33
  v_exp_f32 v34, v34
  v_exp_f32 v35, v35
  v_smfmac_f32_32x32x32_bf16 v[128:143], v[180:183], v[24:31], v5
  v_exp_f32 v36, v36
  v_exp_f32 v37, v37
  v_exp_f32 v38, v38
  v_exp_f32 v39, v39
  v_mfma_f32_32x32x16_bf16 v[8:23], v[240:243], v[60:63], 0
  v_exp_f32 v40, v40
  v_exp_f32 v41, v41
  v_exp_f32 v42, v42
  v_exp_f32 v43, v43
  v_mfma_f32_32x32x8_bf16 v[8:23], v[246:247], v[74:75], v[8:23]
  v_exp_f32 v44, v44
  v_exp_f32 v45, v45
  v_exp_f32 v46, v46
  v_exp_f32 v47, v47
  v_smfmac_f32_32x32x32_bf16 v[128:143], v[184:187], v[32:39], v5
  buffer_load_dwordx4 a[184:187], v2, s[36:39], 0 offen offset:2048
  buffer_load_dwordx4 a[188:191], v2, s[36:39], 0 offen offset:3072
  v_exp_f32 v48, v48
  v_exp_f32 v49, v49
  v_exp_f32 v50, v50
  v_exp_f32 v51, v51
  v_smfmac_f32_32x32x32_bf16 v[80:95], v[248:251], v[40:47], v5
  s_add_u32 s28, s20, s72
  s_addc_u32 s29, s21, 0
  v_exp_f32 v52, v52
  v_exp_f32 v53, v53
  v_exp_f32 v54, v54
  v_exp_f32 v55, v55
  v_mfma_f32_32x32x16_bf16 v[24:39], v[240:243], v[64:67], 0
  v_exp_f32 v8, v8
  v_exp_f32 v9, v9
  v_exp_f32 v10, v10
  v_exp_f32 v11, v11
  v_mfma_f32_32x32x8_bf16 v[24:39], v[246:247], v[76:77], v[24:39]
  v_exp_f32 v12, v12
  v_exp_f32 v13, v13
  v_exp_f32 v14, v14
  v_exp_f32 v15, v15
  v_smfmac_f32_32x32x32_bf16 v[80:95], v[252:255], v[48:55], v5
  buffer_load_dwordx4 v[180:183], v1, s[28:31], 0 offen offset:3072
  buffer_load_dwordx4 v[184:187], v2, s[28:31], 0 offen
  buffer_load_dwordx4 v[160:163], v1, s[28:31], 0 offen offset:2048
  buffer_load_dwordx4 v[152:155], v1, s[28:31], 0 offen offset:0
  v_exp_f32 v16, v16
  v_exp_f32 v17, v17
  v_exp_f32 v18, v18
  v_exp_f32 v19, v19
  v_smfmac_f32_32x32x32_bf16 v[96:111], v[248:251], v[8:15], v5
  v_exp_f32 v20, v20
  v_exp_f32 v21, v21
  v_exp_f32 v22, v22
  v_exp_f32 v23, v23
  v_mfma_f32_32x32x16_bf16 v[40:55], v[240:243], v[68:71], 0
  v_exp_f32 v24, v24
  v_exp_f32 v25, v25
  v_exp_f32 v26, v26
  v_exp_f32 v27, v27
  v_mfma_f32_32x32x8_bf16 v[40:55], v[246:247], v[78:79], v[40:55]
  v_exp_f32 v28, v28
  v_exp_f32 v29, v29
  v_exp_f32 v30, v30
  v_exp_f32 v31, v31
  v_smfmac_f32_32x32x32_bf16 v[96:111], v[252:255], v[16:23], v5
  buffer_load_dwordx4 a[252:255], v1, s[52:55], 0 offen offset:3072
  v_exp_f32 v32, v32
  v_exp_f32 v33, v33
  v_exp_f32 v34, v34
  v_exp_f32 v35, v35
  v_smfmac_f32_32x32x32_bf16 v[112:127], v[248:251], v[24:31], v5
  s_add_u32 s36, s36, 8192
  s_addc_u32 s37, s37, 0
  s_waitcnt vmcnt(17)
  v_exp_f32 v36, v36
  v_exp_f32 v37, v37
  v_exp_f32 v38, v38
  v_exp_f32 v39, v39
  v_mfma_f32_32x32x16_bf16 v[8:23], v[144:147], v[56:59], 0
  v_exp_f32 v40, v40
  v_exp_f32 v41, v41
  v_exp_f32 v42, v42
  v_exp_f32 v43, v43
  v_mfma_f32_32x32x8_bf16 v[8:23], v[156:157], v[72:73], v[8:23]
  v_exp_f32 v44, v44
  v_exp_f32 v45, v45
  v_exp_f32 v46, v46
  v_exp_f32 v47, v47
  v_smfmac_f32_32x32x32_bf16 v[112:127], v[252:255], v[32:39], v5
  buffer_load_dwordx4 a[192:195], v1, s[36:39], 0 offen offset:0
  buffer_load_dwordx4 a[196:199], v1, s[36:39], 0 offen offset:1024
  v_exp_f32 v48, v48
  v_exp_f32 v49, v49
  v_exp_f32 v50, v50
  v_exp_f32 v51, v51
  v_smfmac_f32_32x32x32_bf16 v[128:143], v[248:251], v[40:47], v5
  v_exp_f32 v52, v52
  v_exp_f32 v53, v53
  v_exp_f32 v54, v54
  v_exp_f32 v55, v55
  v_mfma_f32_32x32x16_bf16 v[24:39], v[144:147], v[60:63], 0
  v_exp_f32 v8, v8
  v_exp_f32 v9, v9
  v_exp_f32 v10, v10
  v_exp_f32 v11, v11
  v_mfma_f32_32x32x8_bf16 v[24:39], v[156:157], v[74:75], v[24:39]
  v_exp_f32 v12, v12
  v_exp_f32 v13, v13
  v_exp_f32 v14, v14
  v_exp_f32 v15, v15
  v_smfmac_f32_32x32x32_bf16 v[128:143], v[252:255], v[48:55], v5
  buffer_load_dwordx4 a[200:203], v1, s[36:39], 0 offen offset:2048
  buffer_load_dwordx4 a[204:207], v1, s[36:39], 0 offen offset:3072
  v_exp_f32 v16, v16
  v_exp_f32 v17, v17
  v_exp_f32 v18, v18
  v_exp_f32 v19, v19
  v_smfmac_f32_32x32x32_bf16 v[80:95], v[164:167], v[8:15], v5
  v_exp_f32 v20, v20
  v_exp_f32 v21, v21
  v_exp_f32 v22, v22
  v_exp_f32 v23, v23
  v_mfma_f32_32x32x16_bf16 v[40:55], v[144:147], v[64:67], 0
  s_add_u32 s74, s74, 2
  v_exp_f32 v24, v24
  v_exp_f32 v25, v25
  v_exp_f32 v26, v26
  v_exp_f32 v27, v27
  v_mfma_f32_32x32x8_bf16 v[40:55], v[156:157], v[76:77], v[40:55]
  v_exp_f32 v28, v28
  v_exp_f32 v29, v29
  v_exp_f32 v30, v30
  v_exp_f32 v31, v31
  v_smfmac_f32_32x32x32_bf16 v[80:95], v[168:171], v[16:23], v5
  buffer_load_dwordx4 v[248:251], v2, s[28:31], 0 offen offset:1024
  buffer_load_dwordx4 v[252:255], v2, s[28:31], 0 offen offset:2048
  buffer_load_dwordx4 v[240:243], v1, s[28:31], 0 offen offset:1024
  v_exp_f32 v32, v32
  v_exp_f32 v33, v33
  v_exp_f32 v34, v34
  v_exp_f32 v35, v35
  v_smfmac_f32_32x32x32_bf16 v[96:111], v[164:167], v[24:31], v5
  v_exp_f32 v36, v36
  v_exp_f32 v37, v37
  v_exp_f32 v38, v38
  v_exp_f32 v39, v39
  v_mfma_f32_32x32x16_bf16 v[8:23], v[144:147], v[68:71], 0
  s_and_b32 s74, s74, 31
  v_exp_f32 v40, v40
  v_exp_f32 v41, v41
  v_exp_f32 v42, v42
  v_exp_f32 v43, v43
  v_mfma_f32_32x32x8_bf16 v[8:23], v[156:157], v[78:79], v[8:23]
  v_exp_f32 v44, v44
  v_exp_f32 v45, v45
  v_exp_f32 v46, v46
  v_exp_f32 v47, v47
  v_smfmac_f32_32x32x32_bf16 v[96:111], v[168:171], v[32:39], v5
  buffer_load_dwordx4 a[252:255], v2, s[52:55], 0 offen offset:0
  v_exp_f32 v48, v48
  v_exp_f32 v49, v49
  v_exp_f32 v50, v50
  v_exp_f32 v51, v51
  v_smfmac_f32_32x32x32_bf16 v[112:127], v[164:167], v[40:47], v5
  s_waitcnt vmcnt(17)
  v_exp_f32 v52, v52
  v_exp_f32 v53, v53
  v_exp_f32 v54, v54
  v_exp_f32 v55, v55
  v_mfma_f32_32x32x16_bf16 v[24:39], v[148:151], v[56:59], 0
  s_mul_i32 s72, s74, 7168
  v_exp_f32 v8, v8
  v_exp_f32 v9, v9
  v_exp_f32 v10, v10
  v_exp_f32 v11, v11
  v_mfma_f32_32x32x8_bf16 v[24:39], v[158:159], v[72:73], v[24:39]
  v_exp_f32 v12, v12
  v_exp_f32 v13, v13
  v_exp_f32 v14, v14
  v_exp_f32 v15, v15
  v_smfmac_f32_32x32x32_bf16 v[112:127], v[168:171], v[48:55], v5
  v_exp_f32 v16, v16
  v_exp_f32 v17, v17
  v_exp_f32 v18, v18
  v_exp_f32 v19, v19
  v_smfmac_f32_32x32x32_bf16 v[128:143], v[164:167], v[8:15], v5
  v_exp_f32 v20, v20
  v_exp_f32 v21, v21
  v_exp_f32 v22, v22
  v_exp_f32 v23, v23
  v_mfma_f32_32x32x16_bf16 v[40:55], v[148:151], v[60:63], 0
  v_exp_f32 v24, v24
  v_exp_f32 v25, v25
  v_exp_f32 v26, v26
  v_exp_f32 v27, v27
  v_mfma_f32_32x32x8_bf16 v[40:55], v[158:159], v[74:75], v[40:55]
  v_exp_f32 v28, v28
  v_exp_f32 v29, v29
  v_exp_f32 v30, v30
  v_exp_f32 v31, v31
  v_smfmac_f32_32x32x32_bf16 v[128:143], v[168:171], v[16:23], v5
  buffer_load_dwordx4 a[208:211], v2, s[36:39], 0 offen offset:0
  buffer_load_dwordx4 a[212:215], v2, s[36:39], 0 offen offset:1024
  v_exp_f32 v32, v32
  v_exp_f32 v33, v33
  v_exp_f32 v34, v34
  v_exp_f32 v35, v35
  v_smfmac_f32_32x32x32_bf16 v[80:95], v[172:175], v[24:31], v5
  s_add_u32 s28, s20, s72
  s_addc_u32 s29, s21, 0
  v_exp_f32 v36, v36
  v_exp_f32 v37, v37
  v_exp_f32 v38, v38
  v_exp_f32 v39, v39
  v_mfma_f32_32x32x16_bf16 v[8:23], v[148:151], v[64:67], 0
  v_exp_f32 v40, v40
  v_exp_f32 v41, v41
  v_exp_f32 v42, v42
  v_exp_f32 v43, v43
  v_mfma_f32_32x32x8_bf16 v[8:23], v[158:159], v[76:77], v[8:23]
  v_exp_f32 v44, v44
  v_exp_f32 v45, v45
  v_exp_f32 v46, v46
  v_exp_f32 v47, v47
  v_smfmac_f32_32x32x32_bf16 v[80:95], v[176:179], v[32:39], v5
  buffer_load_dwordx4 v[164:167], v1, s[28:31], 0 offen offset:3072
  buffer_load_dwordx4 v[168:171], v2, s[28:31], 0 offen
  buffer_load_dwordx4 v[244:247], v1, s[28:31], 0 offen offset:2048
  buffer_load_dwordx4 v[144:147], v1, s[28:31], 0 offen offset:0
  v_exp_f32 v48, v48
  v_exp_f32 v49, v49
  v_exp_f32 v50, v50
  v_exp_f32 v51, v51
  v_smfmac_f32_32x32x32_bf16 v[96:111], v[172:175], v[40:47], v5
  v_exp_f32 v52, v52
  v_exp_f32 v53, v53
  v_exp_f32 v54, v54
  v_exp_f32 v55, v55
  v_mfma_f32_32x32x16_bf16 v[24:39], v[148:151], v[68:71], 0
  v_exp_f32 v8, v8
  v_exp_f32 v9, v9
  v_exp_f32 v10, v10
  v_exp_f32 v11, v11
  v_mfma_f32_32x32x8_bf16 v[24:39], v[158:159], v[78:79], v[24:39]
  v_exp_f32 v12, v12
  v_exp_f32 v13, v13
  v_exp_f32 v14, v14
  v_exp_f32 v15, v15
  v_smfmac_f32_32x32x32_bf16 v[96:111], v[176:179], v[48:55], v5
  buffer_load_dwordx4 a[216:219], v2, s[36:39], 0 offen offset:2048
  buffer_load_dwordx4 a[220:223], v2, s[36:39], 0 offen offset:3072
  v_exp_f32 v16, v16
  v_exp_f32 v17, v17
  v_exp_f32 v18, v18
  v_exp_f32 v19, v19
  v_smfmac_f32_32x32x32_bf16 v[112:127], v[172:175], v[8:15], v5
  s_waitcnt vmcnt(17)
  v_exp_f32 v20, v20
  v_exp_f32 v21, v21
  v_exp_f32 v22, v22
  v_exp_f32 v23, v23
  v_mfma_f32_32x32x16_bf16 v[40:55], v[152:155], v[56:59], 0
  v_exp_f32 v24, v24
  v_exp_f32 v25, v25
  v_exp_f32 v26, v26
  v_exp_f32 v27, v27
  v_mfma_f32_32x32x8_bf16 v[40:55], v[160:161], v[72:73], v[40:55]
  v_exp_f32 v28, v28
  v_exp_f32 v29, v29
  v_exp_f32 v30, v30
  v_exp_f32 v31, v31
  v_smfmac_f32_32x32x32_bf16 v[112:127], v[176:179], v[16:23], v5
  buffer_load_dwordx4 a[252:255], v2, s[52:55], 0 offen offset:1024
  v_exp_f32 v32, v32
  v_exp_f32 v33, v33
  v_exp_f32 v34, v34
  v_exp_f32 v35, v35
  v_smfmac_f32_32x32x32_bf16 v[128:143], v[172:175], v[24:31], v5
  s_add_u32 s36, s36, 8192
  s_addc_u32 s37, s37, 0
  v_exp_f32 v36, v36
  v_exp_f32 v37, v37
  v_exp_f32 v38, v38
  v_exp_f32 v39, v39
  v_mfma_f32_32x32x16_bf16 v[8:23], v[152:155], v[60:63], 0
  v_exp_f32 v40, v40
  v_exp_f32 v41, v41
  v_exp_f32 v42, v42
  v_exp_f32 v43, v43
  v_mfma_f32_32x32x8_bf16 v[8:23], v[160:161], v[74:75], v[8:23]
  v_exp_f32 v44, v44
  v_exp_f32 v45, v45
  v_exp_f32 v46, v46
  v_exp_f32 v47, v47
  v_smfmac_f32_32x32x32_bf16 v[128:143], v[176:179], v[32:39], v5
  buffer_load_dwordx4 a[224:227], v1, s[36:39], 0 offen offset:0
  buffer_load_dwordx4 a[228:231], v1, s[36:39], 0 offen offset:1024
  v_exp_f32 v48, v48
  v_exp_f32 v49, v49
  v_exp_f32 v50, v50
  v_exp_f32 v51, v51
  v_smfmac_f32_32x32x32_bf16 v[80:95], v[180:183], v[40:47], v5
  v_exp_f32 v52, v52
  v_exp_f32 v53, v53
  v_exp_f32 v54, v54
  v_exp_f32 v55, v55
  v_mfma_f32_32x32x16_bf16 v[24:39], v[152:155], v[64:67], 0
  s_add_u32 s74, s74, 2
  v_exp_f32 v8, v8
  v_exp_f32 v9, v9
  v_exp_f32 v10, v10
  v_exp_f32 v11, v11
  v_mfma_f32_32x32x8_bf16 v[24:39], v[160:161], v[76:77], v[24:39]
  v_exp_f32 v12, v12
  v_exp_f32 v13, v13
  v_exp_f32 v14, v14
  v_exp_f32 v15, v15
  v_smfmac_f32_32x32x32_bf16 v[80:95], v[184:187], v[48:55], v5
  buffer_load_dwordx4 v[172:175], v2, s[28:31], 0 offen offset:1024
  buffer_load_dwordx4 v[176:179], v2, s[28:31], 0 offen offset:2048
  buffer_load_dwordx4 v[148:151], v1, s[28:31], 0 offen offset:1024
  v_exp_f32 v16, v16
  v_exp_f32 v17, v17
  v_exp_f32 v18, v18
  v_exp_f32 v19, v19
  v_smfmac_f32_32x32x32_bf16 v[96:111], v[180:183], v[8:15], v5
  v_exp_f32 v20, v20
  v_exp_f32 v21, v21
  v_exp_f32 v22, v22
  v_exp_f32 v23, v23
  v_mfma_f32_32x32x16_bf16 v[40:55], v[152:155], v[68:71], 0
  s_and_b32 s74, s74, 31
  v_exp_f32 v24, v24
  v_exp_f32 v25, v25
  v_exp_f32 v26, v26
  v_exp_f32 v27, v27
  v_mfma_f32_32x32x8_bf16 v[40:55], v[160:161], v[78:79], v[40:55]
  v_exp_f32 v28, v28
  v_exp_f32 v29, v29
  v_exp_f32 v30, v30
  v_exp_f32 v31, v31
  v_smfmac_f32_32x32x32_bf16 v[96:111], v[184:187], v[16:23], v5
  buffer_load_dwordx4 a[232:235], v1, s[36:39], 0 offen offset:2048
  buffer_load_dwordx4 a[236:239], v1, s[36:39], 0 offen offset:3072
  v_exp_f32 v32, v32
  v_exp_f32 v33, v33
  v_exp_f32 v34, v34
  v_exp_f32 v35, v35
  v_smfmac_f32_32x32x32_bf16 v[112:127], v[180:183], v[24:31], v5
  s_waitcnt vmcnt(17)
  v_exp_f32 v36, v36
  v_exp_f32 v37, v37
  v_exp_f32 v38, v38
  v_exp_f32 v39, v39
  v_mfma_f32_32x32x16_bf16 v[8:23], v[240:243], v[56:59], 0
  s_mul_i32 s72, s74, 7168
  v_exp_f32 v40, v40
  v_exp_f32 v41, v41
  v_exp_f32 v42, v42
  v_exp_f32 v43, v43
  v_mfma_f32_32x32x8_bf16 v[8:23], v[162:163], v[72:73], v[8:23]
  v_exp_f32 v44, v44
  v_exp_f32 v45, v45
  v_exp_f32 v46, v46
  v_exp_f32 v47, v47
  v_smfmac_f32_32x32x32_bf16 v[112:127], v[184:187], v[32:39], v5
  v_exp_f32 v48, v48
  v_exp_f32 v49, v49
  v_exp_f32 v50, v50
  v_exp_f32 v51, v51
  v_smfmac_f32_32x32x32_bf16 v[128:143], v[180:183], v[40:47], v5
  v_exp_f32 v52, v52
  v_exp_f32 v53, v53
  v_exp_f32 v54, v54
  v_exp_f32 v55, v55
  v_mfma_f32_32x32x16_bf16 v[24:39], v[240:243], v[60:63], 0
  v_exp_f32 v8, v8
  v_exp_f32 v9, v9
  v_exp_f32 v10, v10
  v_exp_f32 v11, v11
  v_mfma_f32_32x32x8_bf16 v[24:39], v[162:163], v[74:75], v[24:39]
  v_exp_f32 v12, v12
  v_exp_f32 v13, v13
  v_exp_f32 v14, v14
  v_exp_f32 v15, v15
  v_smfmac_f32_32x32x32_bf16 v[128:143], v[184:187], v[48:55], v5
  buffer_load_dwordx4 a[252:255], v2, s[52:55], 0 offen offset:2048
  v_exp_f32 v16, v16
  v_exp_f32 v17, v17
  v_exp_f32 v18, v18
  v_exp_f32 v19, v19
  v_smfmac_f32_32x32x32_bf16 v[80:95], v[248:251], v[8:15], v5
  s_add_u32 s28, s20, s72
  s_addc_u32 s29, s21, 0
  v_exp_f32 v20, v20
  v_exp_f32 v21, v21
  v_exp_f32 v22, v22
  v_exp_f32 v23, v23
  v_mfma_f32_32x32x16_bf16 v[40:55], v[240:243], v[64:67], 0
  v_exp_f32 v24, v24
  v_exp_f32 v25, v25
  v_exp_f32 v26, v26
  v_exp_f32 v27, v27
  v_mfma_f32_32x32x8_bf16 v[40:55], v[162:163], v[76:77], v[40:55]
  v_exp_f32 v28, v28
  v_exp_f32 v29, v29
  v_exp_f32 v30, v30
  v_exp_f32 v31, v31
  v_smfmac_f32_32x32x32_bf16 v[80:95], v[252:255], v[16:23], v5
  buffer_load_dwordx4 v[180:183], v1, s[28:31], 0 offen offset:3072
  buffer_load_dwordx4 v[184:187], v2, s[28:31], 0 offen
  buffer_load_dwordx4 v[156:159], v1, s[28:31], 0 offen offset:2048
  buffer_load_dwordx4 v[152:155], v1, s[28:31], 0 offen offset:0
  v_exp_f32 v32, v32
  v_exp_f32 v33, v33
  v_exp_f32 v34, v34
  v_exp_f32 v35, v35
  v_smfmac_f32_32x32x32_bf16 v[96:111], v[248:251], v[24:31], v5
  v_exp_f32 v36, v36
  v_exp_f32 v37, v37
  v_exp_f32 v38, v38
  v_exp_f32 v39, v39
  v_mfma_f32_32x32x16_bf16 v[8:23], v[240:243], v[68:71], 0
  v_exp_f32 v40, v40
  v_exp_f32 v41, v41
  v_exp_f32 v42, v42
  v_exp_f32 v43, v43
  v_mfma_f32_32x32x8_bf16 v[8:23], v[162:163], v[78:79], v[8:23]
  v_exp_f32 v44, v44
  v_exp_f32 v45, v45
  v_exp_f32 v46, v46
  v_exp_f32 v47, v47
  v_smfmac_f32_32x32x32_bf16 v[96:111], v[252:255], v[32:39], v5
  buffer_load_dwordx4 a[252:255], v1, s[24:27], s81 offen offset:0
  buffer_load_dwordx4 a[252:255], v1, s[24:27], s81 offen offset:1024
  v_exp_f32 v48, v48
  v_exp_f32 v49, v49
  v_exp_f32 v50, v50
  v_exp_f32 v51, v51
  v_smfmac_f32_32x32x32_bf16 v[112:127], v[248:251], v[40:47], v5
  s_getpc_b64 s[52:53]
Lcw:
  s_waitcnt vmcnt(17)
  v_exp_f32 v52, v52
  v_exp_f32 v53, v53
  v_exp_f32 v54, v54
  v_exp_f32 v55, v55
  v_mfma_f32_32x32x16_bf16 v[24:39], v[144:147], v[56:59], 0
  v_exp_f32 v8, v8
  v_exp_f32 v9, v9
  v_exp_f32 v10, v10
  v_exp_f32 v11, v11
  v_mfma_f32_32x32x8_bf16 v[24:39], v[244:245], v[72:73], v[24:39]
  v_exp_f32 v12, v12
  v_exp_f32 v13, v13
  v_exp_f32 v14, v14
  v_exp_f32 v15, v15
  v_smfmac_f32_32x32x32_bf16 v[112:127], v[252:255], v[48:55], v5
  buffer_load_dwordx4 a[252:255], v1, s[24:27], s81 offen offset:1536
  v_exp_f32 v16, v16
  v_exp_f32 v17, v17
  v_exp_f32 v18, v18
  v_exp_f32 v19, v19
  v_smfmac_f32_32x32x32_bf16 v[128:143], v[248:251], v[8:15], v5
  s_add_u32 s52, s52, Lpost-Lcw
  s_addc_u32 s53, s53, 0
  v_exp_f32 v20, v20
  v_exp_f32 v21, v21
  v_exp_f32 v22, v22
  v_exp_f32 v23, v23
  v_mfma_f32_32x32x16_bf16 v[40:55], v[144:147], v[60:63], 0
  v_exp_f32 v24, v24
  v_exp_f32 v25, v25
  v_exp_f32 v26, v26
  v_exp_f32 v27, v27
  v_mfma_f32_32x32x8_bf16 v[40:55], v[244:245], v[74:75], v[40:55]
  v_exp_f32 v28, v28
  v_exp_f32 v29, v29
  v_exp_f32 v30, v30
  v_exp_f32 v31, v31
  v_smfmac_f32_32x32x32_bf16 v[128:143], v[252:255], v[16:23], v5
  buffer_load_dwordx4 a[240:243], v2, s[36:39], 0 offen offset:0
  buffer_load_dwordx4 a[244:247], v2, s[36:39], 0 offen offset:1024
  v_exp_f32 v32, v32
  v_exp_f32 v33, v33
  v_exp_f32 v34, v34
  v_exp_f32 v35, v35
  v_smfmac_f32_32x32x32_bf16 v[80:95], v[164:167], v[24:31], v5
  s_mov_b32 s54, Lcode_end-Lpost
  s_and_b32 s13, s8, 127
  s_lshl_b32 s13, s13, 10
  v_exp_f32 v36, v36
  v_exp_f32 v37, v37
  v_exp_f32 v38, v38
  v_exp_f32 v39, v39
  v_mfma_f32_32x32x16_bf16 v[8:23], v[144:147], v[64:67], 0
  v_exp_f32 v40, v40
  v_exp_f32 v41, v41
  v_exp_f32 v42, v42
  v_exp_f32 v43, v43
  v_mfma_f32_32x32x8_bf16 v[8:23], v[244:245], v[76:77], v[8:23]
  v_exp_f32 v44, v44
  v_exp_f32 v45, v45
  v_exp_f32 v46, v46
  v_exp_f32 v47, v47
  v_smfmac_f32_32x32x32_bf16 v[80:95], v[168:171], v[32:39], v5
  buffer_load_dwordx4 v[248:251], v2, s[28:31], 0 offen offset:1024
  buffer_load_dwordx4 v[252:255], v2, s[28:31], 0 offen offset:2048
  buffer_load_dwordx4 v[240:243], v1, s[28:31], 0 offen offset:1024
  buffer_load_dwordx4 v[160:163], v1, s[52:55], s13 offen
  v_exp_f32 v48, v48
  v_exp_f32 v49, v49
  v_exp_f32 v50, v50
  v_exp_f32 v51, v51
  v_smfmac_f32_32x32x32_bf16 v[96:111], v[164:167], v[40:47], v5
  v_exp_f32 v52, v52
  v_exp_f32 v53, v53
  v_exp_f32 v54, v54
  v_exp_f32 v55, v55
  v_mfma_f32_32x32x16_bf16 v[24:39], v[144:147], v[68:71], 0
  v_exp_f32 v8, v8
  v_exp_f32 v9, v9
  v_exp_f32 v10, v10
  v_exp_f32 v11, v11
  v_mfma_f32_32x32x8_bf16 v[24:39], v[244:245], v[78:79], v[24:39]
  v_exp_f32 v12, v12
  v_exp_f32 v13, v13
  v_exp_f32 v14, v14
  v_exp_f32 v15, v15
  v_smfmac_f32_32x32x32_bf16 v[96:111], v[168:171], v[48:55], v5
  buffer_load_dwordx4 a[248:251], v2, s[36:39], 0 offen offset:2048
  buffer_load_dwordx4 a[252:255], v2, s[36:39], 0 offen offset:3072
  v_exp_f32 v16, v16
  v_exp_f32 v17, v17
  v_exp_f32 v18, v18
  v_exp_f32 v19, v19
  v_smfmac_f32_32x32x32_bf16 v[112:127], v[164:167], v[8:15], v5
  s_waitcnt vmcnt(18)
  v_exp_f32 v20, v20
  v_exp_f32 v21, v21
  v_exp_f32 v22, v22
  v_exp_f32 v23, v23
  v_mfma_f32_32x32x16_bf16 v[40:55], v[148:151], v[56:59], 0
  v_exp_f32 v24, v24
  v_exp_f32 v25, v25
  v_exp_f32 v26, v26
  v_exp_f32 v27, v27
  v_mfma_f32_32x32x8_bf16 v[40:55], v[246:247], v[72:73], v[40:55]
  v_exp_f32 v28, v28
  v_exp_f32 v29, v29
  v_exp_f32 v30, v30
  v_exp_f32 v31, v31
  v_smfmac_f32_32x32x32_bf16 v[112:127], v[168:171], v[16:23], v5
  v_exp_f32 v32, v32
  v_exp_f32 v33, v33
  v_exp_f32 v34, v34
  v_exp_f32 v35, v35
  v_smfmac_f32_32x32x32_bf16 v[128:143], v[164:167], v[24:31], v5
  s_add_u32 s48, s88, 0
  s_addc_u32 s49, s89, 0
  s_sub_i32 s50, s90, 0
  s_max_i32 s50, s50, 0
  s_sub_u32 m0, s87, 9216
  v_exp_f32 v36, v36
  v_exp_f32 v37, v37
  v_exp_f32 v38, v38
  v_exp_f32 v39, v39
  v_mfma_f32_32x32x16_bf16 v[8:23], v[148:151], v[60:63], 0
  v_exp_f32 v40, v40
  v_exp_f32 v41, v41
  v_exp_f32 v42, v42
  v_exp_f32 v43, v43
  v_mfma_f32_32x32x8_bf16 v[8:23], v[246:247], v[74:75], v[8:23]
  v_exp_f32 v44, v44
  v_exp_f32 v45, v45
  v_exp_f32 v46, v46
  v_exp_f32 v47, v47
  v_smfmac_f32_32x32x32_bf16 v[128:143], v[168:171], v[32:39], v5
  buffer_load_dwordx4 v1, s[48:51], 0 offen offset:0 lds
  buffer_load_dwordx4 v1, s[48:51], 0 offen offset:1024 lds
  v_exp_f32 v48, v48
  v_exp_f32 v49, v49
  v_exp_f32 v50, v50
  v_exp_f32 v51, v51
  v_smfmac_f32_32x32x32_bf16 v[80:95], v[172:175], v[40:47], v5
  v_exp_f32 v52, v52
  v_exp_f32 v53, v53
  v_exp_f32 v54, v54
  v_exp_f32 v55, v55
  v_mfma_f32_32x32x16_bf16 v[24:39], v[148:151], v[64:67], 0
  v_exp_f32 v8, v8
  v_exp_f32 v9, v9
  v_exp_f32 v10, v10
  v_exp_f32 v11, v11
  v_mfma_f32_32x32x8_bf16 v[24:39], v[246:247], v[76:77], v[24:39]
  v_exp_f32 v12, v12
  v_exp_f32 v13, v13
  v_exp_f32 v14, v14
  v_exp_f32 v15, v15
  v_smfmac_f32_32x32x32_bf16 v[80:95], v[176:179], v[48:55], v5
  v_and_b32 v147, 15, v0
  v_lshrrev_b32 v145, 5, v0
  v_lshlrev_b32 v146, 8, v145
  v_lshl_add_u32 v146, v147, 4, v146
  v_bfe_u32 v145, v0, 4, 1
  v_lshl_add_u32 v146, v145, 3, v146
  v_lshrrev_b32 v145, 4, v0
  v_lshlrev_b32 v147, 3, v147
  v_lshl_add_u32 v147, v145, 30, v147
  v_exp_f32 v16, v16
  v_exp_f32 v17, v17
  v_exp_f32 v18, v18
  v_exp_f32 v19, v19
  v_smfmac_f32_32x32x32_bf16 v[96:111], v[172:175], v[8:15], v5
  v_exp_f32 v20, v20
  v_exp_f32 v21, v21
  v_exp_f32 v22, v22
  v_exp_f32 v23, v23
  v_mfma_f32_32x32x16_bf16 v[40:55], v[148:151], v[68:71], 0
  v_exp_f32 v24, v24
  v_exp_f32 v25, v25
  v_exp_f32 v26, v26
  v_exp_f32 v27, v27
  v_mfma_f32_32x32x8_bf16 v[40:55], v[246:247], v[78:79], v[40:55]
  v_exp_f32 v28, v28
  v_exp_f32 v29, v29
  v_exp_f32 v30, v30
  v_exp_f32 v31, v31
  v_smfmac_f32_32x32x32_bf16 v[96:111], v[176:179], v[16:23], v5
  buffer_load_dwordx4 v1, s[48:51], 0 offen offset:2048 lds
  buffer_load_dwordx4 v1, s[48:51], 0 offen offset:3072 lds
  v_exp_f32 v32, v32
  v_exp_f32 v33, v33
  v_exp_f32 v34, v34
  v_exp_f32 v35, v35
  v_smfmac_f32_32x32x32_bf16 v[112:127], v[172:175], v[24:31], v5
  s_sub_u32 m0, s87, 5120
  s_waitcnt vmcnt(15)
  v_exp_f32 v36, v36
  v_exp_f32 v37, v37
  v_exp_f32 v38, v38
  v_exp_f32 v39, v39
  v_mfma_f32_32x32x16_bf16 v[8:23], v[152:155], v[56:59], 0
  v_exp_f32 v40, v40
  v_exp_f32 v41, v41
  v_exp_f32 v42, v42
  v_exp_f32 v43, v43
  v_mfma_f32_32x32x8_bf16 v[8:23], v[156:157], v[72:73], v[8:23]
  v_exp_f32 v44, v44
  v_exp_f32 v45, v45
  v_exp_f32 v46, v46
  v_exp_f32 v47, v47
  v_smfmac_f32_32x32x32_bf16 v[112:127], v[176:179], v[32:39], v5
  buffer_load_dwordx4 v2, s[48:51], 0 offen offset:0 lds
  s_waitcnt vmcnt(7)
  v_lshrrev_b32 v161, 3, v0
  v_and_b32 v160, 7, v0
  v_lshlrev_b32 v160, 4, v160
  v_lshl_add_u32 v160, v161, 10, v160
  s_and_b32 s13, s10, 28
  s_lshl_b32 s13, s13, 10
  buffer_load_dwordx4 v[160:163], v160, s[44:47], s13 offen offset:512 sc1
  v_exp_f32 v48, v48
  v_exp_f32 v49, v49
  v_exp_f32 v50, v50
  v_exp_f32 v51, v51
  v_smfmac_f32_32x32x32_bf16 v[128:143], v[172:175], v[40:47], v5
  s_add_u32 s48, s88, 10240
  s_addc_u32 s49, s89, 0
  s_sub_i32 s50, s90, 10240
  s_max_i32 s50, s50, 0
  s_sub_u32 m0, s87, 4096
  v_exp_f32 v52, v52
  v_exp_f32 v53, v53
  v_exp_f32 v54, v54
  v_exp_f32 v55, v55
  v_mfma_f32_32x32x16_bf16 v[24:39], v[152:155], v[60:63], 0
  v_exp_f32 v8, v8
  v_exp_f32 v9, v9
  v_exp_f32 v10, v10
  v_exp_f32 v11, v11
  v_mfma_f32_32x32x8_bf16 v[24:39], v[156:157], v[74:75], v[24:39]
  v_exp_f32 v12, v12
  v_exp_f32 v13, v13
  v_exp_f32 v14, v14
  v_exp_f32 v15, v15
  v_smfmac_f32_32x32x32_bf16 v[128:143], v[176:179], v[48:55], v5
  buffer_load_dwordx4 v1, s[48:51], 0 offen offset:0 lds
  buffer_load_dwordx4 v1, s[48:51], 0 offen offset:1024 lds
  v_exp_f32 v16, v16
  v_exp_f32 v17, v17
  v_exp_f32 v18, v18
  v_exp_f32 v19, v19
  v_smfmac_f32_32x32x32_bf16 v[80:95], v[180:183], v[8:15], v5
  v_exp_f32 v20, v20
  v_exp_f32 v21, v21
  v_exp_f32 v22, v22
  v_exp_f32 v23, v23
  v_mfma_f32_32x32x16_bf16 v[40:55], v[152:155], v[64:67], 0
  v_exp_f32 v24, v24
  v_exp_f32 v25, v25
  v_exp_f32 v26, v26
  v_exp_f32 v27, v27
  v_mfma_f32_32x32x8_bf16 v[40:55], v[156:157], v[76:77], v[40:55]
  v_exp_f32 v28, v28
  v_exp_f32 v29, v29
  v_exp_f32 v30, v30
  v_exp_f32 v31, v31
  v_smfmac_f32_32x32x32_bf16 v[80:95], v[184:187], v[16:23], v5
  buffer_load_dword v144, v147, s[56:59], s71 offen
  buffer_load_dwordx2 v[144:145], v146, s[56:59], s70 offen offset:2048
  buffer_load_dwordx4 v[164:167], v1, s[56:59], s70 offen
  buffer_load_dwordx4 v[168:171], v1, s[56:59], s70 offen offset:1024
  v_exp_f32 v32, v32
  v_exp_f32 v33, v33
  v_exp_f32 v34, v34
  v_exp_f32 v35, v35
  v_smfmac_f32_32x32x32_bf16 v[96:111], v[180:183], v[24:31], v5
  v_exp_f32 v36, v36
  v_exp_f32 v37, v37
  v_exp_f32 v38, v38
  v_exp_f32 v39, v39
  v_mfma_f32_32x32x16_bf16 v[8:23], v[152:155], v[68:71], 0
  v_exp_f32 v40, v40
  v_exp_f32 v41, v41
  v_exp_f32 v42, v42
  v_exp_f32 v43, v43
  v_mfma_f32_32x32x8_bf16 v[8:23], v[156:157], v[78:79], v[8:23]
  v_exp_f32 v44, v44
  v_exp_f32 v45, v45
  v_exp_f32 v46, v46
  v_exp_f32 v47, v47
  v_smfmac_f32_32x32x32_bf16 v[96:111], v[184:187], v[32:39], v5
  buffer_load_dwordx4 v1, s[48:51], 0 offen offset:2048 lds
  v_exp_f32 v48, v48
  v_exp_f32 v49, v49
  v_exp_f32 v50, v50
  v_exp_f32 v51, v51
  v_smfmac_f32_32x32x32_bf16 v[112:127], v[180:183], v[40:47], v5
  v_exp_f32 v52, v52
  v_exp_f32 v53, v53
  v_exp_f32 v54, v54
  v_exp_f32 v55, v55
  v_mfma_f32_32x32x16_bf16 v[24:39], v[240:243], v[56:59], 0
  v_exp_f32 v8, v8
  v_exp_f32 v9, v9
  v_exp_f32 v10, v10
  v_exp_f32 v11, v11
  v_mfma_f32_32x32x8_bf16 v[24:39], v[158:159], v[72:73], v[24:39]
  v_exp_f32 v12, v12
  v_exp_f32 v13, v13
  v_exp_f32 v14, v14
  v_exp_f32 v15, v15
  v_smfmac_f32_32x32x32_bf16 v[112:127], v[184:187], v[48:55], v5
  v_exp_f32 v16, v16
  v_exp_f32 v17, v17
  v_exp_f32 v18, v18
  v_exp_f32 v19, v19
  v_smfmac_f32_32x32x32_bf16 v[128:143], v[180:183], v[8:15], v5
  v_exp_f32 v20, v20
  v_exp_f32 v21, v21
  v_exp_f32 v22, v22
  v_exp_f32 v23, v23
  v_mfma_f32_32x32x16_bf16 v[40:55], v[240:243], v[60:63], 0
  v_exp_f32 v24, v24
  v_exp_f32 v25, v25
  v_exp_f32 v26, v26
  v_exp_f32 v27, v27
  v_mfma_f32_32x32x8_bf16 v[40:55], v[158:159], v[74:75], v[40:55]
  v_exp_f32 v28, v28
  v_exp_f32 v29, v29
  v_exp_f32 v30, v30
  v_exp_f32 v31, v31
  v_smfmac_f32_32x32x32_bf16 v[128:143], v[184:187], v[16:23], v5
  v_exp_f32 v32, v32
  v_exp_f32 v33, v33
  v_exp_f32 v34, v34
  v_exp_f32 v35, v35
  v_smfmac_f32_32x32x32_bf16 v[80:95], v[248:251], v[24:31], v5
  v_exp_f32 v36, v36
  v_exp_f32 v37, v37
  v_exp_f32 v38, v38
  v_exp_f32 v39, v39
  v_mfma_f32_32x32x16_bf16 v[8:23], v[240:243], v[64:67], 0
  v_exp_f32 v40, v40
  v_exp_f32 v41, v41
  v_exp_f32 v42, v42
  v_exp_f32 v43, v43
  v_mfma_f32_32x32x8_bf16 v[8:23], v[158:159], v[76:77], v[8:23]
  v_exp_f32 v44, v44
  v_exp_f32 v45, v45
  v_exp_f32 v46, v46
  v_exp_f32 v47, v47
  v_smfmac_f32_32x32x32_bf16 v[80:95], v[252:255], v[32:39], v5
  v_exp_f32 v48, v48
  v_exp_f32 v49, v49
  v_exp_f32 v50, v50
  v_exp_f32 v51, v51
  v_smfmac_f32_32x32x32_bf16 v[96:111], v[248:251], v[40:47], v5
  v_add_u32 v6, s87, v1
  v_add_u32 v7, s91, v1
  v_exp_f32 v52, v52
  v_exp_f32 v53, v53
  v_exp_f32 v54, v54
  v_exp_f32 v55, v55
  v_mfma_f32_32x32x16_bf16 v[24:39], v[240:243], v[68:71], 0
  v_exp_f32 v8, v8
  v_exp_f32 v9, v9
  v_exp_f32 v10, v10
  v_exp_f32 v11, v11
  v_mfma_f32_32x32x8_bf16 v[24:39], v[158:159], v[78:79], v[24:39]
  v_exp_f32 v12, v12
  v_exp_f32 v13, v13
  v_exp_f32 v14, v14
  v_exp_f32 v15, v15
  v_smfmac_f32_32x32x32_bf16 v[96:111], v[252:255], v[48:55], v5
  v_exp_f32 v16, v16
  v_exp_f32 v17, v17
  v_exp_f32 v18, v18
  v_exp_f32 v19, v19
  v_smfmac_f32_32x32x32_bf16 v[112:127], v[248:251], v[8:15], v5
  ds_write_b128 v6, v[80:83] offset:0
  ds_write_b128 v6, v[84:87] offset:1024
  ds_write_b128 v6, v[88:91] offset:2048
  v_exp_f32 v20, v20
  v_exp_f32 v21, v21
  v_exp_f32 v22, v22
  v_exp_f32 v23, v23
  v_exp_f32 v24, v24
  v_exp_f32 v25, v25
  v_exp_f32 v26, v26
  v_exp_f32 v27, v27
  v_exp_f32 v28, v28
  v_exp_f32 v29, v29
  v_exp_f32 v30, v30
  v_exp_f32 v31, v31
  v_smfmac_f32_32x32x32_bf16 v[112:127], v[252:255], v[16:23], v5
  ds_write_b128 v6, v[96:99] offset:3072
  ds_write_b128 v6, v[100:103] offset:4096
  ds_write_b128 v6, v[104:107] offset:5120
  v_exp_f32 v32, v32
  v_exp_f32 v33, v33
  v_exp_f32 v34, v34
  v_exp_f32 v35, v35
  v_smfmac_f32_32x32x32_bf16 v[128:143], v[248:251], v[24:31], v5
  v_exp_f32 v36, v36
  v_exp_f32 v37, v37
  v_exp_f32 v38, v38
  v_exp_f32 v39, v39
  s_waitcnt lgkmcnt(0)
  s_barrier
  ds_read_b128 v[80:83], v7 offset:0
  ds_read_b128 v[84:87], v7 offset:1024
  ds_read_b128 v[88:91], v7 offset:2048
  ds_read_b128 v[92:95], v7 offset:3072
  ds_read_b128 v[96:99], v7 offset:4096
  ds_read_b128 v[100:103], v7 offset:5120
Lpost:
  v_smfmac_f32_32x32x32_bf16 v[128:143], v[252:255], v[32:39], v5
  v_lshrrev_b32 v10, 5, v0
  v_and_b32 v8, 15, v0
  v_lshlrev_b32 v8, 4, v8
  v_bfe_u32 v6, v0, 4, 1
  v_lshl_add_u32 v9, v6, 8, v8
  v_lshl_add_u32 v8, v10, 10, v9
  v_lshl_add_u32 v9, v10, 30, v9
  s_waitcnt lgkmcnt(3)
  v_pk_add_f32 v[120:121], v[120:121], v[88:89]
  v_pk_add_f32 v[122:123], v[122:123], v[90:91]
  v_pk_add_f32 v[112:113], v[112:113], v[80:81]
  v_pk_add_f32 v[114:115], v[114:115], v[82:83]
  v_pk_add_f32 v[116:117], v[116:117], v[84:85]
  v_pk_add_f32 v[118:119], v[118:119], v[86:87]
  v_mov_b32 v12, v120
  v_mov_b32 v13, v120
  s_nop 1
  v_permlane32_swap_b32 v12, v13
  v_rcp_f32 v12, v13
  s_waitcnt lgkmcnt(0)
  v_pk_add_f32 v[136:137], v[136:137], v[100:101]
  v_pk_add_f32 v[138:139], v[138:139], v[102:103]
  v_pk_add_f32 v[128:129], v[128:129], v[92:93]
  v_pk_add_f32 v[130:131], v[130:131], v[94:95]
  v_pk_add_f32 v[132:133], v[132:133], v[96:97]
  v_pk_add_f32 v[134:135], v[134:135], v[98:99]
  v_mov_b32 v14, v136
  v_mov_b32 v15, v136
  s_nop 1
  v_permlane32_swap_b32 v14, v15
  v_rcp_f32 v14, v15
  v_pk_mul_f32 v[112:113], v[112:113], v[12:13] op_sel_hi:[1,0]
  v_pk_mul_f32 v[114:115], v[114:115], v[12:13] op_sel_hi:[1,0]
  v_pk_mul_f32 v[116:117], v[116:117], v[12:13] op_sel_hi:[1,0]
  v_pk_mul_f32 v[118:119], v[118:119], v[12:13] op_sel_hi:[1,0]
  v_pk_mul_f32 v[120:121], v[120:121], v[12:13] op_sel_hi:[1,0]
  v_pk_mul_f32 v[122:123], v[122:123], v[12:13] op_sel_hi:[1,0]
  v_cvt_pk_bf16_f32 v16, v112, v113
  v_cvt_pk_bf16_f32 v17, v114, v115
  v_cvt_pk_bf16_f32 v18, v116, v117
  v_cvt_pk_bf16_f32 v19, v118, v119
  v_cvt_pk_bf16_f32 v20, v120, v121
  v_cvt_pk_bf16_f32 v21, v122, v123
  buffer_store_dwordx4 v[16:19], v8, s[24:27], s85 offen offset:0
  buffer_store_dwordx2 v[20:21], v9, s[24:27], s86 offen offset:0
  v_pk_mul_f32 v[128:129], v[128:129], v[14:15] op_sel_hi:[1,0]
  v_pk_mul_f32 v[130:131], v[130:131], v[14:15] op_sel_hi:[1,0]
  v_pk_mul_f32 v[132:133], v[132:133], v[14:15] op_sel_hi:[1,0]
  v_pk_mul_f32 v[134:135], v[134:135], v[14:15] op_sel_hi:[1,0]
  v_pk_mul_f32 v[136:137], v[136:137], v[14:15] op_sel_hi:[1,0]
  v_pk_mul_f32 v[138:139], v[138:139], v[14:15] op_sel_hi:[1,0]
  v_cvt_pk_bf16_f32 v24, v128, v129
  v_cvt_pk_bf16_f32 v25, v130, v131
  v_cvt_pk_bf16_f32 v26, v132, v133
  v_cvt_pk_bf16_f32 v27, v134, v135
  v_cvt_pk_bf16_f32 v28, v136, v137
  v_cvt_pk_bf16_f32 v29, v138, v139
  buffer_store_dwordx4 v[24:27], v8, s[24:27], s85 offen offset:512
  buffer_store_dwordx2 v[28:29], v9, s[24:27], s86 offen offset:512
  s_waitcnt vmcnt(11)
  v_xor_b32 v160, s9, v160
  v_xor_b32 v161, s9, v161
  v_xor_b32 v162, s9, v162
  v_xor_b32 v163, s9, v163
  v_or3_b32 v160, v160, v161, v162
  v_or_b32 v160, v160, v163
  v_cmp_eq_u32 vcc, 0, v160
  s_nop 0
  s_cmp_eq_u32 vcc_lo, -1
  s_cselect_b32 s95, 1, 0
  s_and_b32 s16, s10, 3
  s_lshl_b32 s16, s16, 3
  s_lshr_b32 s16, vcc_lo, s16
  s_and_b32 s16, s16, 0xff
  s_cmp_eq_u32 s16, 0xff
  s_cselect_b32 s72, 1, 0
  s_mov_b32 s16, 0x21800000
  s_mov_b32 s17, 0x5f800000
  v_cmp_le_f32 vcc, s16, v13
  v_cmp_ge_f32 s[18:19], s17, v13
  s_nop 0
  s_and_b64 s[14:15], vcc, s[18:19]
  v_cmp_le_f32 vcc, s16, v15
  v_cmp_ge_f32 s[18:19], s17, v15
  s_and_b64 s[14:15], s[14:15], vcc
  s_and_b64 s[14:15], s[14:15], s[18:19]
  s_cmp_eq_u64 s[14:15], -1
  s_cselect_b32 s16, 0, 1
  s_lshl_b32 s17, s12, 2
  s_add_u32 s17, s17, 110592
  v_mov_b32 v6, s16
  v_mov_b32 v7, s17
  ds_write_b32 v7, v6
  s_waitcnt lgkmcnt(0)
  s_barrier
  v_mov_b32 v7, 110592
  ds_read_b128 v[80:83], v7
  s_waitcnt lgkmcnt(0)
  v_or3_b32 v80, v80, v81, v82
  v_or_b32 v80, v80, v83
  s_nop 0
  v_readfirstlane_b32 s16, v80
  s_nop 0
  s_andn2_b32 s16, s16, s76
  s_cbranch_scc1 Lfallback
  s_mov_b32 s73, s72
  v_mov_b32 v76, v146
  v_mov_b32 v77, v147
  v_add_u32 v78, 51200, v1
  ds_read_b128 v[8:11], v1 offset:0
  ds_read_b128 v[12:15], v1 offset:1024
  ds_read_b128 v[16:19], v1 offset:2048
  ds_read_b128 v[20:23], v1 offset:3072
  ds_read_b128 v[24:27], v1 offset:4096
  ds_read_b128 v[28:31], v1 offset:5120
  s_add_u32 s52, s4, s75
  s_addc_u32 s53, s5, 0
  s_mov_b32 s54, 24576
  s_mov_b32 s55, 0x20000
  s_movk_i32 s17, 4096
  s_movk_i32 s18, 14336
  s_movk_i32 s19, 18432
  s_waitcnt vmcnt(0)
  v_mov_b32 v6, s0
  s_cmp_lg_u32 s73, 0
  s_cbranch_scc0 Lsigs0
  buffer_store_dword v6, v3, s[44:47], s79 offen offset:0
Lsigd0:
  v_lshlrev_b32 v56, 16, v164
  v_and_b32 v57, 0xffff0000, v164
  v_lshlrev_b32 v58, 16, v165
  v_and_b32 v59, 0xffff0000, v165
  v_lshlrev_b32 v60, 16, v166
  v_and_b32 v61, 0xffff0000, v166
  v_lshlrev_b32 v62, 16, v167
  v_and_b32 v63, 0xffff0000, v167
  v_lshlrev_b32 v64, 16, v168
  v_and_b32 v65, 0xffff0000, v168
  v_lshlrev_b32 v66, 16, v169
  v_and_b32 v67, 0xffff0000, v169
  v_lshlrev_b32 v68, 16, v170
  v_and_b32 v69, 0xffff0000, v170
  v_lshlrev_b32 v70, 16, v171
  v_and_b32 v71, 0xffff0000, v171
  v_lshlrev_b32 v72, 16, v144
  v_and_b32 v73, 0xffff0000, v144
  v_lshlrev_b32 v74, 16, v145
  v_and_b32 v75, 0xffff0000, v145
  v_lshrrev_b32 v81, 4, v0
  v_and_b32 v80, 15, v0
  v_lshlrev_b32 v80, 4, v80
  v_lshl_add_u32 v80, v81, 10, v80
  v_lshrrev_b32 v81, 1, v81
  v_lshl_add_u32 v81, v81, 11, v80
  s_mov_b32 s16, -1
  s_mov_b32 s80, 0x400000
Lpoll0:
  buffer_load_dword v6, v4, s[44:47], s79 offen offset:0 sc1
  s_sub_u32 s80, s80, 1
  s_cbranch_scc1 Lpolled0
  s_waitcnt vmcnt(0)
  v_cmp_eq_u32 vcc, s0, v6
  s_nop 0
  s_and_b32 s81, vcc_lo, s16
  s_cmp_eq_u32 s81, s16
  s_cbranch_scc0 Lpoll0
Lpolled0:
  s_cmp_lg_u32 s73, 0
  s_cbranch_scc0 Lacqs0
Lacq0:
  buffer_load_dwordx4 v[88:91], v80, s[52:55], 0 offen sc1
  buffer_load_dwordx4 v[92:95], v80, s[52:55], s17 offen sc1
  buffer_load_dwordx4 v[96:99], v81, s[52:55], s61 offen sc1
  buffer_load_dwordx4 v[100:103], v80, s[52:55], s18 offen sc1
  buffer_load_dwordx4 v[104:107], v80, s[52:55], s19 offen sc1
  s_add_u32 s52, s52, 24576
  s_addc_u32 s53, s53, 0
  buffer_load_dwordx4 v[108:111], v80, s[52:55], 0 offen sc1
  s_waitcnt vmcnt(5) lgkmcnt(5)
  v_mfma_f32_16x16x32_bf16 v[36:39], v[8:11], v[88:91], v[56:59]
  ds_read_b128 v[32:35], v1 offset:6144
  buffer_load_dwordx4 v[112:115], v80, s[52:55], s17 offen sc1
  s_waitcnt lgkmcnt(5)
  v_mfma_f32_16x16x32_bf16 v[40:43], v[12:15], v[88:91], v[60:63]
  ds_read_b128 v[8:11], v1 offset:7168
  s_waitcnt lgkmcnt(4)
  v_mfma_f32_16x16x32_bf16 v[44:47], v[16:19], v[88:91], v[64:67]
  ds_read_b128 v[12:15], v1 offset:8192
  v_mfma_f32_16x16x32_bf16 v[48:51], v[20:23], v[88:91], v[68:71]
  ds_read_b128 v[16:19], v1 offset:9216
  s_waitcnt lgkmcnt(4)
  v_mfma_f32_16x16x32_bf16 v[52:55], v[24:27], v[88:91], v[72:75]
  ds_read_b128 v[20:23], v1 offset:10240
  s_waitcnt vmcnt(5)
  v_mfma_f32_16x16x32_bf16 v[36:39], v[28:31], v[92:95], v[36:39]
  ds_read_b128 v[24:27], v1 offset:11264
  s_waitcnt lgkmcnt(4)
  v_mfma_f32_16x16x32_bf16 v[40:43], v[32:35], v[92:95], v[40:43]
  ds_read_b128 v[28:31], v1 offset:12288
  buffer_load_dwordx4 v[116:119], v81, s[52:55], s61 offen sc1
  v_mfma_f32_16x16x32_bf16 v[44:47], v[8:11], v[92:95], v[44:47]
  ds_read_b128 v[32:35], v1 offset:13312
  s_waitcnt lgkmcnt(4)
  v_mfma_f32_16x16x32_bf16 v[48:51], v[12:15], v[92:95], v[48:51]
  ds_read_b128 v[8:11], v1 offset:14336
  s_waitcnt vmcnt(5)
  v_mfma_f32_16x16x32_bf16 v[52:55], v[16:19], v[92:95], v[52:55]
  ds_read_b128 v[12:15], v1 offset:15360
  s_waitcnt lgkmcnt(4)
  v_mfma_f32_16x16x32_bf16 v[36:39], v[20:23], v[96:99], v[36:39]
  ds_read_b128 v[16:19], v1 offset:16384
  buffer_load_dwordx4 v[120:123], v80, s[52:55], s18 offen sc1
  v_mfma_f32_16x16x32_bf16 v[40:43], v[24:27], v[96:99], v[40:43]
  ds_read_b128 v[20:23], v1 offset:17408
  s_waitcnt lgkmcnt(4)
  v_mfma_f32_16x16x32_bf16 v[44:47], v[28:31], v[96:99], v[44:47]
  ds_read_b128 v[24:27], v1 offset:18432
  v_mfma_f32_16x16x32_bf16 v[48:51], v[32:35], v[96:99], v[48:51]
  ds_read_b128 v[28:31], v1 offset:19456
  s_waitcnt lgkmcnt(4)
  v_mfma_f32_16x16x32_bf16 v[52:55], v[8:11], v[96:99], v[52:55]
  ds_read_b128 v[32:35], v1 offset:20480
  s_waitcnt vmcnt(5)
  v_mfma_f32_16x16x32_bf16 v[36:39], v[12:15], v[100:103], v[36:39]
  ds_read_b128 v[8:11], v1 offset:21504
  s_waitcnt lgkmcnt(4)
  v_mfma_f32_16x16x32_bf16 v[40:43], v[16:19], v[100:103], v[40:43]
  ds_read_b128 v[12:15], v1 offset:22528
  buffer_load_dwordx4 v[124:127], v80, s[52:55], s19 offen sc1
  v_mfma_f32_16x16x32_bf16 v[44:47], v[20:23], v[100:103], v[44:47]
  ds_read_b128 v[16:19], v1 offset:23552
  s_waitcnt lgkmcnt(4)
  v_mfma_f32_16x16x32_bf16 v[48:51], v[24:27], v[100:103], v[48:51]
  ds_read_b128 v[20:23], v1 offset:24576
  s_waitcnt vmcnt(5)
  v_mfma_f32_16x16x32_bf16 v[52:55], v[28:31], v[100:103], v[52:55]
  ds_read_b128 v[24:27], v1 offset:25600
  s_waitcnt lgkmcnt(4)
  v_mfma_f32_16x16x32_bf16 v[36:39], v[32:35], v[104:107], v[36:39]
  ds_read_b128 v[28:31], v1 offset:26624
  s_add_u32 s52, s52, 24576
  s_addc_u32 s53, s53, 0
  buffer_load_dwordx4 v[128:131], v80, s[52:55], 0 offen sc1
  v_mfma_f32_16x16x32_bf16 v[40:43], v[8:11], v[104:107], v[40:43]
  ds_read_b128 v[32:35], v1 offset:27648
  s_waitcnt lgkmcnt(4)
  v_mfma_f32_16x16x32_bf16 v[44:47], v[12:15], v[104:107], v[44:47]
  ds_read_b128 v[8:11], v1 offset:28672
  v_mfma_f32_16x16x32_bf16 v[48:51], v[16:19], v[104:107], v[48:51]
  ds_read_b128 v[12:15], v1 offset:29696
  s_waitcnt lgkmcnt(4)
  v_mfma_f32_16x16x32_bf16 v[52:55], v[20:23], v[104:107], v[52:55]
  ds_read_b128 v[16:19], v1 offset:30720
  s_waitcnt vmcnt(5)
  v_mfma_f32_16x16x32_bf16 v[36:39], v[24:27], v[108:111], v[36:39]
  ds_read_b128 v[20:23], v1 offset:31744
  s_waitcnt lgkmcnt(4)
  v_mfma_f32_16x16x32_bf16 v[40:43], v[28:31], v[108:111], v[40:43]
  ds_read_b128 v[24:27], v1 offset:32768
  buffer_load_dwordx4 v[132:135], v80, s[52:55], s17 offen sc1
  v_mfma_f32_16x16x32_bf16 v[44:47], v[32:35], v[108:111], v[44:47]
  ds_read_b128 v[28:31], v1 offset:33792
  s_waitcnt lgkmcnt(4)
  v_mfma_f32_16x16x32_bf16 v[48:51], v[8:11], v[108:111], v[48:51]
  ds_read_b128 v[32:35], v1 offset:34816
  s_waitcnt vmcnt(5)
  v_mfma_f32_16x16x32_bf16 v[52:55], v[12:15], v[108:111], v[52:55]
  ds_read_b128 v[8:11], v1 offset:35840
  s_waitcnt lgkmcnt(4)
  v_mfma_f32_16x16x32_bf16 v[36:39], v[16:19], v[112:115], v[36:39]
  ds_read_b128 v[12:15], v1 offset:36864
  buffer_load_dwordx4 v[136:139], v81, s[52:55], s61 offen sc1
  v_mfma_f32_16x16x32_bf16 v[40:43], v[20:23], v[112:115], v[40:43]
  ds_read_b128 v[16:19], v1 offset:37888
  s_waitcnt lgkmcnt(4)
  v_mfma_f32_16x16x32_bf16 v[44:47], v[24:27], v[112:115], v[44:47]
  ds_read_b128 v[20:23], v1 offset:38912
  v_mfma_f32_16x16x32_bf16 v[48:51], v[28:31], v[112:115], v[48:51]
  ds_read_b128 v[24:27], v1 offset:39936
  s_waitcnt lgkmcnt(4)
  v_mfma_f32_16x16x32_bf16 v[52:55], v[32:35], v[112:115], v[52:55]
  ds_read_b128 v[28:31], v1 offset:40960
  s_waitcnt vmcnt(5)
  v_mfma_f32_16x16x32_bf16 v[36:39], v[8:11], v[116:119], v[36:39]
  ds_read_b128 v[32:35], v1 offset:41984
  s_waitcnt lgkmcnt(4)
  v_mfma_f32_16x16x32_bf16 v[40:43], v[12:15], v[116:119], v[40:43]
  ds_read_b128 v[8:11], v1 offset:43008
  buffer_load_dwordx4 v[140:143], v80, s[52:55], s18 offen sc1
  v_mfma_f32_16x16x32_bf16 v[44:47], v[16:19], v[116:119], v[44:47]
  ds_read_b128 v[12:15], v1 offset:44032
  s_waitcnt lgkmcnt(4)
  v_mfma_f32_16x16x32_bf16 v[48:51], v[20:23], v[116:119], v[48:51]
  ds_read_b128 v[16:19], v1 offset:45056
  s_waitcnt vmcnt(5)
  v_mfma_f32_16x16x32_bf16 v[52:55], v[24:27], v[116:119], v[52:55]
  ds_read_b128 v[20:23], v1 offset:46080
  s_waitcnt lgkmcnt(4)
  v_mfma_f32_16x16x32_bf16 v[36:39], v[28:31], v[120:123], v[36:39]
  ds_read_b128 v[24:27], v1 offset:47104
  buffer_load_dwordx4 v[144:147], v80, s[52:55], s19 offen sc1
  v_mfma_f32_16x16x32_bf16 v[40:43], v[32:35], v[120:123], v[40:43]
  ds_read_b128 v[28:31], v1 offset:48128
  s_waitcnt lgkmcnt(4)
  v_mfma_f32_16x16x32_bf16 v[44:47], v[8:11], v[120:123], v[44:47]
  ds_read_b128 v[32:35], v1 offset:49152
  v_mfma_f32_16x16x32_bf16 v[48:51], v[12:15], v[120:123], v[48:51]
  ds_read_b128 v[8:11], v1 offset:50176
  s_waitcnt lgkmcnt(4)
  v_mfma_f32_16x16x32_bf16 v[52:55], v[16:19], v[120:123], v[52:55]
  ds_read_b128 v[12:15], v78 offset:0
  s_waitcnt vmcnt(5)
  v_mfma_f32_16x16x32_bf16 v[36:39], v[20:23], v[124:127], v[36:39]
  ds_read_b128 v[16:19], v78 offset:1024
  s_waitcnt lgkmcnt(4)
  v_mfma_f32_16x16x32_bf16 v[40:43], v[24:27], v[124:127], v[40:43]
  ds_read_b128 v[20:23], v78 offset:2048
  s_add_u32 s52, s52, 24576
  s_addc_u32 s53, s53, 0
  buffer_load_dwordx4 v[148:151], v80, s[52:55], 0 offen sc1
  v_mfma_f32_16x16x32_bf16 v[44:47], v[28:31], v[124:127], v[44:47]
  ds_read_b128 v[24:27], v78 offset:3072
  s_waitcnt lgkmcnt(4)
  v_mfma_f32_16x16x32_bf16 v[48:51], v[32:35], v[124:127], v[48:51]
  ds_read_b128 v[28:31], v78 offset:4096
  s_waitcnt vmcnt(5)
  v_mfma_f32_16x16x32_bf16 v[52:55], v[8:11], v[124:127], v[52:55]
  ds_read_b128 v[32:35], v78 offset:5120
  s_waitcnt lgkmcnt(4)
  v_mfma_f32_16x16x32_bf16 v[36:39], v[12:15], v[128:131], v[36:39]
  ds_read_b128 v[8:11], v78 offset:6144
  buffer_load_dwordx4 v[152:155], v80, s[52:55], s17 offen sc1
  v_mfma_f32_16x16x32_bf16 v[40:43], v[16:19], v[128:131], v[40:43]
  ds_read_b128 v[12:15], v78 offset:7168
  s_waitcnt lgkmcnt(4)
  v_mfma_f32_16x16x32_bf16 v[44:47], v[20:23], v[128:131], v[44:47]
  ds_read_b128 v[16:19], v78 offset:8192
  v_mfma_f32_16x16x32_bf16 v[48:51], v[24:27], v[128:131], v[48:51]
  ds_read_b128 v[20:23], v78 offset:9216
  s_waitcnt lgkmcnt(4)
  v_mfma_f32_16x16x32_bf16 v[52:55], v[28:31], v[128:131], v[52:55]
  ds_read_b128 v[24:27], v78 offset:10240
  s_waitcnt vmcnt(5)
  v_mfma_f32_16x16x32_bf16 v[36:39], v[32:35], v[132:135], v[36:39]
  ds_read_b128 v[28:31], v78 offset:11264
  s_waitcnt lgkmcnt(4)
  v_mfma_f32_16x16x32_bf16 v[40:43], v[8:11], v[132:135], v[40:43]
  ds_read_b128 v[32:35], v78 offset:12288
  buffer_load_dwordx4 v[156:159], v81, s[52:55], s61 offen sc1
  v_mfma_f32_16x16x32_bf16 v[44:47], v[12:15], v[132:135], v[44:47]
  ds_read_b128 v[8:11], v78 offset:13312
  s_waitcnt lgkmcnt(4)
  v_mfma_f32_16x16x32_bf16 v[48:51], v[16:19], v[132:135], v[48:51]
  ds_read_b128 v[12:15], v78 offset:14336
  s_waitcnt vmcnt(5)
  v_mfma_f32_16x16x32_bf16 v[52:55], v[20:23], v[132:135], v[52:55]
  ds_read_b128 v[16:19], v78 offset:15360
  s_waitcnt lgkmcnt(4)
  v_mfma_f32_16x16x32_bf16 v[36:39], v[24:27], v[136:139], v[36:39]
  ds_read_b128 v[20:23], v78 offset:16384
  buffer_load_dwordx4 v[160:163], v80, s[52:55], s18 offen sc1
  v_mfma_f32_16x16x32_bf16 v[40:43], v[28:31], v[136:139], v[40:43]
  ds_read_b128 v[24:27], v78 offset:17408
  s_waitcnt lgkmcnt(4)
  v_mfma_f32_16x16x32_bf16 v[44:47], v[32:35], v[136:139], v[44:47]
  ds_read_b128 v[28:31], v78 offset:18432
  v_mfma_f32_16x16x32_bf16 v[48:51], v[8:11], v[136:139], v[48:51]
  ds_read_b128 v[32:35], v78 offset:19456
  s_waitcnt lgkmcnt(4)
  v_mfma_f32_16x16x32_bf16 v[52:55], v[12:15], v[136:139], v[52:55]
  ds_read_b128 v[8:11], v78 offset:20480
  s_waitcnt vmcnt(5)
  v_mfma_f32_16x16x32_bf16 v[36:39], v[16:19], v[140:143], v[36:39]
  ds_read_b128 v[12:15], v78 offset:21504
  s_waitcnt lgkmcnt(4)
  v_mfma_f32_16x16x32_bf16 v[40:43], v[20:23], v[140:143], v[40:43]
  ds_read_b128 v[16:19], v78 offset:22528
  buffer_load_dwordx4 v[164:167], v80, s[52:55], s19 offen sc1
  v_mfma_f32_16x16x32_bf16 v[44:47], v[24:27], v[140:143], v[44:47]
  ds_read_b128 v[20:23], v78 offset:23552
  s_waitcnt lgkmcnt(4)
  v_mfma_f32_16x16x32_bf16 v[48:51], v[28:31], v[140:143], v[48:51]
  ds_read_b128 v[24:27], v78 offset:24576
  s_waitcnt vmcnt(5)
  v_mfma_f32_16x16x32_bf16 v[52:55], v[32:35], v[140:143], v[52:55]
  ds_read_b128 v[28:31], v78 offset:25600
  s_waitcnt lgkmcnt(4)
  v_mfma_f32_16x16x32_bf16 v[36:39], v[8:11], v[144:147], v[36:39]
  ds_read_b128 v[32:35], v78 offset:26624
  v_mfma_f32_16x16x32_bf16 v[40:43], v[12:15], v[144:147], v[40:43]
  ds_read_b128 v[8:11], v78 offset:27648
  s_waitcnt lgkmcnt(4)
  v_mfma_f32_16x16x32_bf16 v[44:47], v[16:19], v[144:147], v[44:47]
  ds_read_b128 v[12:15], v78 offset:28672
  v_mfma_f32_16x16x32_bf16 v[48:51], v[20:23], v[144:147], v[48:51]
  ds_read_b128 v[16:19], v78 offset:29696
  s_waitcnt lgkmcnt(4)
  v_mfma_f32_16x16x32_bf16 v[52:55], v[24:27], v[144:147], v[52:55]
  ds_read_b128 v[20:23], v78 offset:30720
  s_waitcnt vmcnt(4)
  v_mfma_f32_16x16x32_bf16 v[36:39], v[28:31], v[148:151], v[36:39]
  ds_read_b128 v[24:27], v78 offset:31744
  s_waitcnt lgkmcnt(4)
  v_mfma_f32_16x16x32_bf16 v[40:43], v[32:35], v[148:151], v[40:43]
  ds_read_b128 v[28:31], v78 offset:32768
  v_mfma_f32_16x16x32_bf16 v[44:47], v[8:11], v[148:151], v[44:47]
  ds_read_b128 v[32:35], v78 offset:33792
  s_waitcnt lgkmcnt(4)
  v_mfma_f32_16x16x32_bf16 v[48:51], v[12:15], v[148:151], v[48:51]
  ds_read_b128 v[8:11], v78 offset:34816
  s_waitcnt vmcnt(3)
  v_mfma_f32_16x16x32_bf16 v[52:55], v[16:19], v[148:151], v[52:55]
  ds_read_b128 v[12:15], v78 offset:35840
  s_waitcnt lgkmcnt(4)
  v_mfma_f32_16x16x32_bf16 v[36:39], v[20:23], v[152:155], v[36:39]
  ds_read_b128 v[16:19], v78 offset:36864
  v_mfma_f32_16x16x32_bf16 v[40:43], v[24:27], v[152:155], v[40:43]
  ds_read_b128 v[20:23], v78 offset:37888
  s_waitcnt lgkmcnt(4)
  v_mfma_f32_16x16x32_bf16 v[44:47], v[28:31], v[152:155], v[44:47]
  ds_read_b128 v[24:27], v78 offset:38912
  v_mfma_f32_16x16x32_bf16 v[48:51], v[32:35], v[152:155], v[48:51]
  ds_read_b128 v[28:31], v78 offset:39936
  s_waitcnt lgkmcnt(4)
  v_mfma_f32_16x16x32_bf16 v[52:55], v[8:11], v[152:155], v[52:55]
  ds_read_b128 v[32:35], v78 offset:40960
  s_waitcnt vmcnt(2)
  v_mfma_f32_16x16x32_bf16 v[36:39], v[12:15], v[156:159], v[36:39]
  ds_read_b128 v[8:11], v78 offset:41984
  s_waitcnt lgkmcnt(4)
  v_mfma_f32_16x16x32_bf16 v[40:43], v[16:19], v[156:159], v[40:43]
  ds_read_b128 v[12:15], v78 offset:43008
  v_mfma_f32_16x16x32_bf16 v[44:47], v[20:23], v[156:159], v[44:47]
  ds_read_b128 v[16:19], v78 offset:44032
  s_waitcnt lgkmcnt(4)
  v_mfma_f32_16x16x32_bf16 v[48:51], v[24:27], v[156:159], v[48:51]
  ds_read_b128 v[20:23], v78 offset:45056
  s_waitcnt vmcnt(1)
  v_mfma_f32_16x16x32_bf16 v[52:55], v[28:31], v[156:159], v[52:55]
  ds_read_b128 v[24:27], v78 offset:46080
  s_waitcnt lgkmcnt(4)
  v_mfma_f32_16x16x32_bf16 v[36:39], v[32:35], v[160:163], v[36:39]
  ds_read_b128 v[28:31], v78 offset:47104
  v_mfma_f32_16x16x32_bf16 v[40:43], v[8:11], v[160:163], v[40:43]
  ds_read_b128 v[32:35], v78 offset:48128
  s_waitcnt lgkmcnt(4)
  v_mfma_f32_16x16x32_bf16 v[44:47], v[12:15], v[160:163], v[44:47]
  ds_read_b128 v[8:11], v78 offset:49152
  v_mfma_f32_16x16x32_bf16 v[48:51], v[16:19], v[160:163], v[48:51]
  ds_read_b128 v[12:15], v78 offset:50176
  s_waitcnt lgkmcnt(4)
  v_mfma_f32_16x16x32_bf16 v[52:55], v[20:23], v[160:163], v[52:55]
  s_waitcnt vmcnt(0)
  v_mfma_f32_16x16x32_bf16 v[36:39], v[24:27], v[164:167], v[36:39]
  s_waitcnt lgkmcnt(2)
  v_mfma_f32_16x16x32_bf16 v[40:43], v[28:31], v[164:167], v[40:43]
  v_mfma_f32_16x16x32_bf16 v[44:47], v[32:35], v[164:167], v[44:47]
  s_waitcnt lgkmcnt(0)
  v_mfma_f32_16x16x32_bf16 v[48:51], v[8:11], v[164:167], v[48:51]
  v_mfma_f32_16x16x32_bf16 v[52:55], v[12:15], v[164:167], v[52:55]
  s_nop 1
  v_cvt_pk_bf16_f32 v96, v36, v37
  v_cvt_pk_bf16_f32 v97, v38, v39
  v_cvt_pk_bf16_f32 v98, v40, v41
  v_cvt_pk_bf16_f32 v99, v42, v43
  v_cvt_pk_bf16_f32 v100, v44, v45
  v_cvt_pk_bf16_f32 v101, v46, v47
  v_cvt_pk_bf16_f32 v102, v48, v49
  v_cvt_pk_bf16_f32 v103, v50, v51
  v_cvt_pk_bf16_f32 v104, v52, v53
  v_cvt_pk_bf16_f32 v105, v54, v55
  buffer_store_dwordx4 v[96:99], v1, s[56:59], s70 offen
  buffer_store_dwordx4 v[100:103], v1, s[56:59], s70 offen offset:1024
  buffer_store_dwordx2 v[104:105], v76, s[56:59], s70 offen offset:2048
  s_barrier
  v_pk_add_f32 v[108:109], v[36:37], v[38:39]
  v_pk_mul_f32 v[110:111], v[36:37], v[36:37]
  v_pk_fma_f32 v[110:111], v[38:39], v[38:39], v[110:111]
  v_pk_add_f32 v[108:109], v[108:109], v[40:41]
  v_pk_fma_f32 v[110:111], v[40:41], v[40:41], v[110:111]
  v_pk_add_f32 v[108:109], v[108:109], v[42:43]
  v_pk_fma_f32 v[110:111], v[42:43], v[42:43], v[110:111]
  v_pk_add_f32 v[108:109], v[108:109], v[44:45]
  v_pk_fma_f32 v[110:111], v[44:45], v[44:45], v[110:111]
  v_pk_add_f32 v[108:109], v[108:109], v[46:47]
  v_pk_fma_f32 v[110:111], v[46:47], v[46:47], v[110:111]
  v_pk_add_f32 v[108:109], v[108:109], v[48:49]
  v_pk_fma_f32 v[110:111], v[48:49], v[48:49], v[110:111]
  v_pk_add_f32 v[108:109], v[108:109], v[50:51]
  v_pk_fma_f32 v[110:111], v[50:51], v[50:51], v[110:111]
  v_pk_add_f32 v[108:109], v[108:109], v[52:53]
  v_pk_fma_f32 v[110:111], v[52:53], v[52:53], v[110:111]
  v_pk_add_f32 v[108:109], v[108:109], v[54:55]
  v_pk_fma_f32 v[110:111], v[54:55], v[54:55], v[110:111]
  v_add_f32 v108, v108, v109
  v_add_f32 v109, v110, v111
  v_mov_b32 v110, v108
  v_mov_b32 v111, v109
  s_nop 0
  v_permlane16_swap_b32 v108, v110
  v_permlane16_swap_b32 v109, v111
  v_pk_add_f32 v[108:109], v[108:109], v[110:111]
  v_mov_b32 v110, v108
  v_mov_b32 v111, v109
  s_nop 0
  v_permlane32_swap_b32 v108, v110
  v_permlane32_swap_b32 v109, v111
  v_pk_add_f32 v[108:109], v[108:109], v[110:111]
  buffer_store_dwordx2 v[108:109], v77, s[56:59], s71 offen
  v_and_b32 v107, 15, v0
  v_bfe_u32 v6, v0, 4, 1
  v_mul_u32_u24 v106, 20480, v6
  v_lshl_add_u32 v106, v107, 4, v106
  v_lshrrev_b32 v6, 5, v0
  v_lshl_add_u32 v106, v6, 8, v106
  v_lshrrev_b32 v6, 4, v0
  v_lshlrev_b32 v107, 3, v107
  v_lshl_add_u32 v107, v6, 8, v107
  s_lshr_b32 s13, s8, 3
  s_mul_i32 s13, s13, 20480
  s_add_u32 s13, s13, 16777216
  s_add_u32 s24, s4, s13
  s_addc_u32 s25, s5, 0
  s_mov_b32 s26, 4096
  s_mov_b32 s27, 0x20000
  s_lshr_b32 s13, s8, 3
  s_lshl_b32 s13, s13, 10
  s_add_u32 s13, s13, 19398656
  s_add_u32 s28, s4, s13
  s_addc_u32 s29, s5, 0
  s_mov_b32 s30, 1024
  s_mov_b32 s31, 0x20000
  s_mul_i32 m0, s12, 20480
  s_mul_i32 s13, s10, 221184
  s_lshl_b32 s14, s84, 12
  s_add_u32 s13, s13, s14
  s_add_u32 s13, s13, 20971520
  s_min_u32 s14, s82, 4096
  s_add_u32 s52, s4, s13
  s_addc_u32 s53, s5, 0
  s_mov_b32 s54, s14
  s_mov_b32 s55, 0x20000
  s_add_u32 s13, s13, 4096
  s_min_u32 s14, s83, 4096
  s_add_u32 s56, s4, s13
  s_addc_u32 s57, s5, 0
  s_mov_b32 s58, s14
  s_mov_b32 s59, 0x20000
  s_sub_u32 s75, s87, 9216
  s_mov_b32 s43, 0x20000
  s_mul_i32 s13, s10, 221184
  s_mul_i32 s14, s12, 57344
  s_add_u32 s13, s13, s14
  s_add_u32 s13, s13, 20971520
  s_sub_u32 s15, 221184, s14
  s_mov_b32 s14, s13
  s_add_u32 s13, s12, 0
  s_and_b32 s13, s13, 3
  s_lshl_b32 s13, s13, 10
  v_add_u32 v88, s13, v1
  s_add_u32 s13, s12, 1
  s_and_b32 s13, s13, 3
  s_lshl_b32 s13, s13, 10
  v_add_u32 v89, s13, v1
  s_add_u32 s13, s12, 2
  s_and_b32 s13, s13, 3
  s_lshl_b32 s13, s13, 10
  v_add_u32 v90, s13, v1
  s_add_u32 s13, s12, 3
  s_and_b32 s13, s13, 3
  s_lshl_b32 s13, s13, 10
  v_add_u32 v91, s13, v1
  v_bfe_u32 v6, v0, 4, 1
  v_and_b32 v148, 15, v0
  v_lshlrev_b32 v148, 4, v148
  v_lshl_add_u32 v148, v6, 10, v148
  v_lshrrev_b32 v6, 5, v0
  v_lshl_add_u32 v148, v6, 8, v148
  s_waitcnt vmcnt(0)
  v_mov_b32 v6, s0
  s_cmp_lg_u32 s73, 0
  s_cbranch_scc0 Lsigs1
  buffer_store_dword v6, v3, s[44:47], s79 offen offset:128
Lsigd1:
  s_mov_b32 s80, 0x400000
Lpoll1:
  buffer_load_dword v6, v4, s[44:47], s79 offen offset:128 sc1
  s_sub_u32 s80, s80, 1
  s_cbranch_scc1 Lpolled1
  s_waitcnt vmcnt(0)
  v_cmp_eq_u32 vcc, s0, v6
  s_nop 0
  s_and_b32 s81, vcc_lo, s78
  s_cmp_eq_u32 s81, s78
  s_cbranch_scc0 Lpoll1
Lpolled1:
  s_cmp_lg_u32 s73, 0
  s_cbranch_scc0 Lacqs1
Lacq1:
  buffer_load_dwordx4 v1, s[24:27], 0 offen offset:0 sc1 lds
  buffer_load_dwordx4 v1, s[24:27], 0 offen offset:1024 sc1 lds
  buffer_load_dwordx4 v1, s[24:27], 0 offen offset:2048 sc1 lds
  buffer_load_dwordx4 v1, s[24:27], 0 offen offset:3072 sc1 lds
  s_add_u32 m0, m0, 4096
  s_add_u32 s24, s24, 4096
  s_addc_u32 s25, s25, 0
  buffer_load_dwordx4 v1, s[24:27], 0 offen offset:0 sc1 lds
  buffer_load_dwordx2 v[92:93], v107, s[28:31], 0 offen sc1
  buffer_load_dwordx2 v[94:95], v107, s[28:31], 0 offen offset:128 sc1
  buffer_load_dwordx4 v1, s[24:27], 0 offen offset:1024 sc1 lds
  buffer_load_dwordx4 v1, s[24:27], 0 offen offset:2048 sc1 lds
  buffer_load_dwordx4 v1, s[24:27], 0 offen offset:3072 sc1 lds
  s_waitcnt vmcnt(8)
  s_barrier
  ds_read_b128 v[56:59], v106 offset:0
  ds_read_b128 v[60:63], v106 offset:40960
  ds_read_b128 v[64:67], v106 offset:512
  ds_read_b128 v[68:71], v106 offset:41472
  ds_read_b128 v[72:75], v106 offset:1024
  s_waitcnt lgkmcnt(4)
  v_mfma_f32_32x32x16_bf16 v[8:23], v[188:191], v[56:59], 0
  ds_read_b128 v[76:79], v106 offset:41984
  s_add_u32 m0, m0, 4096
  s_add_u32 s24, s24, 4096
  s_addc_u32 s25, s25, 0
  buffer_load_dwordx4 v1, s[24:27], 0 offen offset:0 sc1 lds
  s_waitcnt lgkmcnt(4)
  v_mfma_f32_32x32x16_bf16 v[24:39], v[188:191], v[60:63], 0
  ds_read_b128 v[56:59], v106 offset:1536
  buffer_load_dwordx4 v1, s[24:27], 0 offen offset:1024 sc1 lds
  s_waitcnt lgkmcnt(3)
  v_mfma_f32_32x32x16_bf16 v[8:23], v[192:195], v[64:67], v[8:23]
  ds_read_b128 v[60:63], v106 offset:42496
  buffer_load_dwordx4 v1, s[24:27], 0 offen offset:2048 sc1 lds
  v_mfma_f32_32x32x16_bf16 v[24:39], v[192:195], v[68:71], v[24:39]
  s_waitcnt vmcnt(8)
  s_barrier
  ds_read_b128 v[64:67], v106 offset:2048
  buffer_load_dwordx4 v1, s[24:27], 0 offen offset:3072 sc1 lds
  s_waitcnt lgkmcnt(3)
  v_mfma_f32_32x32x16_bf16 v[8:23], v[196:199], v[72:75], v[8:23]
  ds_read_b128 v[68:71], v106 offset:43008
  s_add_u32 m0, m0, 4096
  s_add_u32 s24, s24, 4096
  s_addc_u32 s25, s25, 0
  buffer_load_dwordx4 v1, s[24:27], 0 offen offset:0 sc1 lds
  v_mfma_f32_32x32x16_bf16 v[24:39], v[196:199], v[76:79], v[24:39]
  ds_read_b128 v[72:75], v106 offset:2560
  buffer_load_dwordx4 v1, s[24:27], 0 offen offset:1024 sc1 lds
  s_waitcnt lgkmcnt(3)
  v_mfma_f32_32x32x16_bf16 v[8:23], v[200:203], v[56:59], v[8:23]
  ds_read_b128 v[76:79], v106 offset:43520
  buffer_load_dwordx4 v1, s[24:27], 0 offen offset:2048 sc1 lds
  v_mfma_f32_32x32x16_bf16 v[24:39], v[200:203], v[60:63], v[24:39]
  ds_read_b128 v[56:59], v106 offset:3072
  buffer_load_dwordx4 v1, s[24:27], 0 offen offset:3072 sc1 lds
  s_waitcnt lgkmcnt(3)
  v_mfma_f32_32x32x16_bf16 v[8:23], v[204:207], v[64:67], v[8:23]
  ds_read_b128 v[60:63], v106 offset:44032
  s_add_u32 m0, m0, 4096
  s_add_u32 s24, s24, 4096
  s_addc_u32 s25, s25, 0
  buffer_load_dwordx4 v1, s[24:27], 0 offen offset:0 sc1 lds
  v_mfma_f32_32x32x16_bf16 v[24:39], v[204:207], v[68:71], v[24:39]
  ds_read_b128 v[64:67], v106 offset:3584
  buffer_load_dwordx4 v1, s[24:27], 0 offen offset:1024 sc1 lds
  s_waitcnt lgkmcnt(3)
  v_mfma_f32_32x32x16_bf16 v[8:23], v[208:211], v[72:75], v[8:23]
  ds_read_b128 v[68:71], v106 offset:44544
  buffer_load_dwordx4 v1, s[24:27], 0 offen offset:2048 sc1 lds
  v_mfma_f32_32x32x16_bf16 v[24:39], v[208:211], v[76:79], v[24:39]
  ds_read_b128 v[72:75], v106 offset:4096
  buffer_load_dwordx4 v1, s[24:27], 0 offen offset:3072 sc1 lds
  s_waitcnt lgkmcnt(3)
  v_mfma_f32_32x32x16_bf16 v[8:23], v[212:215], v[56:59], v[8:23]
  ds_read_b128 v[76:79], v106 offset:45056
  v_mfma_f32_32x32x16_bf16 v[24:39], v[212:215], v[60:63], v[24:39]
  ds_read_b128 v[56:59], v106 offset:4608
  s_waitcnt lgkmcnt(3)
  v_mfma_f32_32x32x16_bf16 v[8:23], v[216:219], v[64:67], v[8:23]
  ds_read_b128 v[60:63], v106 offset:45568
  v_mfma_f32_32x32x16_bf16 v[24:39], v[216:219], v[68:71], v[24:39]
  s_waitcnt vmcnt(10)
  s_barrier
  ds_read_b128 v[64:67], v106 offset:5120
  s_waitcnt lgkmcnt(3)
  v_mfma_f32_32x32x16_bf16 v[8:23], v[220:223], v[72:75], v[8:23]
  ds_read_b128 v[68:71], v106 offset:46080
  v_mfma_f32_32x32x16_bf16 v[24:39], v[220:223], v[76:79], v[24:39]
  ds_read_b128 v[72:75], v106 offset:5632
  s_waitcnt lgkmcnt(3)
  v_mfma_f32_32x32x16_bf16 v[8:23], v[224:227], v[56:59], v[8:23]
  ds_read_b128 v[76:79], v106 offset:46592
  v_mfma_f32_32x32x16_bf16 v[24:39], v[224:227], v[60:63], v[24:39]
  ds_read_b128 v[56:59], v106 offset:6144
  s_waitcnt lgkmcnt(3)
  v_mfma_f32_32x32x16_bf16 v[8:23], v[228:231], v[64:67], v[8:23]
  ds_read_b128 v[60:63], v106 offset:47104
  buffer_load_dwordx4 v[240:243], v2, s[32:35], 0 offen offset:1024
  buffer_load_dwordx4 v[244:247], v2, s[32:35], 0 offen offset:2048
  v_mfma_f32_32x32x16_bf16 v[24:39], v[228:231], v[68:71], v[24:39]
  ds_read_b128 v[64:67], v106 offset:6656
  s_waitcnt lgkmcnt(3)
  v_mfma_f32_32x32x16_bf16 v[8:23], v[232:235], v[72:75], v[8:23]
  ds_read_b128 v[68:71], v106 offset:47616
  v_mfma_f32_32x32x16_bf16 v[24:39], v[232:235], v[76:79], v[24:39]
  ds_read_b128 v[72:75], v106 offset:7168
  s_waitcnt lgkmcnt(3)
  v_mfma_f32_32x32x16_bf16 v[8:23], v[236:239], v[56:59], v[8:23]
  ds_read_b128 v[76:79], v106 offset:48128
  buffer_load_dwordx4 v[248:251], v2, s[32:35], 0 offen offset:3072
  buffer_load_dwordx4 v[252:255], v1, s[32:35], s61 offen offset:0
  s_add_u32 s32, s4, s14
  s_addc_u32 s33, s5, 0
  s_mov_b32 s34, s15
  v_mfma_f32_32x32x16_bf16 v[24:39], v[236:239], v[60:63], v[24:39]
  ds_read_b128 v[56:59], v106 offset:7680
  s_waitcnt lgkmcnt(3)
  v_mfma_f32_32x32x16_bf16 v[8:23], a[0:3], v[64:67], v[8:23]
  ds_read_b128 v[60:63], v106 offset:48640
  v_mfma_f32_32x32x16_bf16 v[24:39], a[0:3], v[68:71], v[24:39]
  ds_read_b128 v[64:67], v106 offset:8192
  s_waitcnt lgkmcnt(3)
  v_mfma_f32_32x32x16_bf16 v[8:23], a[4:7], v[72:75], v[8:23]
  ds_read_b128 v[68:71], v106 offset:49152
  buffer_load_dwordx4 v[168:171], v1, s[36:39], s61 offen offset:0
  s_add_u32 s40, s88, 10240
  s_addc_u32 s41, s89, 0
  s_sub_i32 s42, s90, 10240
  s_max_i32 s42, s42, 0
  buffer_load_dwordx4 v[172:175], v1, s[40:43], 0 offen offset:3072
  v_mfma_f32_32x32x16_bf16 v[24:39], a[4:7], v[76:79], v[24:39]
  ds_read_b128 v[72:75], v106 offset:8704
  s_waitcnt lgkmcnt(3)
  v_mfma_f32_32x32x16_bf16 v[8:23], a[8:11], v[56:59], v[8:23]
  ds_read_b128 v[76:79], v106 offset:49664
  v_mfma_f32_32x32x16_bf16 v[24:39], a[8:11], v[60:63], v[24:39]
  ds_read_b128 v[56:59], v106 offset:9216
  s_waitcnt lgkmcnt(3)
  v_mfma_f32_32x32x16_bf16 v[8:23], a[12:15], v[64:67], v[8:23]
  ds_read_b128 v[60:63], v106 offset:50176
  buffer_load_dwordx4 v[176:179], v2, s[40:43], 0 offen offset:0
  s_add_u32 s40, s88, 20480
  s_addc_u32 s41, s89, 0
  s_sub_i32 s42, s90, 20480
  s_max_i32 s42, s42, 0
  buffer_load_dwordx4 v[180:183], v1, s[40:43], 0 offen offset:0
  v_add_f32 v92, v92, v94
  v_add_f32 v93, v93, v95
  v_mfma_f32_32x32x16_bf16 v[24:39], a[12:15], v[68:71], v[24:39]
  ds_read_b128 v[64:67], v106 offset:9728
  s_waitcnt lgkmcnt(3)
  v_mov_b32 v128, v92
  s_nop 1
  v_permlane16_swap_b32 v92, v128
  v_mfma_f32_32x32x16_bf16 v[8:23], a[16:19], v[72:75], v[8:23]
  ds_read_b128 v[68:71], v106 offset:50688
  v_add_f32 v92, v92, v128
  v_mov_b32 v128, v92
  v_mfma_f32_32x32x16_bf16 v[24:39], a[16:19], v[76:79], v[24:39]
  s_waitcnt vmcnt(13)
  s_barrier
  ds_read_b128 v[72:75], v106 offset:10240
  s_waitcnt lgkmcnt(3)
  v_permlane32_swap_b32 v92, v128
  v_add_f32 v92, v92, v128
  v_mfma_f32_32x32x16_bf16 v[8:23], a[20:23], v[56:59], v[8:23]
  ds_read_b128 v[76:79], v106 offset:51200
  buffer_load_dwordx4 v[184:187], v1, s[40:43], 0 offen offset:1024
  buffer_load_dwordx4 v[188:191], v1, s[40:43], 0 offen offset:2048
  v_mov_b32 v128, v93
  s_nop 1
  v_permlane16_swap_b32 v93, v128
  v_mfma_f32_32x32x16_bf16 v[24:39], a[20:23], v[60:63], v[24:39]
  ds_read_b128 v[56:59], v106 offset:10752
  s_waitcnt lgkmcnt(3)
  v_add_f32 v93, v93, v128
  v_mov_b32 v128, v93
  v_mfma_f32_32x32x16_bf16 v[8:23], a[24:27], v[64:67], v[8:23]
  ds_read_b128 v[60:63], v106 offset:51712
  v_permlane32_swap_b32 v93, v128
  v_add_f32 v93, v93, v128
  v_mfma_f32_32x32x16_bf16 v[24:39], a[24:27], v[68:71], v[24:39]
  ds_read_b128 v[64:67], v106 offset:11264
  s_waitcnt lgkmcnt(3)
  v_mul_f32 v92, 0x3acccccd, v92
  v_mul_f32 v93, 0x3acccccd, v93
  v_mfma_f32_32x32x16_bf16 v[8:23], a[28:31], v[72:75], v[8:23]
  ds_read_b128 v[68:71], v106 offset:52224
  buffer_load_dwordx4 v[192:195], v1, s[40:43], 0 offen offset:3072
  buffer_load_dwordx4 v[196:199], v2, s[40:43], 0 offen offset:0
  v_fma_f32 v93, -v92, v92, v93
  v_max_f32 v93, 0, v93
  v_mfma_f32_32x32x16_bf16 v[24:39], a[28:31], v[76:79], v[24:39]
  ds_read_b128 v[72:75], v106 offset:11776
  s_waitcnt lgkmcnt(3)
  v_add_f32 v93, 0x3727c5ac, v93
  v_rsq_f32 v128, v93
  v_mfma_f32_32x32x16_bf16 v[8:23], a[32:35], v[56:59], v[8:23]
  ds_read_b128 v[76:79], v106 offset:52736
  v_sub_f32 v92, 0, v92
  v_mul_f32 v93, v93, v128
  v_mfma_f32_32x32x16_bf16 v[24:39], a[32:35], v[60:63], v[24:39]
  ds_read_b128 v[56:59], v106 offset:12288
  s_waitcnt lgkmcnt(3)
  v_cvt_pk_bf16_f32 v133, v92, v93
  v_lshlrev_b32 v129, 16, v133
  v_mfma_f32_32x32x16_bf16 v[8:23], a[36:39], v[64:67], v[8:23]
  ds_read_b128 v[60:63], v106 offset:53248
  s_add_u32 s40, s88, 30720
  s_addc_u32 s41, s89, 0
  s_sub_i32 s42, s90, 30720
  s_max_i32 s42, s42, 0
  buffer_load_dwordx4 v[200:203], v1, s[40:43], 0 offen offset:0
  buffer_load_dwordx4 v[204:207], v1, s[40:43], 0 offen offset:1024
  v_sub_f32 v92, v92, v129
  v_cvt_pk_bf16_f32 v132, v129, v92
  v_mfma_f32_32x32x16_bf16 v[24:39], a[36:39], v[68:71], v[24:39]
  ds_read_b128 v[64:67], v106 offset:12800
  s_waitcnt lgkmcnt(3)
  v_and_b32 v129, 0xffff0000, v133
  v_sub_f32 v93, v93, v129
  v_mfma_f32_32x32x16_bf16 v[8:23], a[40:43], v[72:75], v[8:23]
  ds_read_b128 v[68:71], v106 offset:53760
  v_cvt_pk_bf16_f32 v134, v93, 0
  v_mov_b32 v135, 0
  v_mfma_f32_32x32x16_bf16 v[24:39], a[40:43], v[76:79], v[24:39]
  ds_read_b128 v[72:75], v106 offset:13312
  s_waitcnt lgkmcnt(3)
  s_lshl_b32 s13, s12, 4
  v_and_b32 v129, 15, v0
  v_mfma_f32_32x32x16_bf16 v[8:23], a[44:47], v[56:59], v[8:23]
  ds_read_b128 v[76:79], v106 offset:54272
  buffer_load_dwordx4 v[208:211], v1, s[40:43], 0 offen offset:2048
  buffer_load_dwordx4 v[212:215], v1, s[40:43], 0 offen offset:3072
  v_add_u32 v129, s13, v129
  v_lshlrev_b32 v92, 4, v129
  v_mfma_f32_32x32x16_bf16 v[24:39], a[44:47], v[60:63], v[24:39]
  ds_read_b128 v[56:59], v106 offset:13824
  s_waitcnt lgkmcnt(3)
  v_lshlrev_b32 v129, 2, v129
  v_add_u32 v92, 81920, v92
  v_mfma_f32_32x32x16_bf16 v[8:23], a[48:51], v[64:67], v[8:23]
  ds_read_b128 v[60:63], v106 offset:54784
  v_add_u32 v129, 82944, v129
  ds_write_b128 v92, v[132:135]
  v_mfma_f32_32x32x16_bf16 v[24:39], a[48:51], v[68:71], v[24:39]
  ds_read_b128 v[64:67], v106 offset:14336
  s_waitcnt lgkmcnt(4)
  ds_write_b32 v129, v128
  v_mfma_f32_32x32x16_bf16 v[8:23], a[52:55], v[72:75], v[8:23]
  ds_read_b128 v[68:71], v106 offset:55296
  buffer_load_dwordx4 v[216:219], v2, s[40:43], 0 offen offset:0
  s_add_u32 s40, s88, 35840
  s_addc_u32 s41, s89, 0
  s_sub_i32 s42, s90, 35840
  s_max_i32 s42, s42, 0
  buffer_load_dwordx4 v[220:223], v1, s[40:43], 0 offen offset:0
  v_mfma_f32_32x32x16_bf16 v[24:39], a[52:55], v[76:79], v[24:39]
  ds_read_b128 v[72:75], v106 offset:14848
  s_waitcnt lgkmcnt(5)
  v_mfma_f32_32x32x16_bf16 v[8:23], a[56:59], v[56:59], v[8:23]
  ds_read_b128 v[76:79], v106 offset:55808
  v_mfma_f32_32x32x16_bf16 v[24:39], a[56:59], v[60:63], v[24:39]
  s_waitcnt vmcnt(18)
  s_waitcnt lgkmcnt(0)
  s_barrier
  ds_read_b128 v[56:59], v106 offset:15360
  v_mfma_f32_32x32x16_bf16 v[8:23], a[60:63], v[64:67], v[8:23]
  ds_read_b128 v[60:63], v106 offset:56320
  buffer_load_dwordx4 v[224:227], v1, s[40:43], 0 offen offset:1024
  buffer_load_dwordx4 v[228:231], v1, s[40:43], 0 offen offset:2048
  v_mfma_f32_32x32x16_bf16 v[24:39], a[60:63], v[68:71], v[24:39]
  ds_read_b128 v[64:67], v106 offset:15872
  v_mfma_f32_32x32x16_bf16 v[8:23], a[64:67], v[72:75], v[8:23]
  ds_read_b128 v[68:71], v106 offset:56832
  v_and_b32 v128, 31, v0
  v_lshlrev_b32 v129, 2, v128
  v_mfma_f32_32x32x16_bf16 v[24:39], a[64:67], v[76:79], v[24:39]
  ds_read_b128 v[72:75], v106 offset:16384
  s_waitcnt lgkmcnt(3)
  v_lshlrev_b32 v128, 4, v128
  v_add_u32 v128, 81920, v128
  v_mfma_f32_32x32x16_bf16 v[8:23], a[68:71], v[56:59], v[8:23]
  ds_read_b128 v[76:79], v106 offset:57344
  buffer_load_dwordx4 v[232:235], v1, s[40:43], 0 offen offset:3072
  buffer_load_dwordx4 v[236:239], v2, s[40:43], 0 offen offset:0
  v_add_u32 v129, 82944, v129
  ds_read_b128 v[80:83], v128 offset:0
  v_mfma_f32_32x32x16_bf16 v[24:39], a[68:71], v[60:63], v[24:39]
  ds_read_b128 v[56:59], v106 offset:16896
  s_waitcnt lgkmcnt(4)
  ds_read_b32 v110, v129 offset:0
  ds_read_b128 v[84:87], v128 offset:512
  v_mfma_f32_32x32x16_bf16 v[8:23], a[72:75], v[64:67], v[8:23]
  ds_read_b128 v[60:63], v106 offset:57856
  ds_read_b32 v111, v129 offset:128
  v_mfma_f32_32x32x16_bf16 v[24:39], a[72:75], v[68:71], v[24:39]
  ds_read_b128 v[64:67], v106 offset:17408
  s_waitcnt lgkmcnt(7)
  v_mfma_f32_32x32x16_bf16 v[8:23], a[76:79], v[72:75], v[8:23]
  ds_read_b128 v[68:71], v106 offset:58368
  s_add_u32 s40, s88, 46080
  s_addc_u32 s41, s89, 0
  s_sub_i32 s42, s90, 46080
  s_max_i32 s42, s42, 0
  buffer_load_dwordx4 a[0:3], v1, s[40:43], 0 offen offset:0
  buffer_load_dwordx4 a[4:7], v1, s[40:43], 0 offen offset:1024
  v_mfma_f32_32x32x16_bf16 v[24:39], a[76:79], v[76:79], v[24:39]
  ds_read_b128 v[72:75], v106 offset:17920
  s_waitcnt lgkmcnt(4)
  v_mfma_f32_32x32x16_bf16 v[8:23], a[80:83], v[56:59], v[8:23]
  ds_read_b128 v[76:79], v106 offset:58880
  v_mfma_f32_32x32x16_bf16 v[24:39], a[80:83], v[60:63], v[24:39]
  ds_read_b128 v[56:59], v106 offset:18432
  s_waitcnt lgkmcnt(3)
  v_mfma_f32_32x32x16_bf16 v[8:23], a[84:87], v[64:67], v[8:23]
  ds_read_b128 v[60:63], v106 offset:59392
  buffer_load_dwordx4 a[8:11], v1, s[40:43], 0 offen offset:2048
  buffer_load_dwordx4 a[12:15], v1, s[40:43], 0 offen offset:3072
  v_mfma_f32_32x32x16_bf16 v[24:39], a[84:87], v[68:71], v[24:39]
  ds_read_b128 v[64:67], v106 offset:18944
  s_waitcnt lgkmcnt(3)
  v_mfma_f32_32x32x16_bf16 v[8:23], a[88:91], v[72:75], v[8:23]
  ds_read_b128 v[68:71], v106 offset:59904
  v_mfma_f32_32x32x16_bf16 v[24:39], a[88:91], v[76:79], v[24:39]
  ds_read_b128 v[72:75], v106 offset:19456
  s_waitcnt lgkmcnt(3)
  v_mfma_f32_32x32x16_bf16 v[8:23], a[92:95], v[56:59], v[8:23]
  ds_read_b128 v[76:79], v106 offset:60416
  buffer_load_dwordx4 a[16:19], v2, s[40:43], 0 offen offset:0
  s_add_u32 s40, s88, 56320
  s_addc_u32 s41, s89, 0
  s_sub_i32 s42, s90, 56320
  s_max_i32 s42, s42, 0
  buffer_load_dwordx4 a[20:23], v1, s[40:43], 0 offen offset:0
  v_mfma_f32_32x32x16_bf16 v[24:39], a[92:95], v[60:63], v[24:39]
  ds_read_b128 v[56:59], v106 offset:19968
  s_waitcnt lgkmcnt(3)
  s_waitcnt vmcnt(27)
  v_mfma_f32_32x32x16_bf16 v[8:23], v[240:243], v[64:67], v[8:23]
  ds_read_b128 v[60:63], v106 offset:60928
  v_mfma_f32_32x32x16_bf16 v[24:39], v[240:243], v[68:71], v[24:39]
  s_waitcnt lgkmcnt(2)
  s_waitcnt vmcnt(26)
  v_mfma_f32_32x32x16_bf16 v[8:23], v[244:247], v[72:75], v[8:23]
  buffer_load_dwordx4 a[24:27], v1, s[40:43], 0 offen offset:1024
  buffer_load_dwordx4 a[28:31], v1, s[40:43], 0 offen offset:2048
  v_mfma_f32_32x32x16_bf16 v[24:39], v[244:247], v[76:79], v[24:39]
  s_waitcnt lgkmcnt(0)
  s_waitcnt vmcnt(27)
  v_mfma_f32_32x32x16_bf16 v[8:23], v[248:251], v[56:59], v[8:23]
  v_mfma_f32_32x32x16_bf16 v[24:39], v[248:251], v[60:63], v[24:39]
  s_waitcnt vmcnt(26)
  v_mfma_f32_32x32x16_bf16 v[8:23], v[252:255], v[80:83], v[8:23]
  v_mfma_f32_32x32x16_bf16 v[24:39], v[252:255], v[84:87], v[24:39]
  v_mul_f32 v110, 0x3fb8aa3b, v110
  v_mul_f32 v111, 0x3fb8aa3b, v111
  ds_read_b128 v[56:59], v106 offset:0
  ds_read_b128 v[60:63], v106 offset:512
  ds_read_b128 v[64:67], v106 offset:1024
  ds_read_b128 v[68:71], v106 offset:1536
  ds_read_b128 v[72:75], v106 offset:2048
  s_waitcnt lgkmcnt(4)
  v_mfma_f32_32x32x16_bf16 v[40:55], a[96:99], v[56:59], 0
  ds_read_b128 v[76:79], v106 offset:2560
  buffer_load_dwordx4 a[32:35], v1, s[40:43], 0 offen offset:3072
  buffer_load_dwordx4 a[36:39], v2, s[40:43], 0 offen offset:0
  v_mul_f32 v8, v8, v110
  v_mul_f32 v9, v9, v110
  v_mul_f32 v10, v10, v110
  v_mul_f32 v11, v11, v110
  v_exp_f32 v128, v8
  s_waitcnt lgkmcnt(4)
  v_mfma_f32_32x32x16_bf16 v[40:55], a[100:103], v[60:63], v[40:55]
  ds_read_b128 v[56:59], v106 offset:3072
  s_waitcnt lgkmcnt(3)
  v_exp_f32 v129, v9
  v_exp_f32 v130, v10
  v_mfma_f32_32x32x16_bf16 v[40:55], a[104:107], v[64:67], v[40:55]
  ds_read_b128 v[60:63], v106 offset:3584
  v_exp_f32 v131, v11
  v_fma_f32 v144, v128, 0.5, 1.0
  v_fma_f32 v145, v129, 0.5, 1.0
  v_fma_f32 v146, v130, 0.5, 1.0
  v_fma_f32 v147, v131, 0.5, 1.0
  v_mfma_f32_32x32x16_bf16 v[40:55], a[108:111], v[68:71], v[40:55]
  ds_read_b128 v[64:67], v106 offset:4096
  s_waitcnt lgkmcnt(3)
  v_fma_f32 v128, v128, v144, 1.0
  v_fma_f32 v129, v129, v145, 1.0
  v_fma_f32 v130, v130, v146, 1.0
  v_fma_f32 v131, v131, v147, 1.0
  v_rcp_f32 v128, v128
  v_mfma_f32_32x32x16_bf16 v[40:55], a[112:115], v[72:75], v[40:55]
  ds_read_b128 v[68:71], v106 offset:4608
  v_rcp_f32 v129, v129
  v_rcp_f32 v130, v130
  v_mfma_f32_32x32x16_bf16 v[40:55], a[116:119], v[76:79], v[40:55]
  ds_read_b128 v[72:75], v106 offset:5120
  s_waitcnt lgkmcnt(3)
  v_rcp_f32 v131, v131
  v_fma_f32 v8, -v8, v128, v8
  v_fma_f32 v9, -v9, v129, v9
  v_fma_f32 v10, -v10, v130, v10
  v_fma_f32 v11, -v11, v131, v11
  v_mfma_f32_32x32x16_bf16 v[40:55], a[120:123], v[56:59], v[40:55]
  ds_read_b128 v[76:79], v106 offset:5632
  s_add_u32 s40, s88, 66560
  s_addc_u32 s41, s89, 0
  s_sub_i32 s42, s90, 66560
  s_max_i32 s42, s42, 0
  buffer_load_dwordx4 a[40:43], v1, s[40:43], 0 offen offset:0
  buffer_load_dwordx4 a[44:47], v1, s[40:43], 0 offen offset:1024
  v_cvt_pk_bf16_f32 v136, v8, v9
  v_cvt_pk_bf16_f32 v137, v10, v11
  v_mul_f32 v12, v12, v110
  v_mul_f32 v13, v13, v110
  v_mul_f32 v14, v14, v110
  v_mfma_f32_32x32x16_bf16 v[40:55], a[124:127], v[60:63], v[40:55]
  ds_read_b128 v[56:59], v106 offset:6144
  s_waitcnt lgkmcnt(3)
  v_mul_f32 v15, v15, v110
  v_exp_f32 v132, v12
  v_exp_f32 v133, v13
  v_mfma_f32_32x32x16_bf16 v[40:55], a[128:131], v[64:67], v[40:55]
  ds_read_b128 v[60:63], v106 offset:6656
  v_exp_f32 v134, v14
  v_exp_f32 v135, v15
  v_fma_f32 v144, v132, 0.5, 1.0
  v_fma_f32 v145, v133, 0.5, 1.0
  v_mfma_f32_32x32x16_bf16 v[40:55], a[132:135], v[68:71], v[40:55]
  ds_read_b128 v[64:67], v106 offset:7168
  s_waitcnt lgkmcnt(3)
  v_fma_f32 v146, v134, 0.5, 1.0
  v_fma_f32 v147, v135, 0.5, 1.0
  v_fma_f32 v132, v132, v144, 1.0
  v_fma_f32 v133, v133, v145, 1.0
  v_fma_f32 v134, v134, v146, 1.0
  v_mfma_f32_32x32x16_bf16 v[40:55], a[136:139], v[72:75], v[40:55]
  ds_read_b128 v[68:71], v106 offset:7680
  v_fma_f32 v135, v135, v147, 1.0
  v_rcp_f32 v132, v132
  v_rcp_f32 v133, v133
  v_mfma_f32_32x32x16_bf16 v[40:55], a[140:143], v[76:79], v[40:55]
  ds_read_b128 v[72:75], v106 offset:8192
  s_waitcnt lgkmcnt(3)
  v_rcp_f32 v134, v134
  v_rcp_f32 v135, v135
  v_fma_f32 v12, -v12, v132, v12
  v_fma_f32 v13, -v13, v133, v13
  v_mfma_f32_32x32x16_bf16 v[40:55], a[144:147], v[56:59], v[40:55]
  ds_read_b128 v[76:79], v106 offset:8704
  buffer_load_dwordx4 a[48:51], v1, s[40:43], 0 offen offset:2048
  buffer_load_dwordx4 a[52:55], v1, s[40:43], 0 offen offset:3072
  v_fma_f32 v14, -v14, v134, v14
  v_fma_f32 v15, -v15, v135, v15
  v_cvt_pk_bf16_f32 v138, v12, v13
  v_cvt_pk_bf16_f32 v139, v14, v15
  v_mfma_f32_32x32x16_bf16 v[40:55], a[148:151], v[60:63], v[40:55]
  ds_read_b128 v[56:59], v106 offset:9216
  s_waitcnt lgkmcnt(3)
  buffer_store_dwordx4 v[136:139], v148, s[52:55], 0 offen offset:0
  v_mul_f32 v16, v16, v110
  v_mul_f32 v17, v17, v110
  v_mul_f32 v18, v18, v110
  v_mul_f32 v19, v19, v110
  v_exp_f32 v128, v16
  v_mfma_f32_32x32x16_bf16 v[40:55], a[152:155], v[64:67], v[40:55]
  ds_read_b128 v[60:63], v106 offset:9728
  v_exp_f32 v129, v17
  v_exp_f32 v130, v18
  v_mfma_f32_32x32x16_bf16 v[40:55], a[156:159], v[68:71], v[40:55]
  ds_read_b128 v[64:67], v106 offset:10240
  s_waitcnt lgkmcnt(3)
  v_exp_f32 v131, v19
  v_fma_f32 v144, v128, 0.5, 1.0
  v_fma_f32 v145, v129, 0.5, 1.0
  v_fma_f32 v146, v130, 0.5, 1.0
  v_fma_f32 v147, v131, 0.5, 1.0
  v_mfma_f32_32x32x16_bf16 v[40:55], a[160:163], v[72:75], v[40:55]
  ds_read_b128 v[68:71], v106 offset:10752
  v_fma_f32 v128, v128, v144, 1.0
  v_fma_f32 v129, v129, v145, 1.0
  v_fma_f32 v130, v130, v146, 1.0
  v_fma_f32 v131, v131, v147, 1.0
  v_rcp_f32 v128, v128
  v_mfma_f32_32x32x16_bf16 v[40:55], a[164:167], v[76:79], v[40:55]
  ds_read_b128 v[72:75], v106 offset:11264
  s_waitcnt lgkmcnt(3)
  v_rcp_f32 v129, v129
  v_rcp_f32 v130, v130
  v_mfma_f32_32x32x16_bf16 v[40:55], a[168:171], v[56:59], v[40:55]
  ds_read_b128 v[76:79], v106 offset:11776
  buffer_load_dwordx4 a[56:59], v2, s[40:43], 0 offen offset:0
  s_add_u32 s40, s88, 5120
  s_addc_u32 s41, s89, 0
  s_sub_i32 s42, s90, 5120
  s_max_i32 s42, s42, 0
  buffer_load_dwordx4 a[60:63], v1, s[40:43], 0 offen offset:0
  v_rcp_f32 v131, v131
  v_fma_f32 v16, -v16, v128, v16
  v_fma_f32 v17, -v17, v129, v17
  v_fma_f32 v18, -v18, v130, v18
  v_fma_f32 v19, -v19, v131, v19
  v_mfma_f32_32x32x16_bf16 v[40:55], a[172:175], v[60:63], v[40:55]
  ds_read_b128 v[56:59], v106 offset:12288
  s_waitcnt lgkmcnt(3)
  v_cvt_pk_bf16_f32 v140, v16, v17
  v_cvt_pk_bf16_f32 v141, v18, v19
  v_mul_f32 v20, v20, v110
  v_mul_f32 v21, v21, v110
  v_mul_f32 v22, v22, v110
  v_mfma_f32_32x32x16_bf16 v[40:55], a[176:179], v[64:67], v[40:55]
  ds_read_b128 v[60:63], v106 offset:12800
  v_mul_f32 v23, v23, v110
  v_exp_f32 v132, v20
  v_exp_f32 v133, v21
  v_mfma_f32_32x32x16_bf16 v[40:55], a[180:183], v[68:71], v[40:55]
  ds_read_b128 v[64:67], v106 offset:13312
  s_waitcnt lgkmcnt(3)
  v_exp_f32 v134, v22
  v_exp_f32 v135, v23
  v_fma_f32 v144, v132, 0.5, 1.0
  v_fma_f32 v145, v133, 0.5, 1.0
  v_mfma_f32_32x32x16_bf16 v[40:55], a[184:187], v[72:75], v[40:55]
  ds_read_b128 v[68:71], v106 offset:13824
  v_fma_f32 v146, v134, 0.5, 1.0
  v_fma_f32 v147, v135, 0.5, 1.0
  v_fma_f32 v132, v132, v144, 1.0
  v_fma_f32 v133, v133, v145, 1.0
  v_fma_f32 v134, v134, v146, 1.0
  v_mfma_f32_32x32x16_bf16 v[40:55], a[188:191], v[76:79], v[40:55]
  ds_read_b128 v[72:75], v106 offset:14336
  s_waitcnt lgkmcnt(3)
  v_fma_f32 v135, v135, v147, 1.0
  v_rcp_f32 v132, v132
  v_rcp_f32 v133, v133
  v_mfma_f32_32x32x16_bf16 v[40:55], a[192:195], v[56:59], v[40:55]
  ds_read_b128 v[76:79], v106 offset:14848
  buffer_load_dwordx4 a[64:67], v1, s[40:43], 0 offen offset:1024
  buffer_load_dwordx4 a[68:71], v1, s[40:43], 0 offen offset:2048
  v_rcp_f32 v134, v134
  v_rcp_f32 v135, v135
  v_fma_f32 v20, -v20, v132, v20
  v_fma_f32 v21, -v21, v133, v21
  v_mfma_f32_32x32x16_bf16 v[40:55], a[196:199], v[60:63], v[40:55]
  ds_read_b128 v[56:59], v106 offset:15360
  s_waitcnt lgkmcnt(3)
  v_fma_f32 v22, -v22, v134, v22
  v_fma_f32 v23, -v23, v135, v23
  v_cvt_pk_bf16_f32 v142, v20, v21
  v_cvt_pk_bf16_f32 v143, v22, v23
  v_mfma_f32_32x32x16_bf16 v[40:55], a[200:203], v[64:67], v[40:55]
  ds_read_b128 v[60:63], v106 offset:15872
  buffer_store_dwordx4 v[140:143], v148, s[52:55], 0 offen offset:512
  v_mul_f32 v24, v24, v111
  v_mul_f32 v25, v25, v111
  v_mul_f32 v26, v26, v111
  v_mul_f32 v27, v27, v111
  v_exp_f32 v128, v24
  v_mfma_f32_32x32x16_bf16 v[40:55], a[204:207], v[68:71], v[40:55]
  ds_read_b128 v[64:67], v106 offset:16384
  s_waitcnt lgkmcnt(3)
  v_exp_f32 v129, v25
  v_exp_f32 v130, v26
  v_mfma_f32_32x32x16_bf16 v[40:55], a[208:211], v[72:75], v[40:55]
  ds_read_b128 v[68:71], v106 offset:16896
  v_exp_f32 v131, v27
  v_fma_f32 v144, v128, 0.5, 1.0
  v_fma_f32 v145, v129, 0.5, 1.0
  v_fma_f32 v146, v130, 0.5, 1.0
  v_fma_f32 v147, v131, 0.5, 1.0
  v_mfma_f32_32x32x16_bf16 v[40:55], a[212:215], v[76:79], v[40:55]
  ds_read_b128 v[72:75], v106 offset:17408
  s_waitcnt lgkmcnt(3)
  v_fma_f32 v128, v128, v144, 1.0
  v_fma_f32 v129, v129, v145, 1.0
  v_fma_f32 v130, v130, v146, 1.0
  v_fma_f32 v131, v131, v147, 1.0
  v_rcp_f32 v128, v128
  v_mfma_f32_32x32x16_bf16 v[40:55], a[216:219], v[56:59], v[40:55]
  ds_read_b128 v[76:79], v106 offset:17920
  buffer_load_dwordx4 a[72:75], v1, s[40:43], 0 offen offset:3072
  buffer_load_dwordx4 a[76:79], v2, s[40:43], 0 offen offset:0
  v_rcp_f32 v129, v129
  v_rcp_f32 v130, v130
  v_mfma_f32_32x32x16_bf16 v[40:55], a[220:223], v[60:63], v[40:55]
  ds_read_b128 v[56:59], v106 offset:18432
  s_waitcnt lgkmcnt(3)
  v_rcp_f32 v131, v131
  v_fma_f32 v24, -v24, v128, v24
  v_fma_f32 v25, -v25, v129, v25
  v_fma_f32 v26, -v26, v130, v26
  v_fma_f32 v27, -v27, v131, v27
  v_mfma_f32_32x32x16_bf16 v[40:55], a[224:227], v[64:67], v[40:55]
  ds_read_b128 v[60:63], v106 offset:18944
  v_cvt_pk_bf16_f32 v136, v24, v25
  v_cvt_pk_bf16_f32 v137, v26, v27
  v_mul_f32 v28, v28, v111
  v_mul_f32 v29, v29, v111
  v_mul_f32 v30, v30, v111
  v_mfma_f32_32x32x16_bf16 v[40:55], a[228:231], v[68:71], v[40:55]
  ds_read_b128 v[64:67], v106 offset:19456
  s_waitcnt lgkmcnt(3)
  v_mul_f32 v31, v31, v111
  v_exp_f32 v132, v28
  v_exp_f32 v133, v29
  v_mfma_f32_32x32x16_bf16 v[40:55], a[232:235], v[72:75], v[40:55]
  ds_read_b128 v[68:71], v106 offset:19968
  v_exp_f32 v134, v30
  v_exp_f32 v135, v31
  v_fma_f32 v144, v132, 0.5, 1.0
  v_fma_f32 v145, v133, 0.5, 1.0
  v_mfma_f32_32x32x16_bf16 v[40:55], a[236:239], v[76:79], v[40:55]
  ds_read_b128 v[72:75], v106 offset:40960
  s_waitcnt lgkmcnt(3)
  v_fma_f32 v146, v134, 0.5, 1.0
  v_fma_f32 v147, v135, 0.5, 1.0
  v_fma_f32 v132, v132, v144, 1.0
  v_fma_f32 v133, v133, v145, 1.0
  v_fma_f32 v134, v134, v146, 1.0
  v_mfma_f32_32x32x16_bf16 v[40:55], a[240:243], v[56:59], v[40:55]
  ds_read_b128 v[76:79], v106 offset:41472
  s_add_u32 s40, s88, 15360
  s_addc_u32 s41, s89, 0
  s_sub_i32 s42, s90, 15360
  s_max_i32 s42, s42, 0
  buffer_load_dwordx4 a[80:83], v1, s[40:43], 0 offen offset:0
  buffer_load_dwordx4 a[84:87], v1, s[40:43], 0 offen offset:1024
  v_fma_f32 v135, v135, v147, 1.0
  v_rcp_f32 v132, v132
  v_rcp_f32 v133, v133
  v_mfma_f32_32x32x16_bf16 v[40:55], a[244:247], v[60:63], v[40:55]
  ds_read_b128 v[56:59], v106 offset:41984
  s_waitcnt lgkmcnt(3)
  v_rcp_f32 v134, v134
  v_rcp_f32 v135, v135
  v_fma_f32 v28, -v28, v132, v28
  v_fma_f32 v29, -v29, v133, v29
  v_mfma_f32_32x32x16_bf16 v[40:55], a[248:251], v[64:67], v[40:55]
  ds_read_b128 v[60:63], v106 offset:42496
  v_fma_f32 v30, -v30, v134, v30
  v_fma_f32 v31, -v31, v135, v31
  v_cvt_pk_bf16_f32 v138, v28, v29
  v_cvt_pk_bf16_f32 v139, v30, v31
  v_mfma_f32_32x32x16_bf16 v[40:55], a[252:255], v[68:71], v[40:55]
  ds_read_b128 v[64:67], v106 offset:43008
  s_waitcnt lgkmcnt(3)
  buffer_store_dwordx4 v[136:139], v148, s[52:55], 0 offen offset:2048
  v_mul_f32 v32, v32, v111
  v_mul_f32 v33, v33, v111
  v_mul_f32 v34, v34, v111
  v_mul_f32 v35, v35, v111
  v_exp_f32 v128, v32
  s_waitcnt vmcnt(42)
  v_mfma_f32_32x32x16_bf16 v[40:55], v[168:171], v[80:83], v[40:55]
  v_exp_f32 v129, v33
  v_exp_f32 v130, v34
  v_mfma_f32_32x32x16_bf16 v[112:127], a[96:99], v[72:75], 0
  ds_read_b128 v[68:71], v106 offset:43520
  v_add_u32 v7, s75, v1
  v_exp_f32 v131, v35
  v_fma_f32 v144, v128, 0.5, 1.0
  v_fma_f32 v145, v129, 0.5, 1.0
  v_fma_f32 v146, v130, 0.5, 1.0
  v_fma_f32 v147, v131, 0.5, 1.0
  v_mfma_f32_32x32x16_bf16 v[112:127], a[100:103], v[76:79], v[112:127]
  ds_read_b128 v[72:75], v106 offset:44032
  s_waitcnt lgkmcnt(3)
  v_fma_f32 v128, v128, v144, 1.0
  v_fma_f32 v129, v129, v145, 1.0
  v_fma_f32 v130, v130, v146, 1.0
  v_fma_f32 v131, v131, v147, 1.0
  v_rcp_f32 v128, v128
  v_mfma_f32_32x32x16_bf16 v[112:127], a[104:107], v[56:59], v[112:127]
  ds_read_b128 v[76:79], v106 offset:44544
  buffer_load_dwordx4 a[88:91], v1, s[40:43], 0 offen offset:2048
  buffer_load_dwordx4 a[92:95], v1, s[40:43], 0 offen offset:3072
  v_rcp_f32 v129, v129
  v_rcp_f32 v130, v130
  v_mfma_f32_32x32x16_bf16 v[112:127], a[108:111], v[60:63], v[112:127]
  ds_read_b128 v[56:59], v106 offset:45056
  s_waitcnt lgkmcnt(3)
  v_rcp_f32 v131, v131
  v_fma_f32 v32, -v32, v128, v32
  v_fma_f32 v33, -v33, v129, v33
  v_fma_f32 v34, -v34, v130, v34
  v_fma_f32 v35, -v35, v131, v35
  v_mfma_f32_32x32x16_bf16 v[112:127], a[112:115], v[64:67], v[112:127]
  ds_read_b128 v[60:63], v106 offset:45568
  v_cvt_pk_bf16_f32 v140, v32, v33
  v_cvt_pk_bf16_f32 v141, v34, v35
  v_mul_f32 v36, v36, v111
  v_mul_f32 v37, v37, v111
  v_mul_f32 v38, v38, v111
  v_mfma_f32_32x32x16_bf16 v[112:127], a[116:119], v[68:71], v[112:127]
  ds_read_b128 v[64:67], v106 offset:46080
  s_waitcnt lgkmcnt(3)
  v_mul_f32 v39, v39, v111
  v_exp_f32 v132, v36
  v_exp_f32 v133, v37
  v_mfma_f32_32x32x16_bf16 v[112:127], a[120:123], v[72:75], v[112:127]
  ds_read_b128 v[68:71], v106 offset:46592
  v_exp_f32 v134, v38
  v_exp_f32 v135, v39
  v_fma_f32 v144, v132, 0.5, 1.0
  v_fma_f32 v145, v133, 0.5, 1.0
  v_mfma_f32_32x32x16_bf16 v[112:127], a[124:127], v[76:79], v[112:127]
  ds_read_b128 v[72:75], v106 offset:47104
  s_waitcnt lgkmcnt(3)
  v_fma_f32 v146, v134, 0.5, 1.0
  v_fma_f32 v147, v135, 0.5, 1.0
  v_fma_f32 v132, v132, v144, 1.0
  v_fma_f32 v133, v133, v145, 1.0
  v_fma_f32 v134, v134, v146, 1.0
  v_mfma_f32_32x32x16_bf16 v[112:127], a[128:131], v[56:59], v[112:127]
  ds_read_b128 v[76:79], v106 offset:47616
  buffer_load_dwordx4 v[240:243], v2, s[40:43], 0 offen offset:0
  s_add_u32 s40, s88, 25600
  s_addc_u32 s41, s89, 0
  s_sub_i32 s42, s90, 25600
  s_max_i32 s42, s42, 0
  buffer_load_dwordx4 v[244:247], v1, s[40:43], 0 offen offset:0
  v_fma_f32 v135, v135, v147, 1.0
  v_rcp_f32 v132, v132
  v_rcp_f32 v133, v133
  v_mfma_f32_32x32x16_bf16 v[112:127], a[132:135], v[60:63], v[112:127]
  ds_read_b128 v[56:59], v106 offset:48128
  s_waitcnt lgkmcnt(3)
  v_rcp_f32 v134, v134
  v_rcp_f32 v135, v135
  v_fma_f32 v36, -v36, v132, v36
  v_fma_f32 v37, -v37, v133, v37
  v_mfma_f32_32x32x16_bf16 v[112:127], a[136:139], v[64:67], v[112:127]
  ds_read_b128 v[60:63], v106 offset:48640
  v_fma_f32 v38, -v38, v134, v38
  v_fma_f32 v39, -v39, v135, v39
  v_cvt_pk_bf16_f32 v142, v36, v37
  v_cvt_pk_bf16_f32 v143, v38, v39
  buffer_store_dwordx4 v[140:143], v148, s[52:55], 0 offen offset:2560
  v_mfma_f32_32x32x16_bf16 v[112:127], a[140:143], v[68:71], v[112:127]
  ds_read_b128 v[64:67], v106 offset:49152
  s_waitcnt lgkmcnt(3)
  v_mul_f32 v40, v40, v110
  v_mul_f32 v41, v41, v110
  v_mul_f32 v42, v42, v110
  v_mul_f32 v43, v43, v110
  v_mfma_f32_32x32x16_bf16 v[112:127], a[144:147], v[72:75], v[112:127]
  ds_read_b128 v[68:71], v106 offset:49664
  v_exp_f32 v128, v40
  v_exp_f32 v129, v41
  v_exp_f32 v130, v42
  v_mfma_f32_32x32x16_bf16 v[112:127], a[148:151], v[76:79], v[112:127]
  ds_read_b128 v[72:75], v106 offset:50176
  s_waitcnt lgkmcnt(3)
  v_exp_f32 v131, v43
  v_fma_f32 v144, v128, 0.5, 1.0
  v_fma_f32 v145, v129, 0.5, 1.0
  v_mfma_f32_32x32x16_bf16 v[112:127], a[152:155], v[56:59], v[112:127]
  ds_read_b128 v[76:79], v106 offset:50688
  buffer_load_dwordx4 v[248:251], v1, s[40:43], 0 offen offset:1024
  buffer_load_dwordx4 v[252:255], v1, s[40:43], 0 offen offset:2048
  v_fma_f32 v146, v130, 0.5, 1.0
  v_fma_f32 v147, v131, 0.5, 1.0
  v_fma_f32 v128, v128, v144, 1.0
  v_fma_f32 v129, v129, v145, 1.0
  v_mfma_f32_32x32x16_bf16 v[112:127], a[156:159], v[60:63], v[112:127]
  ds_read_b128 v[56:59], v106 offset:51200
  s_waitcnt lgkmcnt(3)
  v_fma_f32 v130, v130, v146, 1.0
  v_fma_f32 v131, v131, v147, 1.0
  v_rcp_f32 v128, v128
  v_rcp_f32 v129, v129
  v_mfma_f32_32x32x16_bf16 v[112:127], a[160:163], v[64:67], v[112:127]
  ds_read_b128 v[60:63], v106 offset:51712
  v_rcp_f32 v130, v130
  v_rcp_f32 v131, v131
  v_mfma_f32_32x32x16_bf16 v[112:127], a[164:167], v[68:71], v[112:127]
  ds_read_b128 v[64:67], v106 offset:52224
  s_waitcnt lgkmcnt(3)
  v_fma_f32 v40, -v40, v128, v40
  v_fma_f32 v41, -v41, v129, v41
  v_fma_f32 v42, -v42, v130, v42
  v_fma_f32 v43, -v43, v131, v43
  v_mfma_f32_32x32x16_bf16 v[112:127], a[168:171], v[72:75], v[112:127]
  ds_read_b128 v[68:71], v106 offset:52736
  v_cvt_pk_bf16_f32 v136, v40, v41
  v_cvt_pk_bf16_f32 v137, v42, v43
  v_mul_f32 v44, v44, v110
  v_mul_f32 v45, v45, v110
  v_mul_f32 v46, v46, v110
  v_mfma_f32_32x32x16_bf16 v[112:127], a[172:175], v[76:79], v[112:127]
  ds_read_b128 v[72:75], v106 offset:53248
  s_waitcnt lgkmcnt(3)
  ds_read_b128 a[164:167], v7 offset:0
  v_mul_f32 v47, v47, v110
  v_exp_f32 v132, v44
  v_exp_f32 v133, v45
  v_mfma_f32_32x32x16_bf16 v[112:127], a[176:179], v[56:59], v[112:127]
  ds_read_b128 v[76:79], v106 offset:53760
  buffer_load_dwordx4 a[96:99], v1, s[40:43], 0 offen offset:3072
  buffer_load_dwordx4 a[100:103], v2, s[40:43], 0 offen offset:0
  ds_read_b128 a[168:171], v7 offset:1024
  v_exp_f32 v134, v46
  v_exp_f32 v135, v47
  v_mfma_f32_32x32x16_bf16 v[112:127], a[180:183], v[60:63], v[112:127]
  ds_read_b128 v[56:59], v106 offset:54272
  s_waitcnt lgkmcnt(5)
  s_waitcnt vmcnt(4)
  v_mov_b32 v6, s0
  s_cmp_lg_u32 s73, 0
  s_cbranch_scc0 Lsigs2
  buffer_store_dword v6, v3, s[44:47], s79 offen offset:256
Lsigd2:
  ds_read_b128 a[172:175], v7 offset:2048
  v_fma_f32 v144, v132, 0.5, 1.0
  v_fma_f32 v145, v133, 0.5, 1.0
  v_fma_f32 v146, v134, 0.5, 1.0
  v_fma_f32 v147, v135, 0.5, 1.0
  v_fma_f32 v132, v132, v144, 1.0
  v_mfma_f32_32x32x16_bf16 v[112:127], a[184:187], v[64:67], v[112:127]
  ds_read_b128 v[60:63], v106 offset:54784
  ds_read_b128 a[176:179], v7 offset:3072
  v_fma_f32 v133, v133, v145, 1.0
  v_fma_f32 v134, v134, v146, 1.0
  v_fma_f32 v135, v135, v147, 1.0
  v_rcp_f32 v132, v132
  v_mfma_f32_32x32x16_bf16 v[112:127], a[188:191], v[68:71], v[112:127]
  ds_read_b128 v[64:67], v106 offset:55296
  s_waitcnt lgkmcnt(6)
  ds_read_b128 a[180:183], v7 offset:4096
  v_rcp_f32 v133, v133
  v_rcp_f32 v134, v134
  v_mfma_f32_32x32x16_bf16 v[112:127], a[192:195], v[72:75], v[112:127]
  ds_read_b128 v[68:71], v106 offset:55808
  ds_read_b128 a[184:187], v7 offset:5120
  v_rcp_f32 v135, v135
  v_fma_f32 v44, -v44, v132, v44
  v_fma_f32 v45, -v45, v133, v45
  v_mfma_f32_32x32x16_bf16 v[112:127], a[196:199], v[76:79], v[112:127]
  ds_read_b128 v[72:75], v106 offset:56320
  s_waitcnt lgkmcnt(6)
  ds_read_b128 a[188:191], v7 offset:6144
  v_fma_f32 v46, -v46, v134, v46
  v_fma_f32 v47, -v47, v135, v47
  v_cvt_pk_bf16_f32 v138, v44, v45
  v_cvt_pk_bf16_f32 v139, v46, v47
  v_mfma_f32_32x32x16_bf16 v[112:127], a[200:203], v[56:59], v[112:127]
  ds_read_b128 v[76:79], v106 offset:56832
  s_add_u32 s40, s88, 40960
  s_addc_u32 s41, s89, 0
  s_sub_i32 s42, s90, 40960
  s_max_i32 s42, s42, 0
  buffer_load_dwordx4 a[104:107], v1, s[40:43], 0 offen offset:0
  buffer_load_dwordx4 a[108:111], v1, s[40:43], 0 offen offset:1024
  ds_read_b128 a[192:195], v7 offset:7168
  buffer_store_dwordx4 v[136:139], v148, s[56:59], 0 offen offset:0
  v_mul_f32 v48, v48, v110
  v_mul_f32 v49, v49, v110
  v_mul_f32 v50, v50, v110
  v_mul_f32 v51, v51, v110
  v_mfma_f32_32x32x16_bf16 v[112:127], a[204:207], v[60:63], v[112:127]
  ds_read_b128 v[56:59], v106 offset:57344
  s_waitcnt lgkmcnt(6)
  v_exp_f32 v128, v48
  v_exp_f32 v129, v49
  v_exp_f32 v130, v50
  v_mfma_f32_32x32x16_bf16 v[112:127], a[208:211], v[64:67], v[112:127]
  ds_read_b128 v[60:63], v106 offset:57856
  v_exp_f32 v131, v51
  v_fma_f32 v144, v128, 0.5, 1.0
  v_fma_f32 v145, v129, 0.5, 1.0
  v_mfma_f32_32x32x16_bf16 v[112:127], a[212:215], v[68:71], v[112:127]
  ds_read_b128 v[64:67], v106 offset:58368
  s_waitcnt lgkmcnt(4)
  buffer_load_dword v108, v4, s[44:47], s79 offen offset:256 sc1
  v_fma_f32 v146, v130, 0.5, 1.0
  v_fma_f32 v147, v131, 0.5, 1.0
  v_fma_f32 v128, v128, v144, 1.0
  v_fma_f32 v129, v129, v145, 1.0
  v_mfma_f32_32x32x16_bf16 v[112:127], a[216:219], v[72:75], v[112:127]
  ds_read_b128 v[68:71], v106 offset:58880
  v_fma_f32 v130, v130, v146, 1.0
  v_fma_f32 v131, v131, v147, 1.0
  v_rcp_f32 v128, v128
  v_rcp_f32 v129, v129
  v_mfma_f32_32x32x16_bf16 v[112:127], a[220:223], v[76:79], v[112:127]
  ds_read_b128 v[72:75], v106 offset:59392
  s_waitcnt lgkmcnt(3)
  v_rcp_f32 v130, v130
  v_rcp_f32 v131, v131
  v_mfma_f32_32x32x16_bf16 v[112:127], a[224:227], v[56:59], v[112:127]
  ds_read_b128 v[76:79], v106 offset:59904
  buffer_load_dwordx4 a[112:115], v1, s[40:43], 0 offen offset:2048
  buffer_load_dwordx4 a[116:119], v1, s[40:43], 0 offen offset:3072
  v_fma_f32 v48, -v48, v128, v48
  v_fma_f32 v49, -v49, v129, v49
  v_fma_f32 v50, -v50, v130, v50
  v_fma_f32 v51, -v51, v131, v51
  v_mfma_f32_32x32x16_bf16 v[112:127], a[228:231], v[60:63], v[112:127]
  ds_read_b128 v[56:59], v106 offset:60416
  s_waitcnt lgkmcnt(3)
  v_cvt_pk_bf16_f32 v140, v48, v49
  v_cvt_pk_bf16_f32 v141, v50, v51
  v_mul_f32 v52, v52, v110
  v_mul_f32 v53, v53, v110
  v_mul_f32 v54, v54, v110
  v_mfma_f32_32x32x16_bf16 v[112:127], a[232:235], v[64:67], v[112:127]
  ds_read_b128 v[60:63], v106 offset:60928
  v_mul_f32 v55, v55, v110
  v_exp_f32 v132, v52
  v_exp_f32 v133, v53
  v_mfma_f32_32x32x16_bf16 v[112:127], a[236:239], v[68:71], v[112:127]
  s_waitcnt lgkmcnt(2)
  v_exp_f32 v134, v54
  v_exp_f32 v135, v55
  v_mfma_f32_32x32x16_bf16 v[112:127], a[240:243], v[72:75], v[112:127]
  v_fma_f32 v144, v132, 0.5, 1.0
  v_fma_f32 v145, v133, 0.5, 1.0
  v_fma_f32 v146, v134, 0.5, 1.0
  v_fma_f32 v147, v135, 0.5, 1.0
  v_fma_f32 v132, v132, v144, 1.0
  v_mfma_f32_32x32x16_bf16 v[112:127], a[244:247], v[76:79], v[112:127]
  s_waitcnt lgkmcnt(0)
  v_fma_f32 v133, v133, v145, 1.0
  v_fma_f32 v134, v134, v146, 1.0
  v_fma_f32 v135, v135, v147, 1.0
  v_rcp_f32 v132, v132
  v_mfma_f32_32x32x16_bf16 v[112:127], a[248:251], v[56:59], v[112:127]
  buffer_load_dwordx4 a[120:123], v2, s[40:43], 0 offen offset:0
  s_add_u32 s40, s88, 51200
  s_addc_u32 s41, s89, 0
  s_sub_i32 s42, s90, 51200
  s_max_i32 s42, s42, 0
  buffer_load_dwordx4 a[124:127], v1, s[40:43], 0 offen offset:0
  v_rcp_f32 v133, v133
  v_rcp_f32 v134, v134
  v_mfma_f32_32x32x16_bf16 v[112:127], a[252:255], v[60:63], v[112:127]
  v_rcp_f32 v135, v135
  v_fma_f32 v52, -v52, v132, v52
  v_fma_f32 v53, -v53, v133, v53
  v_mfma_f32_32x32x16_bf16 v[112:127], v[168:171], v[84:87], v[112:127]
  v_fma_f32 v54, -v54, v134, v54
  v_fma_f32 v55, -v55, v135, v55
  v_cvt_pk_bf16_f32 v142, v52, v53
  v_cvt_pk_bf16_f32 v143, v54, v55
  buffer_store_dwordx4 v[140:143], v148, s[56:59], 0 offen offset:512
  s_waitcnt vmcnt(5)
  v_cmp_eq_u32 vcc, s0, v108
  s_nop 0
  s_and_b32 s81, vcc_lo, s77
  s_cmp_eq_u32 s81, s77
  s_cselect_b32 s81, s73, 0
  s_cmp_lg_u32 s81, 0
  s_cbranch_scc0 Lchk2
Lchkd2:
  buffer_load_dwordx4 v[152:155], v88, s[32:35], 0 offen sc1
  buffer_load_dwordx4 v[156:159], v89, s[32:35], 0 offen sc1
  buffer_load_dwordx4 v[160:163], v90, s[32:35], 0 offen sc1
  buffer_load_dwordx4 v[164:167], v91, s[32:35], 0 offen sc1
  v_mul_f32 v112, v112, v111
  v_mul_f32 v113, v113, v111
  v_mul_f32 v114, v114, v111
  v_mul_f32 v115, v115, v111
  v_exp_f32 v128, v112
  v_exp_f32 v129, v113
  v_exp_f32 v130, v114
  v_exp_f32 v131, v115
  v_fma_f32 v144, v128, 0.5, 1.0
  v_fma_f32 v145, v129, 0.5, 1.0
  v_fma_f32 v146, v130, 0.5, 1.0
  v_fma_f32 v147, v131, 0.5, 1.0
  v_fma_f32 v128, v128, v144, 1.0
  v_fma_f32 v129, v129, v145, 1.0
  v_fma_f32 v130, v130, v146, 1.0
  v_fma_f32 v131, v131, v147, 1.0
  v_rcp_f32 v128, v128
  v_rcp_f32 v129, v129
  v_rcp_f32 v130, v130
  v_rcp_f32 v131, v131
  v_fma_f32 v112, -v112, v128, v112
  buffer_load_dwordx4 a[196:199], v88, s[32:35], s61 offen sc1
  buffer_load_dwordx4 a[200:203], v89, s[32:35], s61 offen sc1
  v_fma_f32 v113, -v113, v129, v113
  v_fma_f32 v114, -v114, v130, v114
  v_fma_f32 v115, -v115, v131, v115
  v_cvt_pk_bf16_f32 v136, v112, v113
  v_cvt_pk_bf16_f32 v137, v114, v115
  v_mul_f32 v116, v116, v111
  v_mul_f32 v117, v117, v111
  v_mul_f32 v118, v118, v111
  v_mul_f32 v119, v119, v111
  v_exp_f32 v132, v116
  v_exp_f32 v133, v117
  v_exp_f32 v134, v118
  v_exp_f32 v135, v119
  v_fma_f32 v144, v132, 0.5, 1.0
  v_fma_f32 v145, v133, 0.5, 1.0
  v_fma_f32 v146, v134, 0.5, 1.0
  v_fma_f32 v147, v135, 0.5, 1.0
  v_fma_f32 v132, v132, v144, 1.0
  v_fma_f32 v133, v133, v145, 1.0
  v_fma_f32 v134, v134, v146, 1.0
  v_fma_f32 v135, v135, v147, 1.0
  buffer_load_dwordx4 a[204:207], v90, s[32:35], s61 offen sc1
  buffer_load_dwordx4 a[208:211], v91, s[32:35], s61 offen sc1
  v_rcp_f32 v132, v132
  v_rcp_f32 v133, v133
  v_rcp_f32 v134, v134
  v_rcp_f32 v135, v135
  v_fma_f32 v116, -v116, v132, v116
  v_fma_f32 v117, -v117, v133, v117
  v_fma_f32 v118, -v118, v134, v118
  v_fma_f32 v119, -v119, v135, v119
  v_cvt_pk_bf16_f32 v138, v116, v117
  v_cvt_pk_bf16_f32 v139, v118, v119
  buffer_store_dwordx4 v[136:139], v148, s[56:59], 0 offen offset:2048
  v_mul_f32 v120, v120, v111
  v_mul_f32 v121, v121, v111
  v_mul_f32 v122, v122, v111
  v_mul_f32 v123, v123, v111
  v_exp_f32 v128, v120
  v_exp_f32 v129, v121
  v_exp_f32 v130, v122
  v_exp_f32 v131, v123
  v_fma_f32 v144, v128, 0.5, 1.0
  v_fma_f32 v145, v129, 0.5, 1.0
  buffer_load_dwordx4 a[212:215], v88, s[32:35], s62 offen sc1
  buffer_load_dwordx4 a[216:219], v89, s[32:35], s62 offen sc1
  v_fma_f32 v146, v130, 0.5, 1.0
  v_fma_f32 v147, v131, 0.5, 1.0
  v_fma_f32 v128, v128, v144, 1.0
  v_fma_f32 v129, v129, v145, 1.0
  v_fma_f32 v130, v130, v146, 1.0
  v_fma_f32 v131, v131, v147, 1.0
  v_rcp_f32 v128, v128
  v_rcp_f32 v129, v129
  v_rcp_f32 v130, v130
  v_rcp_f32 v131, v131
  v_fma_f32 v120, -v120, v128, v120
  v_fma_f32 v121, -v121, v129, v121
  v_fma_f32 v122, -v122, v130, v122
  v_fma_f32 v123, -v123, v131, v123
  v_cvt_pk_bf16_f32 v140, v120, v121
  v_cvt_pk_bf16_f32 v141, v122, v123
  v_mul_f32 v124, v124, v111
  v_mul_f32 v125, v125, v111
  v_mul_f32 v126, v126, v111
  v_mul_f32 v127, v127, v111
  v_exp_f32 v132, v124
  buffer_load_dwordx4 a[220:223], v90, s[32:35], s62 offen sc1
  buffer_load_dwordx4 a[224:227], v91, s[32:35], s62 offen sc1
  s_waitcnt vmcnt(12)
  v_mfma_f32_16x16x32_bf16 v[8:11], a[164:167], v[152:155], 0
  v_exp_f32 v133, v125
  s_waitcnt vmcnt(11)
  v_mfma_f32_16x16x32_bf16 v[12:15], a[164:167], v[156:159], 0
  buffer_load_dwordx4 a[228:231], v88, s[32:35], s63 offen sc1
  s_waitcnt vmcnt(11)
  v_mfma_f32_16x16x32_bf16 v[16:19], a[164:167], v[160:163], 0
  v_exp_f32 v134, v126
  s_waitcnt vmcnt(10)
  v_mfma_f32_16x16x32_bf16 v[20:23], a[164:167], v[164:167], 0
  v_exp_f32 v135, v127
  v_mfma_f32_16x16x32_bf16 v[24:27], a[168:171], v[152:155], 0
  v_fma_f32 v144, v132, 0.5, 1.0
  v_mfma_f32_16x16x32_bf16 v[28:31], a[168:171], v[156:159], 0
  v_fma_f32 v145, v133, 0.5, 1.0
  v_fma_f32 v146, v134, 0.5, 1.0
  v_mfma_f32_16x16x32_bf16 v[32:35], a[168:171], v[160:163], 0
  buffer_load_dwordx4 a[232:235], v89, s[32:35], s63 offen sc1
  v_fma_f32 v147, v135, 0.5, 1.0
  v_mfma_f32_16x16x32_bf16 v[36:39], a[168:171], v[164:167], 0
  v_fma_f32 v132, v132, v144, 1.0
  v_fma_f32 v133, v133, v145, 1.0
  v_mfma_f32_16x16x32_bf16 v[40:43], a[172:175], v[152:155], 0
  v_fma_f32 v134, v134, v146, 1.0
  v_mfma_f32_16x16x32_bf16 v[44:47], a[172:175], v[156:159], 0
  v_fma_f32 v135, v135, v147, 1.0
  v_mfma_f32_16x16x32_bf16 v[48:51], a[172:175], v[160:163], 0
  v_rcp_f32 v132, v132
  v_mfma_f32_16x16x32_bf16 v[52:55], a[172:175], v[164:167], 0
  buffer_load_dwordx4 a[236:239], v90, s[32:35], s63 offen sc1
  v_rcp_f32 v133, v133
  v_mfma_f32_16x16x32_bf16 v[56:59], a[176:179], v[152:155], 0
  v_mfma_f32_16x16x32_bf16 v[60:63], a[176:179], v[156:159], 0
  v_rcp_f32 v134, v134
  v_mfma_f32_16x16x32_bf16 v[64:67], a[176:179], v[160:163], 0
  v_rcp_f32 v135, v135
  v_mfma_f32_16x16x32_bf16 v[68:71], a[176:179], v[164:167], 0
  v_fma_f32 v124, -v124, v132, v124
  v_mfma_f32_16x16x32_bf16 v[72:75], a[180:183], v[152:155], 0
  buffer_load_dwordx4 a[240:243], v91, s[32:35], s63 offen sc1
  v_fma_f32 v125, -v125, v133, v125
  v_fma_f32 v126, -v126, v134, v126
  v_mfma_f32_16x16x32_bf16 v[76:79], a[180:183], v[156:159], 0
  v_fma_f32 v127, -v127, v135, v127
  v_mfma_f32_16x16x32_bf16 v[80:83], a[180:183], v[160:163], 0
  s_waitcnt vmcnt(9)
  v_cvt_pk_bf16_f32 v142, v124, v125
  v_cvt_pk_bf16_f32 v143, v126, v127
  v_mfma_f32_16x16x32_bf16 v[84:87], a[180:183], v[164:167], 0
  buffer_store_dwordx4 v[140:143], v148, s[56:59], 0 offen offset:2560
  v_mfma_f32_16x16x32_bf16 v[8:11], a[184:187], a[196:199], v[8:11]
  v_mfma_f32_16x16x32_bf16 v[12:15], a[184:187], a[200:203], v[12:15]
  s_mov_b32 s82, 28672
  buffer_load_dwordx4 a[244:247], v88, s[32:35], s82 offen sc1
  v_mfma_f32_16x16x32_bf16 v[16:19], a[184:187], a[204:207], v[16:19]
  v_mfma_f32_16x16x32_bf16 v[20:23], a[184:187], a[208:211], v[20:23]
  v_mfma_f32_16x16x32_bf16 v[24:27], a[188:191], a[196:199], v[24:27]
  v_mfma_f32_16x16x32_bf16 v[28:31], a[188:191], a[200:203], v[28:31]
  v_mfma_f32_16x16x32_bf16 v[32:35], a[188:191], a[204:207], v[32:35]
  s_mov_b32 s82, 28672
  buffer_load_dwordx4 a[248:251], v89, s[32:35], s82 offen sc1
  v_mfma_f32_16x16x32_bf16 v[36:39], a[188:191], a[208:211], v[36:39]
  v_mfma_f32_16x16x32_bf16 v[40:43], a[192:195], a[196:199], v[40:43]
  buffer_load_dwordx4 a[128:131], v1, s[40:43], 0 offen offset:1024
  v_mfma_f32_16x16x32_bf16 v[44:47], a[192:195], a[200:203], v[44:47]
  v_mfma_f32_16x16x32_bf16 v[48:51], a[192:195], a[204:207], v[48:51]
  v_mfma_f32_16x16x32_bf16 v[52:55], a[192:195], a[208:211], v[52:55]
  s_mov_b32 s82, 28672
  buffer_load_dwordx4 a[252:255], v90, s[32:35], s82 offen sc1
  v_mfma_f32_16x16x32_bf16 v[56:59], v[172:175], a[196:199], v[56:59]
  v_mfma_f32_16x16x32_bf16 v[60:63], v[172:175], a[200:203], v[60:63]
  v_mfma_f32_16x16x32_bf16 v[64:67], v[172:175], a[204:207], v[64:67]
  v_mfma_f32_16x16x32_bf16 v[68:71], v[172:175], a[208:211], v[68:71]
  v_mfma_f32_16x16x32_bf16 v[72:75], v[176:179], a[196:199], v[72:75]
  s_mov_b32 s82, 28672
  buffer_load_dwordx4 v[168:171], v91, s[32:35], s82 offen sc1
  v_mfma_f32_16x16x32_bf16 v[76:79], v[176:179], a[200:203], v[76:79]
  v_mfma_f32_16x16x32_bf16 v[80:83], v[176:179], a[204:207], v[80:83]
  s_waitcnt vmcnt(10)
  v_mfma_f32_16x16x32_bf16 v[84:87], v[176:179], a[208:211], v[84:87]
  v_mfma_f32_16x16x32_bf16 v[8:11], v[180:183], a[212:215], v[8:11]
  v_mfma_f32_16x16x32_bf16 v[12:15], v[180:183], a[216:219], v[12:15]
  s_mov_b32 s83, 36864
  buffer_load_dwordx4 v[152:155], v88, s[32:35], s83 offen sc1
  v_mfma_f32_16x16x32_bf16 v[16:19], v[180:183], a[220:223], v[16:19]
  v_mfma_f32_16x16x32_bf16 v[20:23], v[180:183], a[224:227], v[20:23]
  v_mfma_f32_16x16x32_bf16 v[24:27], v[184:187], a[212:215], v[24:27]
  v_mfma_f32_16x16x32_bf16 v[28:31], v[184:187], a[216:219], v[28:31]
  s_waitcnt vmcnt(6)
  v_mov_b32 v6, s0
  s_cmp_lg_u32 s73, 0
  s_cbranch_scc0 Lsigs5
  buffer_store_dword v6, v3, s[44:47], s79 offen offset:640
Lsigd5:
  v_mfma_f32_16x16x32_bf16 v[32:35], v[184:187], a[220:223], v[32:35]
  s_mov_b32 s83, 36864
  buffer_load_dwordx4 v[156:159], v89, s[32:35], s83 offen sc1
  v_mfma_f32_16x16x32_bf16 v[36:39], v[184:187], a[224:227], v[36:39]
  v_mfma_f32_16x16x32_bf16 v[40:43], v[188:191], a[212:215], v[40:43]
  buffer_load_dwordx4 a[132:135], v1, s[40:43], 0 offen offset:2048
  v_mfma_f32_16x16x32_bf16 v[44:47], v[188:191], a[216:219], v[44:47]
  v_mfma_f32_16x16x32_bf16 v[48:51], v[188:191], a[220:223], v[48:51]
  v_mfma_f32_16x16x32_bf16 v[52:55], v[188:191], a[224:227], v[52:55]
  s_mov_b32 s83, 36864
  buffer_load_dwordx4 v[160:163], v90, s[32:35], s83 offen sc1
  v_mfma_f32_16x16x32_bf16 v[56:59], v[192:195], a[212:215], v[56:59]
  v_mfma_f32_16x16x32_bf16 v[60:63], v[192:195], a[216:219], v[60:63]
  v_mfma_f32_16x16x32_bf16 v[64:67], v[192:195], a[220:223], v[64:67]
  v_mfma_f32_16x16x32_bf16 v[68:71], v[192:195], a[224:227], v[68:71]
  v_mfma_f32_16x16x32_bf16 v[72:75], v[196:199], a[212:215], v[72:75]
  s_mov_b32 s83, 36864
  buffer_load_dwordx4 v[164:167], v91, s[32:35], s83 offen sc1
  v_mfma_f32_16x16x32_bf16 v[76:79], v[196:199], a[216:219], v[76:79]
  v_mfma_f32_16x16x32_bf16 v[80:83], v[196:199], a[220:223], v[80:83]
  v_mfma_f32_16x16x32_bf16 v[84:87], v[196:199], a[224:227], v[84:87]
  v_mfma_f32_16x16x32_bf16 v[8:11], v[200:203], a[228:231], v[8:11]
  v_mfma_f32_16x16x32_bf16 v[12:15], v[200:203], a[232:235], v[12:15]
  s_mov_b32 s82, 45056
  buffer_load_dwordx4 a[196:199], v88, s[32:35], s82 offen sc1
  v_mfma_f32_16x16x32_bf16 v[16:19], v[200:203], a[236:239], v[16:19]
  v_mfma_f32_16x16x32_bf16 v[20:23], v[200:203], a[240:243], v[20:23]
  v_mfma_f32_16x16x32_bf16 v[24:27], v[204:207], a[228:231], v[24:27]
  v_mfma_f32_16x16x32_bf16 v[28:31], v[204:207], a[232:235], v[28:31]
  buffer_load_dword v108, v4, s[44:47], s79 offen offset:640 sc1
  v_mfma_f32_16x16x32_bf16 v[32:35], v[204:207], a[236:239], v[32:35]
  s_mov_b32 s82, 45056
  buffer_load_dwordx4 a[200:203], v89, s[32:35], s82 offen sc1
  v_mfma_f32_16x16x32_bf16 v[36:39], v[204:207], a[240:243], v[36:39]
  v_mfma_f32_16x16x32_bf16 v[40:43], v[208:211], a[228:231], v[40:43]
  buffer_load_dwordx4 a[136:139], v1, s[40:43], 0 offen offset:3072
  v_mfma_f32_16x16x32_bf16 v[44:47], v[208:211], a[232:235], v[44:47]
  v_mfma_f32_16x16x32_bf16 v[48:51], v[208:211], a[236:239], v[48:51]
  v_mfma_f32_16x16x32_bf16 v[52:55], v[208:211], a[240:243], v[52:55]
  s_mov_b32 s82, 45056
  buffer_load_dwordx4 a[204:207], v90, s[32:35], s82 offen sc1
  v_mfma_f32_16x16x32_bf16 v[56:59], v[212:215], a[228:231], v[56:59]
  v_mfma_f32_16x16x32_bf16 v[60:63], v[212:215], a[232:235], v[60:63]
  v_mfma_f32_16x16x32_bf16 v[64:67], v[212:215], a[236:239], v[64:67]
  v_mfma_f32_16x16x32_bf16 v[68:71], v[212:215], a[240:243], v[68:71]
  v_mfma_f32_16x16x32_bf16 v[72:75], v[216:219], a[228:231], v[72:75]
  s_mov_b32 s82, 45056
  buffer_load_dwordx4 a[208:211], v91, s[32:35], s82 offen sc1
  v_mfma_f32_16x16x32_bf16 v[76:79], v[216:219], a[232:235], v[76:79]
  v_mfma_f32_16x16x32_bf16 v[80:83], v[216:219], a[236:239], v[80:83]
  s_waitcnt vmcnt(12)
  v_mfma_f32_16x16x32_bf16 v[84:87], v[216:219], a[240:243], v[84:87]
  v_mfma_f32_16x16x32_bf16 v[8:11], v[220:223], a[244:247], v[8:11]
  v_mfma_f32_16x16x32_bf16 v[12:15], v[220:223], a[248:251], v[12:15]
  s_mov_b32 s83, 53248
  buffer_load_dwordx4 v[112:115], v88, s[32:35], s83 offen sc1
  v_mfma_f32_16x16x32_bf16 v[16:19], v[220:223], a[252:255], v[16:19]
  v_mfma_f32_16x16x32_bf16 v[20:23], v[220:223], v[168:171], v[20:23]
  s_lshl_b32 s13, s11, 2
  v_mfma_f32_16x16x32_bf16 v[24:27], v[224:227], a[244:247], v[24:27]
  v_mfma_f32_16x16x32_bf16 v[28:31], v[224:227], a[248:251], v[28:31]
  s_add_u32 s13, s13, s12
  v_mfma_f32_16x16x32_bf16 v[32:35], v[224:227], a[252:255], v[32:35]
  s_mov_b32 s83, 53248
  buffer_load_dwordx4 v[116:119], v89, s[32:35], s83 offen sc1
  v_mfma_f32_16x16x32_bf16 v[36:39], v[224:227], v[168:171], v[36:39]
  s_mul_i32 s13, s13, 41984
  v_mfma_f32_16x16x32_bf16 v[40:43], v[228:231], a[244:247], v[40:43]
  buffer_load_dwordx4 a[140:143], v2, s[40:43], 0 offen offset:0
  v_mfma_f32_16x16x32_bf16 v[44:47], v[228:231], a[248:251], v[44:47]
  s_add_u32 s48, s4, s13
  s_addc_u32 s49, s5, 0
  v_mfma_f32_16x16x32_bf16 v[48:51], v[228:231], a[252:255], v[48:51]
  v_mfma_f32_16x16x32_bf16 v[52:55], v[228:231], v[168:171], v[52:55]
  s_mov_b32 s83, 53248
  buffer_load_dwordx4 v[120:123], v90, s[32:35], s83 offen sc1
  v_mfma_f32_16x16x32_bf16 v[56:59], v[232:235], a[244:247], v[56:59]
  v_mfma_f32_16x16x32_bf16 v[60:63], v[232:235], a[248:251], v[60:63]
  s_mov_b32 s50, 41984
  v_mfma_f32_16x16x32_bf16 v[64:67], v[232:235], a[252:255], v[64:67]
  v_mfma_f32_16x16x32_bf16 v[68:71], v[232:235], v[168:171], v[68:71]
  s_mov_b32 s51, 0x20000
  v_mfma_f32_16x16x32_bf16 v[72:75], v[236:239], a[244:247], v[72:75]
  s_mov_b32 s83, 53248
  buffer_load_dwordx4 v[124:127], v91, s[32:35], s83 offen sc1
  v_mfma_f32_16x16x32_bf16 v[76:79], v[236:239], a[248:251], v[76:79]
  s_cmp_eq_u32 s3, 2
  s_cselect_b32 s50, 0, s50
  v_mfma_f32_16x16x32_bf16 v[80:83], v[236:239], a[252:255], v[80:83]
  s_waitcnt vmcnt(11)
  v_mfma_f32_16x16x32_bf16 v[84:87], v[236:239], v[168:171], v[84:87]
  s_sub_u32 s13, s12, 0
  v_mfma_f32_16x16x32_bf16 v[8:11], a[0:3], v[152:155], v[8:11]
  s_waitcnt vmcnt(9)
  v_cmp_eq_u32 vcc, s0, v108
  s_nop 0
  s_and_b32 s81, vcc_lo, s77
  s_cmp_eq_u32 s81, s77
  s_cselect_b32 s81, s73, 0
  s_cmp_lg_u32 s81, 0
  s_cbranch_scc0 Lchk3
Lchkd3:
  v_mfma_f32_16x16x32_bf16 v[12:15], a[0:3], v[156:159], v[12:15]
  s_mov_b32 s82, 4096
  buffer_load_dwordx4 v[128:131], v88, s[32:35], s82 offen sc1
  v_mfma_f32_16x16x32_bf16 v[16:19], a[0:3], v[160:163], v[16:19]
  v_mfma_f32_16x16x32_bf16 v[20:23], a[0:3], v[164:167], v[20:23]
  s_and_b32 s13, s13, 3
  v_mfma_f32_16x16x32_bf16 v[24:27], a[4:7], v[152:155], v[24:27]
  v_mfma_f32_16x16x32_bf16 v[28:31], a[4:7], v[156:159], v[28:31]
  s_mul_i32 s13, s13, 15360
  v_mfma_f32_16x16x32_bf16 v[32:35], a[4:7], v[160:163], v[32:35]
  s_mov_b32 s82, 4096
  buffer_load_dwordx4 v[132:135], v89, s[32:35], s82 offen sc1
  v_mfma_f32_16x16x32_bf16 v[36:39], a[4:7], v[164:167], v[36:39]
  s_add_u32 s13, s13, 102400
  v_mfma_f32_16x16x32_bf16 v[40:43], a[8:11], v[152:155], v[40:43]
  s_add_u32 s40, s88, 61440
  s_addc_u32 s41, s89, 0
  s_sub_i32 s42, s90, 61440
  s_max_i32 s42, s42, 0
  buffer_load_dwordx4 a[144:147], v1, s[40:43], 0 offen offset:0
  v_mfma_f32_16x16x32_bf16 v[44:47], a[8:11], v[156:159], v[44:47]
  v_add_u32 v92, s13, v1
  v_mfma_f32_16x16x32_bf16 v[48:51], a[8:11], v[160:163], v[48:51]
  v_mfma_f32_16x16x32_bf16 v[52:55], a[8:11], v[164:167], v[52:55]
  s_mov_b32 s82, 4096
  buffer_load_dwordx4 v[136:139], v90, s[32:35], s82 offen sc1
  v_mfma_f32_16x16x32_bf16 v[56:59], a[12:15], v[152:155], v[56:59]
  v_mfma_f32_16x16x32_bf16 v[60:63], a[12:15], v[156:159], v[60:63]
  s_sub_u32 s13, s12, 1
  v_mfma_f32_16x16x32_bf16 v[64:67], a[12:15], v[160:163], v[64:67]
  v_mfma_f32_16x16x32_bf16 v[68:71], a[12:15], v[164:167], v[68:71]
  s_and_b32 s13, s13, 3
  v_mfma_f32_16x16x32_bf16 v[72:75], a[16:19], v[152:155], v[72:75]
  s_mov_b32 s82, 4096
  buffer_load_dwordx4 v[140:143], v91, s[32:35], s82 offen sc1
  v_mfma_f32_16x16x32_bf16 v[76:79], a[16:19], v[156:159], v[76:79]
  s_mul_i32 s13, s13, 15360
  v_mfma_f32_16x16x32_bf16 v[80:83], a[16:19], v[160:163], v[80:83]
  s_waitcnt vmcnt(10)
  v_mfma_f32_16x16x32_bf16 v[84:87], a[16:19], v[164:167], v[84:87]
  s_add_u32 s13, s13, 102400
  v_mfma_f32_16x16x32_bf16 v[8:11], a[20:23], a[196:199], v[8:11]
  v_mfma_f32_16x16x32_bf16 v[12:15], a[20:23], a[200:203], v[12:15]
  s_mov_b32 s83, 12288
  buffer_load_dwordx4 a[212:215], v88, s[32:35], s83 offen sc1
  v_mfma_f32_16x16x32_bf16 v[16:19], a[20:23], a[204:207], v[16:19]
  v_mfma_f32_16x16x32_bf16 v[20:23], a[20:23], a[208:211], v[20:23]
  v_add_u32 v93, s13, v1
  v_mfma_f32_16x16x32_bf16 v[24:27], a[24:27], a[196:199], v[24:27]
  v_mfma_f32_16x16x32_bf16 v[28:31], a[24:27], a[200:203], v[28:31]
  s_sub_u32 s13, s12, 2
  v_mfma_f32_16x16x32_bf16 v[32:35], a[24:27], a[204:207], v[32:35]
  s_mov_b32 s83, 12288
  buffer_load_dwordx4 a[216:219], v89, s[32:35], s83 offen sc1
  v_mfma_f32_16x16x32_bf16 v[36:39], a[24:27], a[208:211], v[36:39]
  s_and_b32 s13, s13, 3
  v_mfma_f32_16x16x32_bf16 v[40:43], a[28:31], a[196:199], v[40:43]
  buffer_load_dwordx4 a[148:151], v1, s[40:43], 0 offen offset:1024
  v_mfma_f32_16x16x32_bf16 v[44:47], a[28:31], a[200:203], v[44:47]
  s_mul_i32 s13, s13, 15360
  v_mfma_f32_16x16x32_bf16 v[48:51], a[28:31], a[204:207], v[48:51]
  v_mfma_f32_16x16x32_bf16 v[52:55], a[28:31], a[208:211], v[52:55]
  s_mov_b32 s83, 12288
  buffer_load_dwordx4 a[220:223], v90, s[32:35], s83 offen sc1
  v_mfma_f32_16x16x32_bf16 v[56:59], a[32:35], a[196:199], v[56:59]
  v_mfma_f32_16x16x32_bf16 v[60:63], a[32:35], a[200:203], v[60:63]
  s_add_u32 s13, s13, 107520
  v_mfma_f32_16x16x32_bf16 v[64:67], a[32:35], a[204:207], v[64:67]
  v_mfma_f32_16x16x32_bf16 v[68:71], a[32:35], a[208:211], v[68:71]
  v_add_u32 v94, s13, v1
  v_mfma_f32_16x16x32_bf16 v[72:75], a[36:39], a[196:199], v[72:75]
  s_mov_b32 s83, 12288
  buffer_load_dwordx4 a[224:227], v91, s[32:35], s83 offen sc1
  v_mfma_f32_16x16x32_bf16 v[76:79], a[36:39], a[200:203], v[76:79]
  s_sub_u32 s13, s12, 3
  v_mfma_f32_16x16x32_bf16 v[80:83], a[36:39], a[204:207], v[80:83]
  s_waitcnt vmcnt(10)
  v_mfma_f32_16x16x32_bf16 v[84:87], a[36:39], a[208:211], v[84:87]
  s_and_b32 s13, s13, 3
  v_mfma_f32_16x16x32_bf16 v[8:11], a[40:43], v[112:115], v[8:11]
  v_mfma_f32_16x16x32_bf16 v[12:15], a[40:43], v[116:119], v[12:15]
  s_mov_b32 s82, 20480
  buffer_load_dwordx4 a[232:235], v89, s[32:35], s82 offen sc1
  v_mfma_f32_16x16x32_bf16 v[16:19], a[40:43], v[120:123], v[16:19]
  v_mfma_f32_16x16x32_bf16 v[20:23], a[40:43], v[124:127], v[20:23]
  s_mul_i32 s13, s13, 15360
  v_mfma_f32_16x16x32_bf16 v[24:27], a[44:47], v[112:115], v[24:27]
  v_mfma_f32_16x16x32_bf16 v[28:31], a[44:47], v[116:119], v[28:31]
  s_add_u32 s13, s13, 112640
  v_mfma_f32_16x16x32_bf16 v[32:35], a[44:47], v[120:123], v[32:35]
  buffer_load_dwordx4 a[248:251], v89, s[32:35], s64 offen sc1
  v_mfma_f32_16x16x32_bf16 v[36:39], a[44:47], v[124:127], v[36:39]
  v_add_u32 v95, s13, v1
  v_mfma_f32_16x16x32_bf16 v[40:43], a[48:51], v[112:115], v[40:43]
  buffer_load_dwordx4 a[152:155], v1, s[40:43], 0 offen offset:2048
  v_mfma_f32_16x16x32_bf16 v[44:47], a[48:51], v[116:119], v[44:47]
  s_mul_i32 s70, s8, 2560
  v_mfma_f32_16x16x32_bf16 v[48:51], a[48:51], v[120:123], v[48:51]
  v_mfma_f32_16x16x32_bf16 v[52:55], a[48:51], v[124:127], v[52:55]
  buffer_load_dwordx4 v[156:159], v89, s[32:35], s65 offen sc1
  v_mfma_f32_16x16x32_bf16 v[56:59], a[52:55], v[112:115], v[56:59]
  v_mfma_f32_16x16x32_bf16 v[60:63], a[52:55], v[116:119], v[60:63]
  s_lshl_b32 s71, s8, 7
  v_mfma_f32_16x16x32_bf16 v[64:67], a[52:55], v[120:123], v[64:67]
  v_mfma_f32_16x16x32_bf16 v[68:71], a[52:55], v[124:127], v[68:71]
  s_add_u32 s71, s71, 2621440
  v_mfma_f32_16x16x32_bf16 v[72:75], a[56:59], v[112:115], v[72:75]
  buffer_load_dwordx4 a[200:203], v89, s[32:35], s66 offen sc1
  v_mfma_f32_16x16x32_bf16 v[76:79], a[56:59], v[116:119], v[76:79]
  v_and_b32 v107, 15, v0
  v_mfma_f32_16x16x32_bf16 v[80:83], a[56:59], v[120:123], v[80:83]
  s_waitcnt vmcnt(10)
  v_mfma_f32_16x16x32_bf16 v[84:87], a[56:59], v[124:127], v[84:87]
  v_lshrrev_b32 v6, 5, v0
  v_mfma_f32_16x16x32_bf16 v[8:11], a[60:63], v[128:131], v[8:11]
  v_mfma_f32_16x16x32_bf16 v[12:15], a[60:63], v[132:135], v[12:15]
  s_mov_b32 s82, 20480
  buffer_load_dwordx4 a[236:239], v90, s[32:35], s82 offen sc1
  v_mfma_f32_16x16x32_bf16 v[16:19], a[60:63], v[136:139], v[16:19]
  v_mfma_f32_16x16x32_bf16 v[20:23], a[60:63], v[140:143], v[20:23]
  v_lshlrev_b32 v106, 8, v6
  v_mfma_f32_16x16x32_bf16 v[24:27], a[64:67], v[128:131], v[24:27]
  v_mfma_f32_16x16x32_bf16 v[28:31], a[64:67], v[132:135], v[28:31]
  v_lshl_add_u32 v106, v107, 4, v106
  v_mfma_f32_16x16x32_bf16 v[32:35], a[64:67], v[136:139], v[32:35]
  buffer_load_dwordx4 a[252:255], v90, s[32:35], s64 offen sc1
  v_mfma_f32_16x16x32_bf16 v[36:39], a[64:67], v[140:143], v[36:39]
  v_bfe_u32 v6, v0, 4, 1
  v_mfma_f32_16x16x32_bf16 v[40:43], a[68:71], v[128:131], v[40:43]
  buffer_load_dwordx4 a[156:159], v1, s[40:43], 0 offen offset:3072
  v_mfma_f32_16x16x32_bf16 v[44:47], a[68:71], v[132:135], v[44:47]
  v_lshl_add_u32 v106, v6, 3, v106
  v_mfma_f32_16x16x32_bf16 v[48:51], a[68:71], v[136:139], v[48:51]
  v_mfma_f32_16x16x32_bf16 v[52:55], a[68:71], v[140:143], v[52:55]
  buffer_load_dwordx4 v[160:163], v90, s[32:35], s65 offen sc1
  v_mfma_f32_16x16x32_bf16 v[56:59], a[72:75], v[128:131], v[56:59]
  v_mfma_f32_16x16x32_bf16 v[60:63], a[72:75], v[132:135], v[60:63]
  v_lshrrev_b32 v6, 4, v0
  v_mfma_f32_16x16x32_bf16 v[64:67], a[72:75], v[136:139], v[64:67]
  v_mfma_f32_16x16x32_bf16 v[68:71], a[72:75], v[140:143], v[68:71]
  v_lshlrev_b32 v107, 3, v107
  v_mfma_f32_16x16x32_bf16 v[72:75], a[76:79], v[128:131], v[72:75]
  buffer_load_dwordx4 a[204:207], v90, s[32:35], s66 offen sc1
  v_mfma_f32_16x16x32_bf16 v[76:79], a[76:79], v[132:135], v[76:79]
  v_lshl_add_u32 v107, v6, 30, v107
  v_mfma_f32_16x16x32_bf16 v[80:83], a[76:79], v[136:139], v[80:83]
  s_waitcnt vmcnt(10)
  v_mfma_f32_16x16x32_bf16 v[84:87], a[76:79], v[140:143], v[84:87]
  s_add_u32 s28, s4, 16777216
  s_addc_u32 s29, s5, 0
  v_mfma_f32_16x16x32_bf16 v[8:11], a[80:83], a[212:215], v[8:11]
  v_mfma_f32_16x16x32_bf16 v[12:15], a[80:83], a[216:219], v[12:15]
  s_mov_b32 s82, 20480
  buffer_load_dwordx4 a[240:243], v91, s[32:35], s82 offen sc1
  v_mfma_f32_16x16x32_bf16 v[16:19], a[80:83], a[220:223], v[16:19]
  v_mfma_f32_16x16x32_bf16 v[20:23], a[80:83], a[224:227], v[20:23]
  s_mov_b32 s30, 0x300000
  v_mfma_f32_16x16x32_bf16 v[24:27], a[84:87], a[212:215], v[24:27]
  v_mfma_f32_16x16x32_bf16 v[28:31], a[84:87], a[216:219], v[28:31]
  s_mov_b32 s31, 0x20000
  v_mfma_f32_16x16x32_bf16 v[32:35], a[84:87], a[220:223], v[32:35]
  buffer_load_dwordx4 v[168:171], v91, s[32:35], s64 offen sc1
  v_mfma_f32_16x16x32_bf16 v[36:39], a[84:87], a[224:227], v[36:39]
  v_mfma_f32_16x16x32_bf16 v[40:43], a[88:91], a[212:215], v[40:43]
  buffer_load_dwordx4 a[160:163], v2, s[40:43], 0 offen offset:0
  v_mfma_f32_16x16x32_bf16 v[44:47], a[88:91], a[216:219], v[44:47]
  v_mfma_f32_16x16x32_bf16 v[48:51], a[88:91], a[220:223], v[48:51]
  v_mfma_f32_16x16x32_bf16 v[52:55], a[88:91], a[224:227], v[52:55]
  buffer_load_dwordx4 v[164:167], v91, s[32:35], s65 offen sc1
  v_mfma_f32_16x16x32_bf16 v[56:59], a[92:95], a[212:215], v[56:59]
  v_mfma_f32_16x16x32_bf16 v[60:63], a[92:95], a[216:219], v[60:63]
  v_mfma_f32_16x16x32_bf16 v[64:67], a[92:95], a[220:223], v[64:67]
  v_mfma_f32_16x16x32_bf16 v[68:71], a[92:95], a[224:227], v[68:71]
  v_mfma_f32_16x16x32_bf16 v[72:75], v[240:243], a[212:215], v[72:75]
  buffer_load_dwordx4 a[208:211], v91, s[32:35], s66 offen sc1
  v_mfma_f32_16x16x32_bf16 v[76:79], v[240:243], a[216:219], v[76:79]
  v_mfma_f32_16x16x32_bf16 v[80:83], v[240:243], a[220:223], v[80:83]
  v_mfma_f32_16x16x32_bf16 v[84:87], v[240:243], a[224:227], v[84:87]
  s_cmp_eq_u32 s3, 2
  s_cbranch_scc1 Lout
  s_waitcnt vmcnt(14)
  v_mfma_f32_16x16x32_bf16 v[12:15], v[244:247], a[232:235], v[12:15]
  v_mfma_f32_16x16x32_bf16 v[28:31], v[248:251], a[232:235], v[28:31]
  s_mov_b32 s82, 20480
  buffer_load_dwordx4 a[228:231], v88, s[32:35], s82 offen sc1
  v_mfma_f32_16x16x32_bf16 v[44:47], v[252:255], a[232:235], v[44:47]
  v_mfma_f32_16x16x32_bf16 v[60:63], a[96:99], a[232:235], v[60:63]
  v_mfma_f32_16x16x32_bf16 v[76:79], a[100:103], a[232:235], v[76:79]
  s_waitcnt vmcnt(14)
  v_mfma_f32_16x16x32_bf16 v[12:15], a[104:107], a[248:251], v[12:15]
  v_mfma_f32_16x16x32_bf16 v[28:31], a[108:111], a[248:251], v[28:31]
  buffer_load_dwordx4 a[244:247], v88, s[32:35], s64 offen sc1
  v_mfma_f32_16x16x32_bf16 v[44:47], a[112:115], a[248:251], v[44:47]
  v_mfma_f32_16x16x32_bf16 v[60:63], a[116:119], a[248:251], v[60:63]
  v_mfma_f32_16x16x32_bf16 v[76:79], a[120:123], a[248:251], v[76:79]
  s_waitcnt vmcnt(13)
  v_mfma_f32_16x16x32_bf16 v[12:15], a[124:127], v[156:159], v[12:15]
  v_mfma_f32_16x16x32_bf16 v[28:31], a[128:131], v[156:159], v[28:31]
  buffer_load_dwordx4 v[152:155], v88, s[32:35], s65 offen sc1
  v_mfma_f32_16x16x32_bf16 v[44:47], a[132:135], v[156:159], v[44:47]
  v_mfma_f32_16x16x32_bf16 v[60:63], a[136:139], v[156:159], v[60:63]
  v_mfma_f32_16x16x32_bf16 v[76:79], a[140:143], v[156:159], v[76:79]
  s_waitcnt vmcnt(13)
  v_mfma_f32_16x16x32_bf16 v[12:15], a[144:147], a[200:203], v[12:15]
  v_mfma_f32_16x16x32_bf16 v[28:31], a[148:151], a[200:203], v[28:31]
  buffer_load_dwordx4 a[196:199], v88, s[32:35], s66 offen sc1
  v_mfma_f32_16x16x32_bf16 v[44:47], a[152:155], a[200:203], v[44:47]
  s_waitcnt vmcnt(11)
  v_mfma_f32_16x16x32_bf16 v[60:63], a[156:159], a[200:203], v[60:63]
  s_waitcnt vmcnt(6)
  v_mfma_f32_16x16x32_bf16 v[76:79], a[160:163], a[200:203], v[76:79]
  v_mfma_f32_16x16x32_bf16 v[16:19], v[244:247], a[236:239], v[16:19]
  v_mfma_f32_16x16x32_bf16 v[32:35], v[248:251], a[236:239], v[32:35]
  ds_write_b128 v92, v[12:15] offset:0
  v_mfma_f32_16x16x32_bf16 v[48:51], v[252:255], a[236:239], v[48:51]
  v_mfma_f32_16x16x32_bf16 v[64:67], a[96:99], a[236:239], v[64:67]
  buffer_load_dwordx4 a[164:167], v1, s[48:51], 0 offen offset:0
  buffer_load_dwordx4 a[168:171], v1, s[48:51], 0 offen offset:1024
  v_mfma_f32_16x16x32_bf16 v[80:83], a[100:103], a[236:239], v[80:83]
  v_mfma_f32_16x16x32_bf16 v[16:19], a[104:107], a[252:255], v[16:19]
  ds_write_b128 v92, v[28:31] offset:1024
  v_mfma_f32_16x16x32_bf16 v[32:35], a[108:111], a[252:255], v[32:35]
  v_mfma_f32_16x16x32_bf16 v[48:51], a[112:115], a[252:255], v[48:51]
  v_mfma_f32_16x16x32_bf16 v[64:67], a[116:119], a[252:255], v[64:67]
  v_mfma_f32_16x16x32_bf16 v[80:83], a[120:123], a[252:255], v[80:83]
  ds_write_b128 v92, v[44:47] offset:2048
  v_mfma_f32_16x16x32_bf16 v[16:19], a[124:127], v[160:163], v[16:19]
  v_mfma_f32_16x16x32_bf16 v[32:35], a[128:131], v[160:163], v[32:35]
  v_mfma_f32_16x16x32_bf16 v[48:51], a[132:135], v[160:163], v[48:51]
  v_mfma_f32_16x16x32_bf16 v[64:67], a[136:139], v[160:163], v[64:67]
  ds_write_b128 v92, v[60:63] offset:3072
  v_mfma_f32_16x16x32_bf16 v[80:83], a[140:143], v[160:163], v[80:83]
  v_mfma_f32_16x16x32_bf16 v[16:19], a[144:147], a[204:207], v[16:19]
  v_mfma_f32_16x16x32_bf16 v[32:35], a[148:151], a[204:207], v[32:35]
  v_mfma_f32_16x16x32_bf16 v[48:51], a[152:155], a[204:207], v[48:51]
  ds_write_b128 v92, v[76:79] offset:4096
  v_mfma_f32_16x16x32_bf16 v[64:67], a[156:159], a[204:207], v[64:67]
  v_mfma_f32_16x16x32_bf16 v[80:83], a[160:163], a[204:207], v[80:83]
  v_mfma_f32_16x16x32_bf16 v[20:23], v[244:247], a[240:243], v[20:23]
  v_mfma_f32_16x16x32_bf16 v[36:39], v[248:251], a[240:243], v[36:39]
  s_nop 0
  ds_write_b128 v92, v[16:19] offset:5120
  v_mfma_f32_16x16x32_bf16 v[52:55], v[252:255], a[240:243], v[52:55]
  v_mfma_f32_16x16x32_bf16 v[68:71], a[96:99], a[240:243], v[68:71]
  buffer_load_dwordx4 a[172:175], v1, s[48:51], 0 offen offset:2048
  buffer_load_dwordx4 a[176:179], v1, s[48:51], 0 offen offset:3072
  v_mfma_f32_16x16x32_bf16 v[84:87], a[100:103], a[240:243], v[84:87]
  v_mfma_f32_16x16x32_bf16 v[20:23], a[104:107], v[168:171], v[20:23]
  ds_write_b128 v92, v[32:35] offset:6144
  v_mfma_f32_16x16x32_bf16 v[36:39], a[108:111], v[168:171], v[36:39]
  v_mfma_f32_16x16x32_bf16 v[52:55], a[112:115], v[168:171], v[52:55]
  v_mfma_f32_16x16x32_bf16 v[68:71], a[116:119], v[168:171], v[68:71]
  v_mfma_f32_16x16x32_bf16 v[84:87], a[120:123], v[168:171], v[84:87]
  ds_write_b128 v92, v[48:51] offset:7168
  s_waitcnt vmcnt(9)
  v_mfma_f32_16x16x32_bf16 v[20:23], a[124:127], v[164:167], v[20:23]
  v_mfma_f32_16x16x32_bf16 v[36:39], a[128:131], v[164:167], v[36:39]
  v_mfma_f32_16x16x32_bf16 v[52:55], a[132:135], v[164:167], v[52:55]
  v_mfma_f32_16x16x32_bf16 v[68:71], a[136:139], v[164:167], v[68:71]
  ds_write_b128 v92, v[64:67] offset:8192
  v_mfma_f32_16x16x32_bf16 v[84:87], a[140:143], v[164:167], v[84:87]
  s_waitcnt vmcnt(8)
  v_mfma_f32_16x16x32_bf16 v[20:23], a[144:147], a[208:211], v[20:23]
  v_mfma_f32_16x16x32_bf16 v[36:39], a[148:151], a[208:211], v[36:39]
  v_mfma_f32_16x16x32_bf16 v[52:55], a[152:155], a[208:211], v[52:55]
  ds_write_b128 v92, v[80:83] offset:9216
  v_mfma_f32_16x16x32_bf16 v[68:71], a[156:159], a[208:211], v[68:71]
  v_mfma_f32_16x16x32_bf16 v[84:87], a[160:163], a[208:211], v[84:87]
  s_waitcnt vmcnt(7)
  v_mfma_f32_16x16x32_bf16 v[8:11], v[244:247], a[228:231], v[8:11]
  v_mfma_f32_16x16x32_bf16 v[24:27], v[248:251], a[228:231], v[24:27]
  ds_write_b128 v92, v[20:23] offset:10240
  v_mfma_f32_16x16x32_bf16 v[40:43], v[252:255], a[228:231], v[40:43]
  v_mfma_f32_16x16x32_bf16 v[56:59], a[96:99], a[228:231], v[56:59]
  v_mfma_f32_16x16x32_bf16 v[72:75], a[100:103], a[228:231], v[72:75]
  s_waitcnt vmcnt(6)
  v_mfma_f32_16x16x32_bf16 v[8:11], a[104:107], a[244:247], v[8:11]
  ds_write_b128 v92, v[36:39] offset:11264
  v_mfma_f32_16x16x32_bf16 v[24:27], a[108:111], a[244:247], v[24:27]
  v_mfma_f32_16x16x32_bf16 v[40:43], a[112:115], a[244:247], v[40:43]
  v_mfma_f32_16x16x32_bf16 v[56:59], a[116:119], a[244:247], v[56:59]
  v_mfma_f32_16x16x32_bf16 v[72:75], a[120:123], a[244:247], v[72:75]
  ds_write_b128 v92, v[52:55] offset:12288
  s_waitcnt vmcnt(5)
  v_mfma_f32_16x16x32_bf16 v[8:11], a[124:127], v[152:155], v[8:11]
  v_mfma_f32_16x16x32_bf16 v[24:27], a[128:131], v[152:155], v[24:27]
  v_mfma_f32_16x16x32_bf16 v[40:43], a[132:135], v[152:155], v[40:43]
  v_mfma_f32_16x16x32_bf16 v[56:59], a[136:139], v[152:155], v[56:59]
  ds_write_b128 v92, v[68:71] offset:13312
  v_mfma_f32_16x16x32_bf16 v[72:75], a[140:143], v[152:155], v[72:75]
  s_waitcnt vmcnt(4)
  v_mfma_f32_16x16x32_bf16 v[8:11], a[144:147], a[196:199], v[8:11]
  v_mfma_f32_16x16x32_bf16 v[24:27], a[148:151], a[196:199], v[24:27]
  v_mfma_f32_16x16x32_bf16 v[40:43], a[152:155], a[196:199], v[40:43]
  ds_write_b128 v92, v[84:87] offset:14336
  v_mfma_f32_16x16x32_bf16 v[56:59], a[156:159], a[196:199], v[56:59]
  v_mfma_f32_16x16x32_bf16 v[72:75], a[160:163], a[196:199], v[72:75]
  buffer_load_dwordx4 a[180:183], v2, s[48:51], 0 offen offset:0
  buffer_load_dwordx4 a[184:187], v2, s[48:51], 0 offen offset:1024
  buffer_load_dwordx4 a[188:191], v2, s[48:51], 0 offen offset:2048
  buffer_load_dwordx4 a[192:195], v2, s[48:51], 0 offen offset:3072
  s_waitcnt lgkmcnt(0)
  s_barrier
  ds_read_b128 v[108:111], v93 offset:0
  ds_read_b128 v[112:115], v94 offset:0
  ds_read_b128 v[116:119], v95 offset:0
  ds_read_b128 v[120:123], v93 offset:1024
  ds_read_b128 v[124:127], v94 offset:1024
  ds_read_b128 v[128:131], v95 offset:1024
  ds_read_b128 v[132:135], v93 offset:2048
  ds_read_b128 v[136:139], v94 offset:2048
  ds_read_b128 v[140:143], v95 offset:2048
  ds_read_b128 v[144:147], v93 offset:3072
  ds_read_b128 v[148:151], v94 offset:3072
  ds_read_b128 v[152:155], v95 offset:3072
  ds_read_b128 v[156:159], v93 offset:4096
  ds_read_b128 v[160:163], v94 offset:4096
  ds_read_b128 v[164:167], v95 offset:4096
  s_add_u32 s48, s48, 8192
  s_addc_u32 s49, s49, 0
  buffer_load_dwordx4 v[172:175], v1, s[48:51], 0 offen offset:0
  buffer_load_dwordx4 v[176:179], v1, s[48:51], 0 offen offset:1024
  buffer_load_dwordx4 v[180:183], v1, s[48:51], 0 offen offset:2048
  buffer_load_dwordx4 v[184:187], v1, s[48:51], 0 offen offset:3072
  v_lshlrev_b32 v16, 16, v96
  v_and_b32 v17, 0xffff0000, v96
  v_lshlrev_b32 v18, 16, v97
  v_and_b32 v19, 0xffff0000, v97
  v_lshlrev_b32 v32, 16, v98
  v_and_b32 v33, 0xffff0000, v98
  v_lshlrev_b32 v34, 16, v99
  v_and_b32 v35, 0xffff0000, v99
  v_lshlrev_b32 v48, 16, v100
  v_and_b32 v49, 0xffff0000, v100
  v_lshlrev_b32 v50, 16, v101
  v_and_b32 v51, 0xffff0000, v101
  v_lshlrev_b32 v64, 16, v102
  v_and_b32 v65, 0xffff0000, v102
  v_lshlrev_b32 v66, 16, v103
  v_and_b32 v67, 0xffff0000, v103
  v_lshlrev_b32 v80, 16, v104
  v_and_b32 v81, 0xffff0000, v104
  v_lshlrev_b32 v82, 16, v105
  v_and_b32 v83, 0xffff0000, v105
  s_waitcnt lgkmcnt(13)
  v_pk_add_f32 v[108:109], v[108:109], v[112:113]
  v_pk_add_f32 v[110:111], v[110:111], v[114:115]
  s_waitcnt lgkmcnt(12)
  v_pk_add_f32 v[8:9], v[8:9], v[116:117]
  v_pk_add_f32 v[10:11], v[10:11], v[118:119]
  v_pk_add_f32 v[8:9], v[8:9], v[108:109]
  v_pk_add_f32 v[10:11], v[10:11], v[110:111]
  v_pk_fma_f32 v[8:9], v[8:9], s[92:93], v[16:17]
  v_pk_fma_f32 v[10:11], v[10:11], s[92:93], v[18:19]
  v_cvt_pk_bf16_f32 v12, v8, v9
  v_cvt_pk_bf16_f32 v13, v10, v11
  s_waitcnt lgkmcnt(10)
  v_pk_add_f32 v[120:121], v[120:121], v[124:125]
  v_pk_add_f32 v[122:123], v[122:123], v[126:127]
  s_waitcnt lgkmcnt(9)
  v_pk_add_f32 v[24:25], v[24:25], v[128:129]
  v_pk_add_f32 v[26:27], v[26:27], v[130:131]
  v_pk_add_f32 v[24:25], v[24:25], v[120:121]
  v_pk_add_f32 v[26:27], v[26:27], v[122:123]
  v_pk_fma_f32 v[24:25], v[24:25], s[92:93], v[32:33]
  v_pk_fma_f32 v[26:27], v[26:27], s[92:93], v[34:35]
  v_cvt_pk_bf16_f32 v14, v24, v25
  v_cvt_pk_bf16_f32 v15, v26, v27
  s_waitcnt lgkmcnt(7)
  v_pk_add_f32 v[132:133], v[132:133], v[136:137]
  v_pk_add_f32 v[134:135], v[134:135], v[138:139]
  s_waitcnt lgkmcnt(6)
  v_pk_add_f32 v[40:41], v[40:41], v[140:141]
  v_pk_add_f32 v[42:43], v[42:43], v[142:143]
  v_pk_add_f32 v[40:41], v[40:41], v[132:133]
  v_pk_add_f32 v[42:43], v[42:43], v[134:135]
  v_pk_fma_f32 v[40:41], v[40:41], s[92:93], v[48:49]
  v_pk_fma_f32 v[42:43], v[42:43], s[92:93], v[50:51]
  v_cvt_pk_bf16_f32 v16, v40, v41
  v_cvt_pk_bf16_f32 v17, v42, v43
  s_waitcnt lgkmcnt(4)
  v_pk_add_f32 v[144:145], v[144:145], v[148:149]
  v_pk_add_f32 v[146:147], v[146:147], v[150:151]
  s_waitcnt lgkmcnt(3)
  v_pk_add_f32 v[56:57], v[56:57], v[152:153]
  v_pk_add_f32 v[58:59], v[58:59], v[154:155]
  v_pk_add_f32 v[56:57], v[56:57], v[144:145]
  v_pk_add_f32 v[58:59], v[58:59], v[146:147]
  v_pk_fma_f32 v[56:57], v[56:57], s[92:93], v[64:65]
  v_pk_fma_f32 v[58:59], v[58:59], s[92:93], v[66:67]
  v_cvt_pk_bf16_f32 v18, v56, v57
  v_cvt_pk_bf16_f32 v19, v58, v59
  s_waitcnt lgkmcnt(1)
  v_pk_add_f32 v[156:157], v[156:157], v[160:161]
  v_pk_add_f32 v[158:159], v[158:159], v[162:163]
  s_waitcnt lgkmcnt(0)
  v_pk_add_f32 v[72:73], v[72:73], v[164:165]
  v_pk_add_f32 v[74:75], v[74:75], v[166:167]
  v_pk_add_f32 v[72:73], v[72:73], v[156:157]
  v_pk_add_f32 v[74:75], v[74:75], v[158:159]
  v_pk_fma_f32 v[72:73], v[72:73], s[92:93], v[80:81]
  v_pk_fma_f32 v[74:75], v[74:75], s[92:93], v[82:83]
  v_cvt_pk_bf16_f32 v20, v72, v73
  v_cvt_pk_bf16_f32 v21, v74, v75
  buffer_store_dwordx4 v[12:15], v1, s[28:31], s70 offen
  buffer_store_dwordx4 v[16:19], v1, s[28:31], s70 offen offset:1024
  buffer_store_dwordx2 v[20:21], v106, s[28:31], s70 offen offset:2048
  v_pk_add_f32 v[108:109], v[8:9], v[10:11]
  v_pk_mul_f32 v[110:111], v[8:9], v[8:9]
  v_pk_fma_f32 v[110:111], v[10:11], v[10:11], v[110:111]
  v_pk_add_f32 v[108:109], v[108:109], v[24:25]
  v_pk_fma_f32 v[110:111], v[24:25], v[24:25], v[110:111]
  v_pk_add_f32 v[108:109], v[108:109], v[26:27]
  v_pk_fma_f32 v[110:111], v[26:27], v[26:27], v[110:111]
  v_pk_add_f32 v[108:109], v[108:109], v[40:41]
  v_pk_fma_f32 v[110:111], v[40:41], v[40:41], v[110:111]
  v_pk_add_f32 v[108:109], v[108:109], v[42:43]
  v_pk_fma_f32 v[110:111], v[42:43], v[42:43], v[110:111]
  v_pk_add_f32 v[108:109], v[108:109], v[56:57]
  v_pk_fma_f32 v[110:111], v[56:57], v[56:57], v[110:111]
  v_pk_add_f32 v[108:109], v[108:109], v[58:59]
  v_pk_fma_f32 v[110:111], v[58:59], v[58:59], v[110:111]
  v_pk_add_f32 v[108:109], v[108:109], v[72:73]
  v_pk_fma_f32 v[110:111], v[72:73], v[72:73], v[110:111]
  v_pk_add_f32 v[108:109], v[108:109], v[74:75]
  v_pk_fma_f32 v[110:111], v[74:75], v[74:75], v[110:111]
  v_add_f32 v108, v108, v109
  v_add_f32 v109, v110, v111
  v_mov_b32 v110, v108
  v_mov_b32 v111, v109
  s_nop 0
  v_permlane16_swap_b32 v108, v110
  v_permlane16_swap_b32 v109, v111
  v_pk_add_f32 v[108:109], v[108:109], v[110:111]
  v_mov_b32 v110, v108
  v_mov_b32 v111, v109
  s_nop 0
  v_permlane32_swap_b32 v108, v110
  v_permlane32_swap_b32 v109, v111
  v_pk_add_f32 v[108:109], v[108:109], v[110:111]
  buffer_store_dwordx2 v[108:109], v107, s[28:31], s71 offen
  v_and_b32 v107, 15, v0
  v_bfe_u32 v6, v0, 4, 1
  v_mul_u32_u24 v106, 20480, v6
  v_lshl_add_u32 v106, v107, 4, v106
  v_lshrrev_b32 v6, 5, v0
  v_lshl_add_u32 v106, v6, 8, v106
  v_lshrrev_b32 v6, 4, v0
  v_lshlrev_b32 v107, 3, v107
  v_lshl_add_u32 v107, v6, 8, v107
  s_lshr_b32 s13, s8, 3
  s_mul_i32 s13, s13, 20480
  s_add_u32 s13, s13, 16777216
  s_add_u32 s52, s4, s13
  s_addc_u32 s53, s5, 0
  s_mov_b32 s54, 4096
  s_mov_b32 s55, 0x20000
  s_lshr_b32 s13, s8, 3
  s_lshl_b32 s13, s13, 10
  s_add_u32 s13, s13, 19398656
  s_add_u32 s56, s4, s13
  s_addc_u32 s57, s5, 0
  s_mov_b32 s58, 1024
  s_mov_b32 s59, 0x20000
  s_mul_i32 m0, s12, 20480
  s_waitcnt vmcnt(0)
  v_mov_b32 v6, s0
  s_cmp_lg_u32 s73, 0
  s_cbranch_scc0 Lsigs3
  buffer_store_dword v6, v3, s[44:47], s79 offen offset:384
Lsigd3:
  buffer_load_dwordx4 v[188:191], v2, s[48:51], 0 offen offset:0
  buffer_load_dwordx4 v[192:195], v2, s[48:51], 0 offen offset:1024
  buffer_load_dwordx4 v[196:199], v2, s[48:51], 0 offen offset:2048
  buffer_load_dwordx4 v[200:203], v2, s[48:51], 0 offen offset:3072
  s_add_u32 s48, s48, 8192
  s_addc_u32 s49, s49, 0
  buffer_load_dwordx4 v[204:207], v1, s[48:51], 0 offen offset:0
  s_mov_b32 s80, 0x400000
Lpoll4:
  buffer_load_dword v6, v4, s[44:47], s79 offen offset:384 sc1
  s_sub_u32 s80, s80, 1
  s_cbranch_scc1 Lpolled4
  s_waitcnt vmcnt(0)
  v_cmp_eq_u32 vcc, s0, v6
  s_nop 0
  s_and_b32 s81, vcc_lo, s78
  s_cmp_eq_u32 s81, s78
  s_cbranch_scc0 Lpoll4
Lpolled4:
  s_cmp_lg_u32 s73, 0
  s_cbranch_scc0 Lacqs4
Lacq4:
  buffer_load_dwordx4 v1, s[52:55], 0 offen offset:0 sc1 lds
  buffer_load_dwordx4 v1, s[52:55], 0 offen offset:1024 sc1 lds
  buffer_load_dwordx4 v1, s[52:55], 0 offen offset:2048 sc1 lds
  buffer_load_dwordx4 v1, s[52:55], 0 offen offset:3072 sc1 lds
  s_add_u32 m0, m0, 4096
  s_add_u32 s52, s52, 4096
  s_addc_u32 s53, s53, 0
  buffer_load_dwordx4 v1, s[52:55], 0 offen offset:0 sc1 lds
  buffer_load_dwordx2 v[116:117], v107, s[56:59], 0 offen sc1
  buffer_load_dwordx2 v[118:119], v107, s[56:59], 0 offen offset:128 sc1
  buffer_load_dwordx4 v1, s[52:55], 0 offen offset:1024 sc1 lds
  buffer_load_dwordx4 v1, s[52:55], 0 offen offset:2048 sc1 lds
  buffer_load_dwordx4 v1, s[52:55], 0 offen offset:3072 sc1 lds
  s_waitcnt vmcnt(8)
  s_barrier
  ds_read_b128 v[72:75], v106 offset:0
  ds_read_b128 v[76:79], v106 offset:40960
  ds_read_b128 v[80:83], v106 offset:512
  ds_read_b128 v[84:87], v106 offset:41472
  ds_read_b128 v[88:91], v106 offset:1024
  s_waitcnt lgkmcnt(4)
  v_mfma_f32_32x32x16_bf16 v[8:23], a[164:167], v[72:75], 0
  ds_read_b128 v[92:95], v106 offset:41984
  s_add_u32 m0, m0, 4096
  s_add_u32 s52, s52, 4096
  s_addc_u32 s53, s53, 0
  buffer_load_dwordx4 v1, s[52:55], 0 offen offset:0 sc1 lds
  s_waitcnt lgkmcnt(4)
  v_mfma_f32_32x32x16_bf16 v[24:39], a[164:167], v[76:79], 0
  ds_read_b128 v[72:75], v106 offset:1536
  buffer_load_dwordx4 v1, s[52:55], 0 offen offset:1024 sc1 lds
  s_waitcnt lgkmcnt(3)
  v_mfma_f32_32x32x16_bf16 v[8:23], a[168:171], v[80:83], v[8:23]
  ds_read_b128 v[76:79], v106 offset:42496
  buffer_load_dwordx4 v1, s[52:55], 0 offen offset:2048 sc1 lds
  v_mfma_f32_32x32x16_bf16 v[24:39], a[168:171], v[84:87], v[24:39]
  s_waitcnt vmcnt(8)
  s_barrier
  ds_read_b128 v[80:83], v106 offset:2048
  buffer_load_dwordx4 v1, s[52:55], 0 offen offset:3072 sc1 lds
  s_waitcnt lgkmcnt(3)
  v_mfma_f32_32x32x16_bf16 v[8:23], a[172:175], v[88:91], v[8:23]
  ds_read_b128 v[84:87], v106 offset:43008
  s_add_u32 m0, m0, 4096
  s_add_u32 s52, s52, 4096
  s_addc_u32 s53, s53, 0
  buffer_load_dwordx4 v1, s[52:55], 0 offen offset:0 sc1 lds
  v_mfma_f32_32x32x16_bf16 v[24:39], a[172:175], v[92:95], v[24:39]
  ds_read_b128 v[88:91], v106 offset:2560
  buffer_load_dwordx4 v1, s[52:55], 0 offen offset:1024 sc1 lds
  s_waitcnt lgkmcnt(3)
  v_mfma_f32_32x32x16_bf16 v[8:23], a[176:179], v[72:75], v[8:23]
  ds_read_b128 v[92:95], v106 offset:43520
  buffer_load_dwordx4 v1, s[52:55], 0 offen offset:2048 sc1 lds
  v_mfma_f32_32x32x16_bf16 v[24:39], a[176:179], v[76:79], v[24:39]
  ds_read_b128 v[72:75], v106 offset:3072
  buffer_load_dwordx4 v1, s[52:55], 0 offen offset:3072 sc1 lds
  s_waitcnt lgkmcnt(3)
  v_mfma_f32_32x32x16_bf16 v[8:23], a[180:183], v[80:83], v[8:23]
  ds_read_b128 v[76:79], v106 offset:44032
  s_add_u32 m0, m0, 4096
  s_add_u32 s52, s52, 4096
  s_addc_u32 s53, s53, 0
  buffer_load_dwordx4 v1, s[52:55], 0 offen offset:0 sc1 lds
  v_mfma_f32_32x32x16_bf16 v[24:39], a[180:183], v[84:87], v[24:39]
  ds_read_b128 v[80:83], v106 offset:3584
  buffer_load_dwordx4 v1, s[52:55], 0 offen offset:1024 sc1 lds
  s_waitcnt lgkmcnt(3)
  v_mfma_f32_32x32x16_bf16 v[8:23], a[184:187], v[88:91], v[8:23]
  ds_read_b128 v[84:87], v106 offset:44544
  buffer_load_dwordx4 v1, s[52:55], 0 offen offset:2048 sc1 lds
  v_mfma_f32_32x32x16_bf16 v[24:39], a[184:187], v[92:95], v[24:39]
  ds_read_b128 v[88:91], v106 offset:4096
  buffer_load_dwordx4 v1, s[52:55], 0 offen offset:3072 sc1 lds
  s_waitcnt lgkmcnt(3)
  v_mfma_f32_32x32x16_bf16 v[8:23], a[188:191], v[72:75], v[8:23]
  ds_read_b128 v[92:95], v106 offset:45056
  buffer_load_dwordx4 v[208:211], v1, s[48:51], 0 offen offset:1024
  buffer_load_dwordx4 v[212:215], v1, s[48:51], 0 offen offset:2048
  v_mfma_f32_32x32x16_bf16 v[24:39], a[188:191], v[76:79], v[24:39]
  ds_read_b128 v[72:75], v106 offset:4608
  s_mul_i32 s17, s12, 15360
  s_add_u32 s17, s17, 102400
  s_waitcnt lgkmcnt(3)
  v_mfma_f32_32x32x16_bf16 v[8:23], a[192:195], v[80:83], v[8:23]
  ds_read_b128 v[76:79], v106 offset:45568
  v_add_u32 v46, s17, v1
  s_xor_b32 s17, s12, 1
  v_mfma_f32_32x32x16_bf16 v[24:39], a[192:195], v[84:87], v[24:39]
  s_waitcnt vmcnt(12)
  s_barrier
  ds_read_b128 v[80:83], v106 offset:5120
  s_mul_i32 s17, s17, 15360
  s_add_u32 s17, s17, 102400
  s_waitcnt lgkmcnt(3)
  v_mfma_f32_32x32x16_bf16 v[8:23], v[172:175], v[88:91], v[8:23]
  ds_read_b128 v[84:87], v106 offset:46080
  buffer_load_dwordx4 v[216:219], v1, s[48:51], 0 offen offset:3072
  buffer_load_dwordx4 v[220:223], v2, s[48:51], 0 offen offset:0
  v_mfma_f32_32x32x16_bf16 v[24:39], v[172:175], v[92:95], v[24:39]
  ds_read_b128 v[88:91], v106 offset:5632
  v_add_u32 v47, s17, v1
  s_lshl_b32 s75, s10, 5
  s_waitcnt lgkmcnt(3)
  v_mfma_f32_32x32x16_bf16 v[8:23], v[176:179], v[72:75], v[8:23]
  ds_read_b128 v[92:95], v106 offset:46592
  s_add_u32 s75, s75, 66560
  s_lshl_b32 s14, s10, 10
  v_mfma_f32_32x32x16_bf16 v[24:39], v[176:179], v[76:79], v[24:39]
  ds_read_b128 v[72:75], v106 offset:6144
  s_add_u32 s14, s14, 32768
  s_cmp_lt_u32 s11, 2
  s_cselect_b32 s75, s75, 1073741824
  s_cselect_b32 s14, s14, 1073741824
  s_waitcnt lgkmcnt(3)
  v_mfma_f32_32x32x16_bf16 v[8:23], v[180:183], v[80:83], v[8:23]
  ds_read_b128 v[76:79], v106 offset:47104
  buffer_load_dwordx4 v[224:227], v2, s[48:51], 0 offen offset:1024
  buffer_load_dwordx4 v[228:231], v2, s[48:51], 0 offen offset:2048
  v_mfma_f32_32x32x16_bf16 v[24:39], v[180:183], v[84:87], v[24:39]
  ds_read_b128 v[80:83], v106 offset:6656
  s_mul_i32 s17, s10, 7168
  s_add_u32 s17, s17, 40894464
  s_waitcnt lgkmcnt(3)
  v_mfma_f32_32x32x16_bf16 v[8:23], v[184:187], v[88:91], v[8:23]
  ds_read_b128 v[84:87], v106 offset:47616
  s_cmp_eq_u32 s11, 0
  s_cselect_b32 s18, 531456, 0
  s_cmp_lt_u32 s12, 3
  s_cselect_b32 s18, s18, 0
  v_mfma_f32_32x32x16_bf16 v[24:39], v[184:187], v[92:95], v[24:39]
  ds_read_b128 v[88:91], v106 offset:7168
  s_add_u32 s32, s4, s17
  s_addc_u32 s33, s5, 0
  s_mov_b32 s34, s18
  s_waitcnt lgkmcnt(3)
  v_mfma_f32_32x32x16_bf16 v[8:23], v[188:191], v[72:75], v[8:23]
  ds_read_b128 v[92:95], v106 offset:48128
  buffer_load_dwordx4 v[232:235], v2, s[48:51], 0 offen offset:3072
  s_add_u32 s48, s48, 8192
  s_addc_u32 s49, s49, 0
  buffer_load_dwordx4 v[236:239], v1, s[48:51], 0 offen offset:0
  v_mfma_f32_32x32x16_bf16 v[24:39], v[188:191], v[76:79], v[24:39]
  ds_read_b128 v[72:75], v106 offset:7680
  s_mov_b32 s35, 0x20000
  s_cmp_eq_u32 s11, 1
  s_cselect_b32 s18, 531456, 0
  s_waitcnt lgkmcnt(3)
  v_mfma_f32_32x32x16_bf16 v[8:23], v[192:195], v[80:83], v[8:23]
  ds_read_b128 v[76:79], v106 offset:48640
  s_add_u32 s36, s4, s17
  s_addc_u32 s37, s5, 0
  s_mov_b32 s38, s18
  v_mfma_f32_32x32x16_bf16 v[24:39], v[192:195], v[84:87], v[24:39]
  ds_read_b128 v[80:83], v106 offset:8192
  s_mov_b32 s39, 0x20000
  s_mov_b32 s15, 0x3f80
  s_waitcnt lgkmcnt(3)
  v_mfma_f32_32x32x16_bf16 v[8:23], v[196:199], v[88:91], v[8:23]
  ds_read_b128 v[84:87], v106 offset:49152
  buffer_load_dwordx4 a[0:3], v1, s[48:51], 0 offen offset:1024
  buffer_load_dwordx4 a[4:7], v1, s[48:51], 0 offen offset:2048
  v_mfma_f32_32x32x16_bf16 v[24:39], v[196:199], v[92:95], v[24:39]
  ds_read_b128 v[88:91], v106 offset:8704
  s_mov_b32 s16, 0x3f803f80
  s_cmp_eq_u32 s11, 0
  s_cselect_b32 s16, s16, s15
  s_cselect_b32 s15, s15, 0
  s_waitcnt lgkmcnt(3)
  v_mfma_f32_32x32x16_bf16 v[8:23], v[200:203], v[72:75], v[8:23]
  ds_read_b128 v[92:95], v106 offset:49664
  v_mov_b32 v40, s16
  v_mov_b32 v41, s15
  v_mfma_f32_32x32x16_bf16 v[24:39], v[200:203], v[76:79], v[24:39]
  ds_read_b128 v[72:75], v106 offset:9216
  s_lshl_b32 s15, s12, 3
  s_add_u32 s16, s15, 1024
  s_waitcnt lgkmcnt(3)
  v_mfma_f32_32x32x16_bf16 v[8:23], v[204:207], v[80:83], v[8:23]
  ds_read_b128 v[76:79], v106 offset:50176
  buffer_load_dwordx4 a[8:11], v1, s[48:51], 0 offen offset:3072
  buffer_load_dwordx4 a[12:15], v2, s[48:51], 0 offen offset:0
  v_add_f32 v116, v116, v118
  v_add_f32 v117, v117, v119
  v_mfma_f32_32x32x16_bf16 v[24:39], v[204:207], v[84:87], v[24:39]
  ds_read_b128 v[80:83], v106 offset:9728
  s_cmp_eq_u32 s12, 2
  s_cselect_b32 s15, 2048, s15
  s_cselect_b32 s16, 2056, s16
  s_lshl_b32 s17, s12, 11
  s_waitcnt lgkmcnt(3)
  s_waitcnt vmcnt(11)
  v_mov_b32 v140, v116
  s_nop 1
  v_permlane16_swap_b32 v116, v140
  v_mfma_f32_32x32x16_bf16 v[8:23], v[208:211], v[88:91], v[8:23]
  ds_read_b128 v[84:87], v106 offset:50688
  s_add_u32 s17, s17, 86016
  v_lshrrev_b32 v6, 5, v0
  v_add_f32 v116, v116, v140
  v_mov_b32 v140, v116
  v_mfma_f32_32x32x16_bf16 v[24:39], v[208:211], v[92:95], v[24:39]
  s_barrier
  ds_read_b128 v[88:91], v106 offset:10240
  v_mul_u32_u24 v6, 576, v6
  v_and_b32 v7, 31, v0
  s_waitcnt lgkmcnt(3)
  s_waitcnt vmcnt(10)
  v_permlane32_swap_b32 v116, v140
  v_add_f32 v116, v116, v140
  v_mfma_f32_32x32x16_bf16 v[8:23], v[212:215], v[72:75], v[8:23]
  ds_read_b128 v[92:95], v106 offset:51200
  buffer_load_dwordx4 a[16:19], v2, s[48:51], 0 offen offset:1024
  buffer_load_dwordx4 a[20:23], v2, s[48:51], 0 offen offset:2048
  v_mov_b32 v140, v117
  s_nop 1
  v_permlane16_swap_b32 v117, v140
  v_mfma_f32_32x32x16_bf16 v[24:39], v[212:215], v[76:79], v[24:39]
  ds_read_b128 v[72:75], v106 offset:10752
  v_lshl_add_u32 v42, v7, 1, v6
  v_add_u32 v42, s17, v42
  s_waitcnt lgkmcnt(3)
  s_waitcnt vmcnt(11)
  v_add_f32 v117, v117, v140
  v_mov_b32 v140, v117
  v_mfma_f32_32x32x16_bf16 v[8:23], v[216:219], v[80:83], v[8:23]
  ds_read_b128 v[76:79], v106 offset:51712
  v_and_b32 v6, 7, v0
  v_lshrrev_b32 v7, 3, v0
  v_permlane32_swap_b32 v117, v140
  v_add_f32 v117, v117, v140
  v_mfma_f32_32x32x16_bf16 v[24:39], v[216:219], v[84:87], v[24:39]
  ds_read_b128 v[80:83], v106 offset:11264
  v_mul_u32_u24 v43, 144, v6
  v_lshl_add_u32 v43, v7, 4, v43
  s_waitcnt lgkmcnt(3)
  s_waitcnt vmcnt(10)
  v_mul_f32 v116, 0x3acccccd, v116
  v_mul_f32 v117, 0x3acccccd, v117
  v_mfma_f32_32x32x16_bf16 v[8:23], v[220:223], v[88:91], v[8:23]
  ds_read_b128 v[84:87], v106 offset:52224
  buffer_load_dwordx4 a[24:27], v2, s[48:51], 0 offen offset:3072
  s_add_u32 s48, s48, 8192
  s_addc_u32 s49, s49, 0
  buffer_load_dwordx4 a[28:31], v1, s[48:51], 0 offen offset:0
  v_fma_f32 v117, -v116, v116, v117
  v_max_f32 v117, 0, v117
  v_mfma_f32_32x32x16_bf16 v[24:39], v[220:223], v[92:95], v[24:39]
  ds_read_b128 v[88:91], v106 offset:11776
  v_add_u32 v43, s17, v43
  v_lshlrev_b32 v44, 9, v7
  s_waitcnt lgkmcnt(3)
  s_waitcnt vmcnt(11)
  v_add_f32 v117, 0x3727c5ac, v117
  v_rsq_f32 v140, v117
  v_mfma_f32_32x32x16_bf16 v[8:23], v[224:227], v[72:75], v[8:23]
  ds_read_b128 v[92:95], v106 offset:52736
  v_lshl_add_u32 v44, v6, 4, v44
  s_lshl_b32 s19, s12, 7
  v_sub_f32 v116, 0, v116
  v_mul_f32 v117, v117, v140
  v_mfma_f32_32x32x16_bf16 v[24:39], v[224:227], v[76:79], v[24:39]
  ds_read_b128 v[72:75], v106 offset:12288
  v_add_u32 v48, 524288, v1
  v_add_u32 v49, 524288, v44
  s_waitcnt lgkmcnt(3)
  s_waitcnt vmcnt(10)
  v_cvt_pk_bf16_f32 v145, v116, v117
  v_lshlrev_b32 v141, 16, v145
  v_mfma_f32_32x32x16_bf16 v[8:23], v[228:231], v[80:83], v[8:23]
  ds_read_b128 v[76:79], v106 offset:53248
  buffer_load_dwordx4 a[32:35], v1, s[48:51], 0 offen offset:1024
  buffer_load_dwordx4 a[36:39], v1, s[48:51], 0 offen offset:2048
  v_sub_f32 v116, v116, v141
  v_cvt_pk_bf16_f32 v144, v141, v116
  v_mfma_f32_32x32x16_bf16 v[24:39], v[228:231], v[84:87], v[24:39]
  ds_read_b128 v[80:83], v106 offset:12800
  s_waitcnt lgkmcnt(3)
  s_waitcnt vmcnt(11)
  v_and_b32 v141, 0xffff0000, v145
  v_sub_f32 v117, v117, v141
  v_mfma_f32_32x32x16_bf16 v[8:23], v[232:235], v[88:91], v[8:23]
  ds_read_b128 v[84:87], v106 offset:53760
  v_cvt_pk_bf16_f32 v146, v117, 0
  v_mov_b32 v147, 0
  v_mfma_f32_32x32x16_bf16 v[24:39], v[232:235], v[92:95], v[24:39]
  ds_read_b128 v[88:91], v106 offset:13312
  s_waitcnt lgkmcnt(3)
  s_waitcnt vmcnt(10)
  s_lshl_b32 s13, s12, 4
  v_and_b32 v141, 15, v0
  v_mfma_f32_32x32x16_bf16 v[8:23], v[236:239], v[72:75], v[8:23]
  ds_read_b128 v[92:95], v106 offset:54272
  buffer_load_dwordx4 a[40:43], v1, s[48:51], 0 offen offset:3072
  buffer_load_dwordx4 a[44:47], v2, s[48:51], 0 offen offset:0
  v_add_u32 v141, s13, v141
  v_lshlrev_b32 v116, 4, v141
  v_mfma_f32_32x32x16_bf16 v[24:39], v[236:239], v[76:79], v[24:39]
  ds_read_b128 v[72:75], v106 offset:13824
  s_waitcnt lgkmcnt(3)
  s_waitcnt vmcnt(11)
  v_lshlrev_b32 v141, 2, v141
  v_add_u32 v116, 81920, v116
  v_mfma_f32_32x32x16_bf16 v[8:23], a[0:3], v[80:83], v[8:23]
  ds_read_b128 v[76:79], v106 offset:54784
  v_add_u32 v141, 82944, v141
  ds_write_b128 v116, v[144:147]
  v_mfma_f32_32x32x16_bf16 v[24:39], a[0:3], v[84:87], v[24:39]
  ds_read_b128 v[80:83], v106 offset:14336
  s_waitcnt lgkmcnt(4)
  s_waitcnt vmcnt(10)
  ds_write_b32 v141, v140
  v_mfma_f32_32x32x16_bf16 v[8:23], a[4:7], v[88:91], v[8:23]
  ds_read_b128 v[84:87], v106 offset:55296
  buffer_load_dwordx4 a[48:51], v2, s[48:51], 0 offen offset:1024
  buffer_load_dwordx4 a[52:55], v2, s[48:51], 0 offen offset:2048
  v_mfma_f32_32x32x16_bf16 v[24:39], a[4:7], v[92:95], v[24:39]
  ds_read_b128 v[88:91], v106 offset:14848
  s_waitcnt lgkmcnt(5)
  s_waitcnt vmcnt(11)
  v_mfma_f32_32x32x16_bf16 v[8:23], a[8:11], v[72:75], v[8:23]
  ds_read_b128 v[92:95], v106 offset:55808
  v_mfma_f32_32x32x16_bf16 v[24:39], a[8:11], v[76:79], v[24:39]
  s_waitcnt lgkmcnt(0)
  s_barrier
  ds_read_b128 v[72:75], v106 offset:15360
  s_waitcnt vmcnt(10)
  v_mfma_f32_32x32x16_bf16 v[8:23], a[12:15], v[80:83], v[8:23]
  ds_read_b128 v[76:79], v106 offset:56320
  buffer_load_dwordx4 a[56:59], v2, s[48:51], 0 offen offset:3072
  s_add_u32 s48, s48, 8192
  s_addc_u32 s49, s49, 0
  buffer_load_dwordx4 a[60:63], v1, s[48:51], 0 offen offset:0
  v_mfma_f32_32x32x16_bf16 v[24:39], a[12:15], v[84:87], v[24:39]
  ds_read_b128 v[80:83], v106 offset:15872
  s_waitcnt vmcnt(11)
  v_mfma_f32_32x32x16_bf16 v[8:23], a[16:19], v[88:91], v[8:23]
  ds_read_b128 v[84:87], v106 offset:56832
  v_and_b32 v140, 31, v0
  v_lshlrev_b32 v141, 2, v140
  v_mfma_f32_32x32x16_bf16 v[24:39], a[16:19], v[92:95], v[24:39]
  ds_read_b128 v[88:91], v106 offset:16384
  s_waitcnt lgkmcnt(3)
  s_waitcnt vmcnt(10)
  v_lshlrev_b32 v140, 4, v140
  v_add_u32 v140, 81920, v140
  v_mfma_f32_32x32x16_bf16 v[8:23], a[20:23], v[72:75], v[8:23]
  ds_read_b128 v[92:95], v106 offset:57344
  s_lshl_b32 s17, s12, 11
  buffer_load_dwordx4 v[52:55], v48, s[36:39], s17 offen sc1
  buffer_load_dwordx4 v[52:55], v48, s[36:39], s17 offen offset:1024 sc1
  v_add_u32 v141, 82944, v141
  ds_read_b128 v[132:135], v140 offset:0
  v_mfma_f32_32x32x16_bf16 v[24:39], a[20:23], v[76:79], v[24:39]
  ds_read_b128 v[72:75], v106 offset:16896
  s_waitcnt lgkmcnt(4)
  s_waitcnt vmcnt(11)
  ds_read_b32 v126, v141 offset:0
  ds_read_b128 v[136:139], v140 offset:512
  v_mfma_f32_32x32x16_bf16 v[8:23], a[24:27], v[80:83], v[8:23]
  ds_read_b128 v[76:79], v106 offset:57856
  ds_read_b32 v127, v141 offset:128
  v_mfma_f32_32x32x16_bf16 v[24:39], a[24:27], v[84:87], v[24:39]
  ds_read_b128 v[80:83], v106 offset:17408
  s_waitcnt lgkmcnt(7)
  s_waitcnt vmcnt(10)
  v_mfma_f32_32x32x16_bf16 v[8:23], a[28:31], v[88:91], v[8:23]
  ds_read_b128 v[84:87], v106 offset:58368
  v_mfma_f32_32x32x16_bf16 v[24:39], a[28:31], v[92:95], v[24:39]
  ds_read_b128 v[88:91], v106 offset:17920
  s_waitcnt lgkmcnt(4)
  s_waitcnt vmcnt(9)
  v_mfma_f32_32x32x16_bf16 v[8:23], a[32:35], v[72:75], v[8:23]
  ds_read_b128 v[92:95], v106 offset:58880
  v_mfma_f32_32x32x16_bf16 v[24:39], a[32:35], v[76:79], v[24:39]
  ds_read_b128 v[72:75], v106 offset:18432
  s_waitcnt lgkmcnt(3)
  s_waitcnt vmcnt(8)
  v_mfma_f32_32x32x16_bf16 v[8:23], a[36:39], v[80:83], v[8:23]
  ds_read_b128 v[76:79], v106 offset:59392
  v_mfma_f32_32x32x16_bf16 v[24:39], a[36:39], v[84:87], v[24:39]
  ds_read_b128 v[80:83], v106 offset:18944
  s_waitcnt lgkmcnt(3)
  s_waitcnt vmcnt(7)
  v_mfma_f32_32x32x16_bf16 v[8:23], a[40:43], v[88:91], v[8:23]
  ds_read_b128 v[84:87], v106 offset:59904
  v_mfma_f32_32x32x16_bf16 v[24:39], a[40:43], v[92:95], v[24:39]
  ds_read_b128 v[88:91], v106 offset:19456
  s_waitcnt lgkmcnt(3)
  s_waitcnt vmcnt(6)
  v_mfma_f32_32x32x16_bf16 v[8:23], a[44:47], v[72:75], v[8:23]
  ds_read_b128 v[92:95], v106 offset:60416
  v_mfma_f32_32x32x16_bf16 v[24:39], a[44:47], v[76:79], v[24:39]
  ds_read_b128 v[72:75], v106 offset:19968
  s_waitcnt lgkmcnt(3)
  s_waitcnt vmcnt(5)
  v_mfma_f32_32x32x16_bf16 v[8:23], a[48:51], v[80:83], v[8:23]
  ds_read_b128 v[76:79], v106 offset:60928
  v_mfma_f32_32x32x16_bf16 v[24:39], a[48:51], v[84:87], v[24:39]
  s_waitcnt lgkmcnt(2)
  s_waitcnt vmcnt(4)
  v_mfma_f32_32x32x16_bf16 v[8:23], a[52:55], v[88:91], v[8:23]
  v_mfma_f32_32x32x16_bf16 v[24:39], a[52:55], v[92:95], v[24:39]
  s_waitcnt lgkmcnt(0)
  s_waitcnt vmcnt(3)
  v_mfma_f32_32x32x16_bf16 v[8:23], a[56:59], v[72:75], v[8:23]
  v_mfma_f32_32x32x16_bf16 v[24:39], a[56:59], v[76:79], v[24:39]
  s_waitcnt vmcnt(2)
  v_mfma_f32_32x32x16_bf16 v[8:23], a[60:63], v[132:135], v[8:23]
  v_mfma_f32_32x32x16_bf16 v[24:39], a[60:63], v[136:139], v[24:39]
  s_cmp_eq_u32 s12, 2
  s_cselect_b32 vcc_hi, -1, 0
  s_mov_b32 vcc_lo, 0
  v_mul_f32 v116, 0x3ea52b5c, v126
  v_mul_f32 v118, 0x3ea52b5c, v127
  s_nop 5
  v_mul_f32 v20, v20, v126
  v_mul_f32 v21, v21, v126
  v_mul_f32 v22, v22, v126
  v_mul_f32 v23, v23, v126
  v_cvt_pk_bf16_f32 v102, v20, v21
  v_cvt_pk_bf16_f32 v103, v22, v23
  v_cndmask_b32 v102, v102, v40, vcc
  v_cndmask_b32 v103, v103, v41, vcc
  ds_write_b16 v42, v102 offset:0
  ds_write_b16_d16_hi v42, v102 offset:144
  ds_write_b16 v42, v103 offset:288
  ds_write_b16_d16_hi v42, v103 offset:432
  buffer_store_dwordx2 v[102:103], v48, s[32:35], s15 offen
  v_mul_f32 v36, v36, v127
  v_mul_f32 v37, v37, v127
  v_mul_f32 v38, v38, v127
  v_mul_f32 v39, v39, v127
  v_cvt_pk_bf16_f32 v110, v36, v37
  v_cvt_pk_bf16_f32 v111, v38, v39
  v_cndmask_b32 v110, v110, v40, vcc
  v_cndmask_b32 v111, v111, v41, vcc
  ds_write_b16 v42, v110 offset:64
  ds_write_b16_d16_hi v42, v110 offset:208
  ds_write_b16 v42, v111 offset:352
  ds_write_b16_d16_hi v42, v111 offset:496
  buffer_store_dwordx2 v[110:111], v48, s[32:35], s16 offen
  ds_read_b128 v[112:115], v43
  v_pk_mul_f32 v[8:9], v[8:9], v[116:117] op_sel_hi:[1,0]
  v_pk_mul_f32 v[10:11], v[10:11], v[116:117] op_sel_hi:[1,0]
  v_pk_mul_f32 v[12:13], v[12:13], v[116:117] op_sel_hi:[1,0]
  v_pk_mul_f32 v[14:15], v[14:15], v[116:117] op_sel_hi:[1,0]
  v_pk_mul_f32 v[16:17], v[16:17], v[116:117] op_sel_hi:[1,0]
  v_pk_mul_f32 v[18:19], v[18:19], v[116:117] op_sel_hi:[1,0]
  s_waitcnt lgkmcnt(0)
  buffer_store_dwordx4 v[112:115], v49, s[36:39], s19 offen offset:3072
  buffer_store_dwordx2 v[102:103], v1, s[32:35], s15 offen sc1
  buffer_store_dwordx2 v[110:111], v1, s[32:35], s16 offen sc1
  buffer_store_dwordx4 v[112:115], v44, s[36:39], s19 offen offset:3072 sc1
  v_cvt_pk_bf16_f32 v64, v8, v9
  v_cvt_pk_bf16_f32 v65, v10, v11
  v_cvt_pk_bf16_f32 v66, v12, v13
  v_cvt_pk_bf16_f32 v67, v14, v15
  v_cvt_pk_bf16_f32 v76, v16, v17
  v_cvt_pk_bf16_f32 v77, v18, v19
  ds_write_b128 v46, v[64:67] offset:0
  v_pk_mul_f32 v[24:25], v[24:25], v[118:119] op_sel_hi:[1,0]
  v_pk_mul_f32 v[26:27], v[26:27], v[118:119] op_sel_hi:[1,0]
  v_pk_mul_f32 v[28:29], v[28:29], v[118:119] op_sel_hi:[1,0]
  v_pk_mul_f32 v[30:31], v[30:31], v[118:119] op_sel_hi:[1,0]
  v_pk_mul_f32 v[32:33], v[32:33], v[118:119] op_sel_hi:[1,0]
  v_pk_mul_f32 v[34:35], v[34:35], v[118:119] op_sel_hi:[1,0]
  v_cvt_pk_bf16_f32 v68, v24, v25
  v_cvt_pk_bf16_f32 v69, v26, v27
  v_cvt_pk_bf16_f32 v70, v28, v29
  v_cvt_pk_bf16_f32 v71, v30, v31
  v_cvt_pk_bf16_f32 v78, v32, v33
  v_cvt_pk_bf16_f32 v79, v34, v35
  ds_write_b128 v46, v[68:71] offset:1024
  ds_write_b128 v46, v[76:79] offset:2048
  s_waitcnt lgkmcnt(0)
  s_barrier
  ds_read_b128 v[56:59], v47 offset:0
  ds_read_b128 v[60:63], v47 offset:1024
  ds_read_b128 v[72:75], v47 offset:2048
  s_waitcnt vmcnt(3)
  v_mov_b32 v6, s0
  buffer_store_dword v6, v3, s[44:47], s14 offen offset:768
  s_mov_b32 s3, 2
  s_add_u32 s79, s60, 32768
  s_mov_b32 s1, 66560
  s_add_u32 s20, s4, 40894464
  s_addc_u32 s21, s5, 0
  s_lshl_b32 s13, s10, 3
  s_add_u32 s13, s13, s11
  s_mul_i32 s13, s13, 12288
  s_add_u32 s13, s13, 33554432
  s_add_u32 s24, s4, s13
  s_addc_u32 s25, s5, 0
  s_mov_b32 s26, 12288
  s_mov_b32 s27, 0x20000
  s_mov_b32 s76, 0
  s_mul_i32 s13, s11, 7
  s_lshl_b32 s14, s12, 1
  s_add_u32 s13, s13, s14
  s_cmp_lt_u32 s13, 54
  s_cselect_b32 s82, 41984, 0
  s_add_u32 s15, s13, 1
  s_cmp_lt_u32 s15, 54
  s_cselect_b32 s83, 41984, 0
  s_cmp_lt_u32 s12, 3
  s_cselect_b32 s83, s83, 0
  s_mov_b32 s84, s13
  s_mul_i32 s14, s13, 41984
  s_add_u32 s14, s14, 2097152
  s_add_u32 s32, s4, s14
  s_addc_u32 s33, s5, 0
  s_mov_b32 s34, s82
  s_mov_b32 s35, 0x20000
  s_add_u32 s14, s14, 41984
  s_add_u32 s36, s4, s14
  s_addc_u32 s37, s5, 0
  s_mov_b32 s38, s83
  s_mov_b32 s39, 0x20000
  s_mul_i32 s14, s11, 102400
  s_mul_i32 s15, s12, 25600
  s_add_u32 s14, s14, s15
  s_add_u32 s14, s14, 8388608
  s_add_u32 s40, s4, s14
  s_addc_u32 s41, s5, 0
  s_mov_b32 s42, 4096
  s_mov_b32 s43, 0x20000
  s_cmp_lg_u32 s95, 0
  s_cselect_b32 s94, 524288, 0
  s_and_b32 s74, s10, 28
  s_and_b32 s13, s12, 1
  s_add_u32 s74, s74, s13
  s_mul_i32 s72, s74, 7168
  s_add_u32 s72, s72, s94
  s_add_u32 s28, s20, s72
  s_addc_u32 s29, s21, 0
  s_mov_b32 s30, 7168
  s_mov_b32 s31, 0x20000
  v_mov_b32 v80, 0
  v_mov_b32 v81, 0
  v_mov_b32 v82, 0
  v_mov_b32 v83, 0
  v_mov_b32 v84, 0
  v_mov_b32 v85, 0
  v_mov_b32 v86, 0
  v_mov_b32 v87, 0
  v_mov_b32 v88, 0
  v_mov_b32 v89, 0
  v_mov_b32 v90, 0
  v_mov_b32 v91, 0
  v_mov_b32 v92, 0
  v_mov_b32 v93, 0
  v_mov_b32 v94, 0
  v_mov_b32 v95, 0
  v_mov_b32 v96, 0
  v_mov_b32 v97, 0
  v_mov_b32 v98, 0
  v_mov_b32 v99, 0
  v_mov_b32 v100, 0
  v_mov_b32 v101, 0
  v_mov_b32 v102, 0
  v_mov_b32 v103, 0
  v_mov_b32 v104, 0
  v_mov_b32 v105, 0
  v_mov_b32 v106, 0
  v_mov_b32 v107, 0
  v_mov_b32 v108, 0
  v_mov_b32 v109, 0
  v_mov_b32 v110, 0
  v_mov_b32 v111, 0
  v_mov_b32 v112, 0
  v_mov_b32 v113, 0
  v_mov_b32 v114, 0
  v_mov_b32 v115, 0
  v_mov_b32 v116, 0
  v_mov_b32 v117, 0
  v_mov_b32 v118, 0
  v_mov_b32 v119, 0
  v_mov_b32 v120, 0
  v_mov_b32 v121, 0
  v_mov_b32 v122, 0
  v_mov_b32 v123, 0
  v_mov_b32 v124, 0
  v_mov_b32 v125, 0
  v_mov_b32 v126, 0
  v_mov_b32 v127, 0
  v_mov_b32 v128, 0
  v_mov_b32 v129, 0
  v_mov_b32 v130, 0
  v_mov_b32 v131, 0
  v_mov_b32 v132, 0
  v_mov_b32 v133, 0
  v_mov_b32 v134, 0
  v_mov_b32 v135, 0
  v_mov_b32 v136, 0
  v_mov_b32 v137, 0
  v_mov_b32 v138, 0
  v_mov_b32 v139, 0
  v_mov_b32 v140, 0
  v_mov_b32 v141, 0
  v_mov_b32 v142, 0
  v_mov_b32 v143, 0
  v_lshrrev_b32 v7, 3, v0
  v_and_b32 v8, 7, v0
  v_lshlrev_b32 v8, 2, v8
  v_lshl_add_u32 v8, v7, 11, v8
  v_lshrrev_b32 v7, 4, v0
  v_lshl_add_u32 v8, v7, 28, v8
  s_lshl_b32 s16, s74, 10
  s_add_u32 s16, s16, 32768
  s_mov_b32 s17, 0xffff
  s_waitcnt vmcnt(1)
  v_mov_b32 v6, s0
  buffer_store_dword v6, v3, s[44:47], s75 offen sc1
  s_waitcnt lgkmcnt(0)
  s_cmp_lg_u32 s95, 0
  s_cbranch_scc0 Lkvg2
  s_mov_b32 s80, 0x400000
Lpoll92:
  buffer_load_dword v6, v8, s[44:47], s16 offen offset:768 sc1
  s_sub_u32 s80, s80, 1
  s_cbranch_scc1 Lpolled92
  s_waitcnt vmcnt(0)
  v_cmp_eq_u32 vcc, s0, v6
  s_nop 0
  s_and_b32 s81, vcc_lo, s17
  s_cmp_eq_u32 s81, s17
  s_cbranch_scc0 Lpoll92
Lpolled92:
Lkvgd2:
  buffer_load_dwordx4 v[144:147], v1, s[28:31], 0 offen offset:0 sc1
  buffer_load_dwordx4 v[156:159], v1, s[28:31], 0 offen offset:2048 sc1
  buffer_load_dwordx4 v[168:171], v2, s[28:31], 0 offen sc1
  buffer_load_dwordx4 v[164:167], v1, s[28:31], 0 offen offset:3072 sc1
  buffer_load_dwordx4 v[172:175], v2, s[28:31], 0 offen offset:1024 sc1
  buffer_load_dwordx4 v[176:179], v2, s[28:31], 0 offen offset:2048 sc1
  buffer_load_dwordx4 v[148:151], v1, s[28:31], 0 offen offset:1024 sc1
  s_waitcnt vmcnt(0)
  s_branch Lattn_go
Lfin:
Lend:
  s_endpgm
Lout:
  s_waitcnt vmcnt(14)
  v_mfma_f32_16x16x32_bf16 v[12:15], v[244:247], a[232:235], v[12:15]
  v_mfma_f32_16x16x32_bf16 v[28:31], v[248:251], a[232:235], v[28:31]
  s_mov_b32 s82, 20480
  buffer_load_dwordx4 a[228:231], v88, s[32:35], s82 offen sc1
  v_mfma_f32_16x16x32_bf16 v[44:47], v[252:255], a[232:235], v[44:47]
  v_mfma_f32_16x16x32_bf16 v[60:63], a[96:99], a[232:235], v[60:63]
  v_mfma_f32_16x16x32_bf16 v[76:79], a[100:103], a[232:235], v[76:79]
  s_waitcnt vmcnt(14)
  v_mfma_f32_16x16x32_bf16 v[12:15], a[104:107], a[248:251], v[12:15]
  v_mfma_f32_16x16x32_bf16 v[28:31], a[108:111], a[248:251], v[28:31]
  buffer_load_dwordx4 a[244:247], v88, s[32:35], s64 offen sc1
  v_mfma_f32_16x16x32_bf16 v[44:47], a[112:115], a[248:251], v[44:47]
  v_mfma_f32_16x16x32_bf16 v[60:63], a[116:119], a[248:251], v[60:63]
  v_mfma_f32_16x16x32_bf16 v[76:79], a[120:123], a[248:251], v[76:79]
  s_waitcnt vmcnt(13)
  v_mfma_f32_16x16x32_bf16 v[12:15], a[124:127], v[156:159], v[12:15]
  v_mfma_f32_16x16x32_bf16 v[28:31], a[128:131], v[156:159], v[28:31]
  buffer_load_dwordx4 v[152:155], v88, s[32:35], s65 offen sc1
  v_mfma_f32_16x16x32_bf16 v[44:47], a[132:135], v[156:159], v[44:47]
  v_mfma_f32_16x16x32_bf16 v[60:63], a[136:139], v[156:159], v[60:63]
  v_mfma_f32_16x16x32_bf16 v[76:79], a[140:143], v[156:159], v[76:79]
  s_waitcnt vmcnt(13)
  v_mfma_f32_16x16x32_bf16 v[12:15], a[144:147], a[200:203], v[12:15]
  v_mfma_f32_16x16x32_bf16 v[28:31], a[148:151], a[200:203], v[28:31]
  buffer_load_dwordx4 a[196:199], v88, s[32:35], s66 offen sc1
  v_mfma_f32_16x16x32_bf16 v[44:47], a[152:155], a[200:203], v[44:47]
  s_waitcnt vmcnt(11)
  v_mfma_f32_16x16x32_bf16 v[60:63], a[156:159], a[200:203], v[60:63]
  s_waitcnt vmcnt(6)
  v_mfma_f32_16x16x32_bf16 v[76:79], a[160:163], a[200:203], v[76:79]
  v_mfma_f32_16x16x32_bf16 v[16:19], v[244:247], a[236:239], v[16:19]
  v_mfma_f32_16x16x32_bf16 v[32:35], v[248:251], a[236:239], v[32:35]
  ds_write_b128 v92, v[12:15] offset:0
  v_mfma_f32_16x16x32_bf16 v[48:51], v[252:255], a[236:239], v[48:51]
  v_mfma_f32_16x16x32_bf16 v[64:67], a[96:99], a[236:239], v[64:67]
  v_mfma_f32_16x16x32_bf16 v[80:83], a[100:103], a[236:239], v[80:83]
  v_mfma_f32_16x16x32_bf16 v[16:19], a[104:107], a[252:255], v[16:19]
  ds_write_b128 v92, v[28:31] offset:1024
  v_mfma_f32_16x16x32_bf16 v[32:35], a[108:111], a[252:255], v[32:35]
  v_mfma_f32_16x16x32_bf16 v[48:51], a[112:115], a[252:255], v[48:51]
  v_mfma_f32_16x16x32_bf16 v[64:67], a[116:119], a[252:255], v[64:67]
  v_mfma_f32_16x16x32_bf16 v[80:83], a[120:123], a[252:255], v[80:83]
  ds_write_b128 v92, v[44:47] offset:2048
  v_mfma_f32_16x16x32_bf16 v[16:19], a[124:127], v[160:163], v[16:19]
  v_mfma_f32_16x16x32_bf16 v[32:35], a[128:131], v[160:163], v[32:35]
  v_mfma_f32_16x16x32_bf16 v[48:51], a[132:135], v[160:163], v[48:51]
  v_mfma_f32_16x16x32_bf16 v[64:67], a[136:139], v[160:163], v[64:67]
  ds_write_b128 v92, v[60:63] offset:3072
  v_mfma_f32_16x16x32_bf16 v[80:83], a[140:143], v[160:163], v[80:83]
  v_mfma_f32_16x16x32_bf16 v[16:19], a[144:147], a[204:207], v[16:19]
  v_mfma_f32_16x16x32_bf16 v[32:35], a[148:151], a[204:207], v[32:35]
  v_mfma_f32_16x16x32_bf16 v[48:51], a[152:155], a[204:207], v[48:51]
  ds_write_b128 v92, v[76:79] offset:4096
  v_mfma_f32_16x16x32_bf16 v[64:67], a[156:159], a[204:207], v[64:67]
  v_mfma_f32_16x16x32_bf16 v[80:83], a[160:163], a[204:207], v[80:83]
  v_mfma_f32_16x16x32_bf16 v[20:23], v[244:247], a[240:243], v[20:23]
  v_mfma_f32_16x16x32_bf16 v[36:39], v[248:251], a[240:243], v[36:39]
  s_nop 0
  ds_write_b128 v92, v[16:19] offset:5120
  v_mfma_f32_16x16x32_bf16 v[52:55], v[252:255], a[240:243], v[52:55]
  v_mfma_f32_16x16x32_bf16 v[68:71], a[96:99], a[240:243], v[68:71]
  v_mfma_f32_16x16x32_bf16 v[84:87], a[100:103], a[240:243], v[84:87]
  v_mfma_f32_16x16x32_bf16 v[20:23], a[104:107], v[168:171], v[20:23]
  ds_write_b128 v92, v[32:35] offset:6144
  v_mfma_f32_16x16x32_bf16 v[36:39], a[108:111], v[168:171], v[36:39]
  v_mfma_f32_16x16x32_bf16 v[52:55], a[112:115], v[168:171], v[52:55]
  v_mfma_f32_16x16x32_bf16 v[68:71], a[116:119], v[168:171], v[68:71]
  v_mfma_f32_16x16x32_bf16 v[84:87], a[120:123], v[168:171], v[84:87]
  ds_write_b128 v92, v[48:51] offset:7168
  s_waitcnt vmcnt(5)
  v_mfma_f32_16x16x32_bf16 v[20:23], a[124:127], v[164:167], v[20:23]
  v_mfma_f32_16x16x32_bf16 v[36:39], a[128:131], v[164:167], v[36:39]
  v_mfma_f32_16x16x32_bf16 v[52:55], a[132:135], v[164:167], v[52:55]
  v_mfma_f32_16x16x32_bf16 v[68:71], a[136:139], v[164:167], v[68:71]
  ds_write_b128 v92, v[64:67] offset:8192
  v_mfma_f32_16x16x32_bf16 v[84:87], a[140:143], v[164:167], v[84:87]
  s_waitcnt vmcnt(4)
  v_mfma_f32_16x16x32_bf16 v[20:23], a[144:147], a[208:211], v[20:23]
  v_mfma_f32_16x16x32_bf16 v[36:39], a[148:151], a[208:211], v[36:39]
  v_mfma_f32_16x16x32_bf16 v[52:55], a[152:155], a[208:211], v[52:55]
  ds_write_b128 v92, v[80:83] offset:9216
  v_mfma_f32_16x16x32_bf16 v[68:71], a[156:159], a[208:211], v[68:71]
  v_mfma_f32_16x16x32_bf16 v[84:87], a[160:163], a[208:211], v[84:87]
  s_waitcnt vmcnt(3)
  v_mfma_f32_16x16x32_bf16 v[8:11], v[244:247], a[228:231], v[8:11]
  v_mfma_f32_16x16x32_bf16 v[24:27], v[248:251], a[228:231], v[24:27]
  ds_write_b128 v92, v[20:23] offset:10240
  v_mfma_f32_16x16x32_bf16 v[40:43], v[252:255], a[228:231], v[40:43]
  v_mfma_f32_16x16x32_bf16 v[56:59], a[96:99], a[228:231], v[56:59]
  v_mfma_f32_16x16x32_bf16 v[72:75], a[100:103], a[228:231], v[72:75]
  s_waitcnt vmcnt(2)
  v_mfma_f32_16x16x32_bf16 v[8:11], a[104:107], a[244:247], v[8:11]
  ds_write_b128 v92, v[36:39] offset:11264
  v_mfma_f32_16x16x32_bf16 v[24:27], a[108:111], a[244:247], v[24:27]
  v_mfma_f32_16x16x32_bf16 v[40:43], a[112:115], a[244:247], v[40:43]
  v_mfma_f32_16x16x32_bf16 v[56:59], a[116:119], a[244:247], v[56:59]
  v_mfma_f32_16x16x32_bf16 v[72:75], a[120:123], a[244:247], v[72:75]
  ds_write_b128 v92, v[52:55] offset:12288
  s_waitcnt vmcnt(1)
  v_mfma_f32_16x16x32_bf16 v[8:11], a[124:127], v[152:155], v[8:11]
  v_mfma_f32_16x16x32_bf16 v[24:27], a[128:131], v[152:155], v[24:27]
  v_mfma_f32_16x16x32_bf16 v[40:43], a[132:135], v[152:155], v[40:43]
  v_mfma_f32_16x16x32_bf16 v[56:59], a[136:139], v[152:155], v[56:59]
  ds_write_b128 v92, v[68:71] offset:13312
  v_mfma_f32_16x16x32_bf16 v[72:75], a[140:143], v[152:155], v[72:75]
  s_waitcnt vmcnt(0)
  v_mfma_f32_16x16x32_bf16 v[8:11], a[144:147], a[196:199], v[8:11]
  v_mfma_f32_16x16x32_bf16 v[24:27], a[148:151], a[196:199], v[24:27]
  v_mfma_f32_16x16x32_bf16 v[40:43], a[152:155], a[196:199], v[40:43]
  ds_write_b128 v92, v[84:87] offset:14336
  v_mfma_f32_16x16x32_bf16 v[56:59], a[156:159], a[196:199], v[56:59]
  v_mfma_f32_16x16x32_bf16 v[72:75], a[160:163], a[196:199], v[72:75]
  s_waitcnt lgkmcnt(0)
  s_barrier
  ds_read_b128 v[108:111], v93 offset:0
  ds_read_b128 v[112:115], v94 offset:0
  ds_read_b128 v[116:119], v95 offset:0
  ds_read_b128 v[120:123], v93 offset:1024
  ds_read_b128 v[124:127], v94 offset:1024
  ds_read_b128 v[128:131], v95 offset:1024
  ds_read_b128 v[132:135], v93 offset:2048
  ds_read_b128 v[136:139], v94 offset:2048
  ds_read_b128 v[140:143], v95 offset:2048
  ds_read_b128 v[144:147], v93 offset:3072
  ds_read_b128 v[148:151], v94 offset:3072
  ds_read_b128 v[152:155], v95 offset:3072
  ds_read_b128 v[156:159], v93 offset:4096
  ds_read_b128 v[160:163], v94 offset:4096
  ds_read_b128 v[164:167], v95 offset:4096
  v_lshlrev_b32 v16, 16, v96
  v_and_b32 v17, 0xffff0000, v96
  v_lshlrev_b32 v18, 16, v97
  v_and_b32 v19, 0xffff0000, v97
  v_lshlrev_b32 v32, 16, v98
  v_and_b32 v33, 0xffff0000, v98
  v_lshlrev_b32 v34, 16, v99
  v_and_b32 v35, 0xffff0000, v99
  v_lshlrev_b32 v48, 16, v100
  v_and_b32 v49, 0xffff0000, v100
  v_lshlrev_b32 v50, 16, v101
  v_and_b32 v51, 0xffff0000, v101
  v_lshlrev_b32 v64, 16, v102
  v_and_b32 v65, 0xffff0000, v102
  v_lshlrev_b32 v66, 16, v103
  v_and_b32 v67, 0xffff0000, v103
  v_lshlrev_b32 v80, 16, v104
  v_and_b32 v81, 0xffff0000, v104
  v_lshlrev_b32 v82, 16, v105
  v_and_b32 v83, 0xffff0000, v105
  s_waitcnt lgkmcnt(13)
  v_pk_add_f32 v[108:109], v[108:109], v[112:113]
  v_pk_add_f32 v[110:111], v[110:111], v[114:115]
  s_waitcnt lgkmcnt(12)
  v_pk_add_f32 v[8:9], v[8:9], v[116:117]
  v_pk_add_f32 v[10:11], v[10:11], v[118:119]
  v_pk_add_f32 v[8:9], v[8:9], v[108:109]
  v_pk_add_f32 v[10:11], v[10:11], v[110:111]
  v_pk_fma_f32 v[8:9], v[8:9], s[92:93], v[16:17]
  v_pk_fma_f32 v[10:11], v[10:11], s[92:93], v[18:19]
  v_cvt_pk_bf16_f32 v12, v8, v9
  v_cvt_pk_bf16_f32 v13, v10, v11
  s_waitcnt lgkmcnt(10)
  v_pk_add_f32 v[120:121], v[120:121], v[124:125]
  v_pk_add_f32 v[122:123], v[122:123], v[126:127]
  s_waitcnt lgkmcnt(9)
  v_pk_add_f32 v[24:25], v[24:25], v[128:129]
  v_pk_add_f32 v[26:27], v[26:27], v[130:131]
  v_pk_add_f32 v[24:25], v[24:25], v[120:121]
  v_pk_add_f32 v[26:27], v[26:27], v[122:123]
  v_pk_fma_f32 v[24:25], v[24:25], s[92:93], v[32:33]
  v_pk_fma_f32 v[26:27], v[26:27], s[92:93], v[34:35]
  v_cvt_pk_bf16_f32 v14, v24, v25
  v_cvt_pk_bf16_f32 v15, v26, v27
  s_waitcnt lgkmcnt(7)
  v_pk_add_f32 v[132:133], v[132:133], v[136:137]
  v_pk_add_f32 v[134:135], v[134:135], v[138:139]
  s_waitcnt lgkmcnt(6)
  v_pk_add_f32 v[40:41], v[40:41], v[140:141]
  v_pk_add_f32 v[42:43], v[42:43], v[142:143]
  v_pk_add_f32 v[40:41], v[40:41], v[132:133]
  v_pk_add_f32 v[42:43], v[42:43], v[134:135]
  v_pk_fma_f32 v[40:41], v[40:41], s[92:93], v[48:49]
  v_pk_fma_f32 v[42:43], v[42:43], s[92:93], v[50:51]
  v_cvt_pk_bf16_f32 v16, v40, v41
  v_cvt_pk_bf16_f32 v17, v42, v43
  s_waitcnt lgkmcnt(4)
  v_pk_add_f32 v[144:145], v[144:145], v[148:149]
  v_pk_add_f32 v[146:147], v[146:147], v[150:151]
  s_waitcnt lgkmcnt(3)
  v_pk_add_f32 v[56:57], v[56:57], v[152:153]
  v_pk_add_f32 v[58:59], v[58:59], v[154:155]
  v_pk_add_f32 v[56:57], v[56:57], v[144:145]
  v_pk_add_f32 v[58:59], v[58:59], v[146:147]
  v_pk_fma_f32 v[56:57], v[56:57], s[92:93], v[64:65]
  v_pk_fma_f32 v[58:59], v[58:59], s[92:93], v[66:67]
  v_cvt_pk_bf16_f32 v18, v56, v57
  v_cvt_pk_bf16_f32 v19, v58, v59
  s_waitcnt lgkmcnt(1)
  v_pk_add_f32 v[156:157], v[156:157], v[160:161]
  v_pk_add_f32 v[158:159], v[158:159], v[162:163]
  s_waitcnt lgkmcnt(0)
  v_pk_add_f32 v[72:73], v[72:73], v[164:165]
  v_pk_add_f32 v[74:75], v[74:75], v[166:167]
  v_pk_add_f32 v[72:73], v[72:73], v[156:157]
  v_pk_add_f32 v[74:75], v[74:75], v[158:159]
  v_pk_fma_f32 v[72:73], v[72:73], s[92:93], v[80:81]
  v_pk_fma_f32 v[74:75], v[74:75], s[92:93], v[82:83]
  v_cvt_pk_bf16_f32 v20, v72, v73
  v_cvt_pk_bf16_f32 v21, v74, v75
  s_mul_i32 s13, s10, 81920
  s_mul_i32 s14, s11, 160
  s_add_u32 s13, s13, s14
  s_mul_i32 s14, s12, 20480
  s_add_u32 s13, s13, s14
  s_mov_b32 s52, s6
  s_mov_b32 s53, s7
  s_mov_b32 s54, 2621440
  s_mov_b32 s55, 0x20000
  v_and_b32 v7, 15, v0
  v_mul_u32_u24 v7, 1280, v7
  v_lshrrev_b32 v6, 4, v0
  v_lshl_add_u32 v6, v6, 3, v7
  buffer_store_dwordx2 v[12:13], v6, s[52:55], s13 offen offset:0
  buffer_store_dwordx2 v[14:15], v6, s[52:55], s13 offen offset:32
  buffer_store_dwordx2 v[16:17], v6, s[52:55], s13 offen offset:64
  buffer_store_dwordx2 v[18:19], v6, s[52:55], s13 offen offset:96
  buffer_store_dwordx2 v[20:21], v6, s[52:55], s13 offen offset:128
  s_cmp_lg_u32 s8, 0
  s_cbranch_scc1 Lfin
  s_mov_b32 s46, 73732
  s_mov_b32 s13, 73728
  v_mov_b32 v7, s0
  buffer_store_dword v7, v3, s[44:47], s13 offen
  s_branch Lfin
Lfallback:
  s_waitcnt vmcnt(0) lgkmcnt(0)
  s_barrier
  s_mov_b32 s76, 1
  s_mov_b32 s94, 0
  v_mov_b32 v80, 0xff800000
  v_mov_b32 v81, 0xff800000
  v_mov_b32 v82, 0xff800000
  v_mov_b32 v83, 0xff800000
  s_and_b32 s74, s10, 28
  s_and_b32 s13, s12, 1
  s_add_u32 s74, s74, s13
  s_mul_i32 s72, s74, 7168
  s_add_u32 s28, s20, s72
  s_addc_u32 s29, s21, 0
  s_sub_u32 s32, s32, 32768
  s_subb_u32 s33, s33, 0
  s_sub_u32 s40, s40, 24576
  s_subb_u32 s41, s41, 0
  s_sub_u32 s36, s36, 32768
  s_subb_u32 s37, s37, 0
  s_mov_b32 s14, 16
Lfb_loop:
  buffer_load_dwordx4 v[144:147], v1, s[28:31], 0 offen
  buffer_load_dwordx4 v[148:151], v1, s[28:31], 0 offen offset:1024
  buffer_load_dwordx4 v[156:159], v1, s[28:31], 0 offen offset:2048
  s_waitcnt vmcnt(0)
  v_mfma_f32_32x32x16_bf16 v[8:23], v[144:147], v[56:59], 0
  v_mfma_f32_32x32x8_bf16 v[8:23], v[156:157], v[72:73], v[8:23]
  s_nop 11
  v_max3_f32 v80, v80, v8, v9
  v_max3_f32 v80, v80, v10, v11
  v_max3_f32 v80, v80, v12, v13
  v_max3_f32 v80, v80, v14, v15
  v_max3_f32 v80, v80, v16, v17
  v_max3_f32 v80, v80, v18, v19
  v_max3_f32 v80, v80, v20, v21
  v_max3_f32 v80, v80, v22, v23
  v_mfma_f32_32x32x16_bf16 v[24:39], v[144:147], v[60:63], 0
  v_mfma_f32_32x32x8_bf16 v[24:39], v[156:157], v[74:75], v[24:39]
  s_nop 11
  v_max3_f32 v81, v81, v24, v25
  v_max3_f32 v81, v81, v26, v27
  v_max3_f32 v81, v81, v28, v29
  v_max3_f32 v81, v81, v30, v31
  v_max3_f32 v81, v81, v32, v33
  v_max3_f32 v81, v81, v34, v35
  v_max3_f32 v81, v81, v36, v37
  v_max3_f32 v81, v81, v38, v39
  v_mfma_f32_32x32x16_bf16 v[8:23], v[144:147], v[64:67], 0
  v_mfma_f32_32x32x8_bf16 v[8:23], v[156:157], v[76:77], v[8:23]
  s_nop 11
  v_max3_f32 v82, v82, v8, v9
  v_max3_f32 v82, v82, v10, v11
  v_max3_f32 v82, v82, v12, v13
  v_max3_f32 v82, v82, v14, v15
  v_max3_f32 v82, v82, v16, v17
  v_max3_f32 v82, v82, v18, v19
  v_max3_f32 v82, v82, v20, v21
  v_max3_f32 v82, v82, v22, v23
  v_mfma_f32_32x32x16_bf16 v[24:39], v[144:147], v[68:71], 0
  v_mfma_f32_32x32x8_bf16 v[24:39], v[156:157], v[78:79], v[24:39]
  s_nop 11
  v_max3_f32 v83, v83, v24, v25
  v_max3_f32 v83, v83, v26, v27
  v_max3_f32 v83, v83, v28, v29
  v_max3_f32 v83, v83, v30, v31
  v_max3_f32 v83, v83, v32, v33
  v_max3_f32 v83, v83, v34, v35
  v_max3_f32 v83, v83, v36, v37
  v_max3_f32 v83, v83, v38, v39
  v_mfma_f32_32x32x16_bf16 v[8:23], v[148:151], v[56:59], 0
  v_mfma_f32_32x32x8_bf16 v[8:23], v[158:159], v[72:73], v[8:23]
  s_nop 11
  v_max3_f32 v80, v80, v8, v9
  v_max3_f32 v80, v80, v10, v11
  v_max3_f32 v80, v80, v12, v13
  v_max3_f32 v80, v80, v14, v15
  v_max3_f32 v80, v80, v16, v17
  v_max3_f32 v80, v80, v18, v19
  v_max3_f32 v80, v80, v20, v21
  v_max3_f32 v80, v80, v22, v23
  v_mfma_f32_32x32x16_bf16 v[24:39], v[148:151], v[60:63], 0
  v_mfma_f32_32x32x8_bf16 v[24:39], v[158:159], v[74:75], v[24:39]
  s_nop 11
  v_max3_f32 v81, v81, v24, v25
  v_max3_f32 v81, v81, v26, v27
  v_max3_f32 v81, v81, v28, v29
  v_max3_f32 v81, v81, v30, v31
  v_max3_f32 v81, v81, v32, v33
  v_max3_f32 v81, v81, v34, v35
  v_max3_f32 v81, v81, v36, v37
  v_max3_f32 v81, v81, v38, v39
  v_mfma_f32_32x32x16_bf16 v[8:23], v[148:151], v[64:67], 0
  v_mfma_f32_32x32x8_bf16 v[8:23], v[158:159], v[76:77], v[8:23]
  s_nop 11
  v_max3_f32 v82, v82, v8, v9
  v_max3_f32 v82, v82, v10, v11
  v_max3_f32 v82, v82, v12, v13
  v_max3_f32 v82, v82, v14, v15
  v_max3_f32 v82, v82, v16, v17
  v_max3_f32 v82, v82, v18, v19
  v_max3_f32 v82, v82, v20, v21
  v_max3_f32 v82, v82, v22, v23
  v_mfma_f32_32x32x16_bf16 v[24:39], v[148:151], v[68:71], 0
  v_mfma_f32_32x32x8_bf16 v[24:39], v[158:159], v[78:79], v[24:39]
  s_nop 11
  v_max3_f32 v83, v83, v24, v25
  v_max3_f32 v83, v83, v26, v27
  v_max3_f32 v83, v83, v28, v29
  v_max3_f32 v83, v83, v30, v31
  v_max3_f32 v83, v83, v32, v33
  v_max3_f32 v83, v83, v34, v35
  v_max3_f32 v83, v83, v36, v37
  v_max3_f32 v83, v83, v38, v39
  s_add_u32 s74, s74, 2
  s_and_b32 s74, s74, 31
  s_mul_i32 s72, s74, 7168
  s_add_u32 s28, s20, s72
  s_addc_u32 s29, s21, 0
  s_sub_u32 s14, s14, 1
  s_cmp_lg_u32 s14, 0
  s_cbranch_scc1 Lfb_loop
  v_mov_b32 v84, v80
  v_mov_b32 v85, v81
  v_mov_b32 v86, v82
  v_mov_b32 v87, v83
  v_permlane32_swap_b32 v80, v84
  v_permlane32_swap_b32 v81, v85
  v_permlane32_swap_b32 v82, v86
  v_permlane32_swap_b32 v83, v87
  v_max_f32 v80, v80, v84
  v_max_f32 v81, v81, v85
  v_max_f32 v82, v82, v86
  v_max_f32 v83, v83, v87
  s_mul_i32 s13, s12, 15360
  s_add_u32 s13, s13, 110592
  s_xor_b32 s14, s12, 1
  s_mul_i32 s14, s14, 15360
  s_add_u32 s14, s14, 110592
  v_add_u32 v88, s13, v1
  v_add_u32 v89, s14, v1
  ds_write_b128 v88, v[80:83]
  s_waitcnt lgkmcnt(0)
  s_barrier
  ds_read_b128 v[84:87], v89
  v_cmp_le_u32 vcc, 32, v0
  s_waitcnt lgkmcnt(0)
  v_max_f32 v92, v80, v86
  v_sub_f32 v92, 0, v92
  v_cvt_pk_bf16_f32 v93, v92, v92
  v_and_b32 v93, 0xffff0000, v93
  v_sub_f32 v92, v92, v93
  v_cvt_pk_bf16_f32 v94, v93, v92
  v_and_b32 v93, 0xffff0000, v94
  v_sub_f32 v92, v92, v93
  v_cvt_pk_bf16_f32 v93, v92, 0
  v_cndmask_b32 v72, v72, v94, vcc
  v_cndmask_b32 v73, v73, v93, vcc
  v_max_f32 v92, v81, v87
  v_sub_f32 v92, 0, v92
  v_cvt_pk_bf16_f32 v93, v92, v92
  v_and_b32 v93, 0xffff0000, v93
  v_sub_f32 v92, v92, v93
  v_cvt_pk_bf16_f32 v94, v93, v92
  v_and_b32 v93, 0xffff0000, v94
  v_sub_f32 v92, v92, v93
  v_cvt_pk_bf16_f32 v93, v92, 0
  v_cndmask_b32 v74, v74, v94, vcc
  v_cndmask_b32 v75, v75, v93, vcc
  v_max_f32 v92, v82, v84
  v_sub_f32 v92, 0, v92
  v_cvt_pk_bf16_f32 v93, v92, v92
  v_and_b32 v93, 0xffff0000, v93
  v_sub_f32 v92, v92, v93
  v_cvt_pk_bf16_f32 v94, v93, v92
  v_and_b32 v93, 0xffff0000, v94
  v_sub_f32 v92, v92, v93
  v_cvt_pk_bf16_f32 v93, v92, 0
  v_cndmask_b32 v76, v76, v94, vcc
  v_cndmask_b32 v77, v77, v93, vcc
  v_max_f32 v92, v83, v85
  v_sub_f32 v92, 0, v92
  v_cvt_pk_bf16_f32 v93, v92, v92
  v_and_b32 v93, 0xffff0000, v93
  v_sub_f32 v92, v92, v93
  v_cvt_pk_bf16_f32 v94, v93, v92
  v_and_b32 v93, 0xffff0000, v94
  v_sub_f32 v92, v92, v93
  v_cvt_pk_bf16_f32 v93, v92, 0
  v_cndmask_b32 v78, v78, v94, vcc
  v_cndmask_b32 v79, v79, v93, vcc
  buffer_load_dwordx4 v[164:167], v1, s[28:31], 0 offen offset:3072 sc1
  buffer_load_dwordx4 v[168:171], v2, s[28:31], 0 offen sc1
  buffer_load_dwordx4 v[156:159], v1, s[28:31], 0 offen offset:2048 sc1
  buffer_load_dwordx4 v[144:147], v1, s[28:31], 0 offen offset:0 sc1
  buffer_load_dwordx4 v[172:175], v2, s[28:31], 0 offen offset:1024 sc1
  buffer_load_dwordx4 v[176:179], v2, s[28:31], 0 offen offset:2048 sc1
  buffer_load_dwordx4 v[148:151], v1, s[28:31], 0 offen offset:1024 sc1
  s_waitcnt vmcnt(0) lgkmcnt(0)
  s_barrier
  s_branch Lattn_main
Lkvg1:
  s_lshl_b32 s13, s74, 1
  s_lshl_b64 s[22:23], 0x33, s13
  s_mov_b32 s80, 0x100000
Lkvp11:
  s_sleep 4
  buffer_load_dwordx4 v[236:239], v1, s[44:47], s1 offen sc1
  s_sub_u32 s80, s80, 1
  s_cbranch_scc1 Lkvq11
  s_waitcnt vmcnt(0)
  v_xor_b32 v236, s0, v236
  v_xor_b32 v237, s0, v237
  v_xor_b32 v238, s0, v238
  v_xor_b32 v239, s0, v239
  v_or3_b32 v236, v236, v237, v238
  v_or3_b32 v236, v236, v239, v239
  v_cmp_eq_u32 vcc, 0, v236
  s_nop 1
  s_and_b64 vcc, vcc, s[22:23]
  s_cmp_eq_u64 vcc, s[22:23]
  s_cbranch_scc0 Lkvp11
Lkvq11:
  s_branch Lkvgd1
Lkvs:
  s_mov_b32 s80, 0x100000
Lkvp1:
  s_sleep 8
  buffer_load_dwordx4 v[236:239], v1, s[44:47], s1 offen sc1
  s_sub_u32 s80, s80, 1
  s_cbranch_scc1 Lkvq1
  s_waitcnt vmcnt(0)
  v_xor_b32 v236, s0, v236
  v_xor_b32 v237, s0, v237
  v_xor_b32 v238, s0, v238
  v_xor_b32 v239, s0, v239
  v_or3_b32 v236, v236, v237, v238
  v_or3_b32 v236, v236, v239, v239
  v_cmp_eq_u32 vcc, 0, v236
  s_nop 1
  s_and_b64 vcc, vcc, s[22:23]
  s_cmp_eq_u64 vcc, s[22:23]
  s_cbranch_scc0 Lkvp1
Lkvq1:
  s_branch Lkvd
Lrls:
  s_mov_b32 s80, 0x100000
Lrlp:
  s_sleep 8
  buffer_load_dwordx4 v[188:191], v1, s[44:47], s18 offen offset:0 sc1
  buffer_load_dwordx4 v[192:195], v1, s[44:47], s18 offen offset:1024 sc1
  buffer_load_dwordx4 v[196:199], v1, s[44:47], s18 offen offset:2048 sc1
  buffer_load_dwordx4 v[200:203], v1, s[44:47], s18 offen offset:3072 sc1
  s_sub_u32 s80, s80, 1
  s_cbranch_scc1 Lrld
  s_waitcnt vmcnt(0)
  v_xor_b32 v188, s0, v188
  v_xor_b32 v189, s0, v189
  v_xor_b32 v190, s0, v190
  v_xor_b32 v191, s0, v191
  v_xor_b32 v192, s0, v192
  v_xor_b32 v193, s0, v193
  v_xor_b32 v194, s0, v194
  v_xor_b32 v195, s0, v195
  v_xor_b32 v196, s0, v196
  v_xor_b32 v197, s0, v197
  v_xor_b32 v198, s0, v198
  v_xor_b32 v199, s0, v199
  v_xor_b32 v200, s0, v200
  v_xor_b32 v201, s0, v201
  v_xor_b32 v202, s0, v202
  v_xor_b32 v203, s0, v203
  v_or3_b32 v188, v188, v189, v190
  v_or3_b32 v188, v188, v191, v192
  v_or3_b32 v188, v188, v193, v194
  v_or3_b32 v188, v188, v195, v196
  v_or3_b32 v188, v188, v197, v198
  v_or3_b32 v188, v188, v199, v200
  v_or3_b32 v188, v188, v201, v202
  v_or3_b32 v188, v188, v203, v203
  v_cmp_eq_u32 vcc, 0, v188
  s_nop 1
  s_and_b64 vcc, vcc, s[22:23]
  s_cmp_eq_u64 vcc, s[22:23]
  s_cbranch_scc0 Lrlp
  s_branch Lrld
Lsigs0:
  buffer_wbl2 sc1
  s_waitcnt vmcnt(0)
  buffer_store_dword v6, v3, s[44:47], s79 offen offset:0 sc1
  s_branch Lsigd0
Lacqs0:
  buffer_inv sc1
  s_waitcnt vmcnt(0)
  s_branch Lacq0
Lsigs1:
  buffer_wbl2 sc1
  s_waitcnt vmcnt(0)
  buffer_store_dword v6, v3, s[44:47], s79 offen offset:128 sc1
  s_branch Lsigd1
Lacqs1:
  buffer_inv sc1
  s_waitcnt vmcnt(0)
  s_branch Lacq1
Lsigs2:
  buffer_wbl2 sc1
  s_waitcnt vmcnt(0)
  buffer_store_dword v6, v3, s[44:47], s79 offen offset:256 sc1
  s_branch Lsigd2
Lchk2:
  s_mov_b32 s80, 0x400000
Lpoll2:
  buffer_load_dword v6, v4, s[44:47], s79 offen offset:256 sc1
  s_sub_u32 s80, s80, 1
  s_cbranch_scc1 Lpolled2
  s_waitcnt vmcnt(0)
  v_cmp_eq_u32 vcc, s0, v6
  s_nop 1
  s_and_b32 s81, vcc_lo, s77
  s_cmp_eq_u32 s81, s77
  s_cbranch_scc0 Lpoll2
Lpolled2:
  s_cmp_lg_u32 s73, 0
  s_cbranch_scc1 Lchkd2
  buffer_inv sc1
  s_waitcnt vmcnt(0)
  s_branch Lchkd2
Lsigs5:
  buffer_wbl2 sc1
  s_waitcnt vmcnt(0)
  buffer_store_dword v6, v3, s[44:47], s79 offen offset:640 sc1
  s_branch Lsigd5
Lchk3:
  s_mov_b32 s80, 0x400000
Lpoll3:
  buffer_load_dword v6, v4, s[44:47], s79 offen offset:640 sc1
  s_sub_u32 s80, s80, 1
  s_cbranch_scc1 Lpolled3
  s_waitcnt vmcnt(0)
  v_cmp_eq_u32 vcc, s0, v6
  s_nop 1
  s_and_b32 s81, vcc_lo, s77
  s_cmp_eq_u32 s81, s77
  s_cbranch_scc0 Lpoll3
Lpolled3:
  s_cmp_lg_u32 s73, 0
  s_cbranch_scc1 Lchkd3
  buffer_inv sc1
  s_waitcnt vmcnt(0)
  s_branch Lchkd3
Lsigs3:
  buffer_wbl2 sc1
  s_waitcnt vmcnt(0)
  buffer_store_dword v6, v3, s[44:47], s79 offen offset:384 sc1
  s_branch Lsigd3
Lacqs4:
  buffer_inv sc1
  s_waitcnt vmcnt(0)
  s_branch Lacq4
Lkvg2:
  s_lshl_b32 s13, s74, 1
  s_lshl_b64 s[22:23], 0x33, s13
  s_mov_b32 s80, 0x100000
Lkvp12:
  s_sleep 4
  buffer_load_dwordx4 v[236:239], v1, s[44:47], s1 offen sc1
  s_sub_u32 s80, s80, 1
  s_cbranch_scc1 Lkvq12
  s_waitcnt vmcnt(0)
  v_xor_b32 v236, s0, v236
  v_xor_b32 v237, s0, v237
  v_xor_b32 v238, s0, v238
  v_xor_b32 v239, s0, v239
  v_or3_b32 v236, v236, v237, v238
  v_or3_b32 v236, v236, v239, v239
  v_cmp_eq_u32 vcc, 0, v236
  s_nop 1
  s_and_b64 vcc, vcc, s[22:23]
  s_cmp_eq_u64 vcc, s[22:23]
  s_cbranch_scc0 Lkvp12
Lkvq12:
  s_branch Lkvgd2
Lcode_end:
.section .rodata,"a"
.p2align 6
.amdhsa_kernel interleave_layers__grouped_kv_mqa__dense_activation_mish__prompt_kernel
  .amdhsa_next_free_vgpr 512
  .amdhsa_next_free_sgpr 102
  .amdhsa_accum_offset 256
  .amdhsa_group_segment_fixed_size 0
  .amdhsa_kernarg_size 96
  .amdhsa_user_sgpr_count 2
  .amdhsa_user_sgpr_kernarg_segment_ptr 1
  .amdhsa_system_sgpr_workgroup_id_x 1
.end_amdhsa_kernel
```
